```python
import torch

def _softmax(x, axis=-1):
    return torch.softmax(x, dim=axis)
def _gelu(x):
    return torch.nn.functional.gelu(x, approximate="tanh")
def _silu(x):
    return torch.nn.functional.silu(x)
def _sigmoid(x):
    return torch.sigmoid(x)
def _layernorm(x, axis=-1, eps=1e-5):
    m = x.mean(dim=axis, keepdim=True)
    v = x.var(dim=axis, keepdim=True, unbiased=False)
    return (x - m) / torch.sqrt(v + eps)
def _scatter_add(tgt, idx, src, axis=0):
    return tgt.clone().index_add_(axis, idx, src)
def _segment_sum(src, seg, n):
    out = torch.zeros((n,) + src.shape[1:], dtype=src.dtype)
    return out.index_add_(0, seg, src)
def _pad(x, pw):
    flat = tuple(v for pair in reversed(pw) for v in pair)
    return torch.nn.functional.pad(x, flat)

kernel_name = 'recurrent_scan__sliding_block__swiglu_ffn__prompt'

def setup_inputs():

    _w = (lambda a: (lambda t: t.to(torch.bfloat16) if t.is_floating_point() else t)(torch.as_tensor(a)))
    def _A_setup():
        B, S, D = 1, 2048, 640
        return {
            "x": _w((lambda *s: torch.randn(*s, dtype=torch.bfloat16) * 0.05)(B, S, D)),
            "wqkv": _w((lambda *s: torch.randn(*s, dtype=torch.bfloat16) * 0.05)(D, 3 * D)),
            "wo": _w((lambda *s: torch.randn(*s, dtype=torch.bfloat16) * 0.05)(D, D)),
        }
    _A_in = _A_setup()

    def _B_setup():
        B, S, D, F = 1, 2048, 640, 1536
        return {
            "x": _w((lambda *s: torch.randn(*s, dtype=torch.bfloat16) * 0.05)(B, S, D)),
            "w_gate": _w((lambda *s: torch.randn(*s, dtype=torch.bfloat16) * 0.05)(D, F)),
            "w_up": _w((lambda *s: torch.randn(*s, dtype=torch.bfloat16) * 0.05)(D, F)),
            "w_down": _w((lambda *s: torch.randn(*s, dtype=torch.bfloat16) * 0.05)(F, D)),
        }
    _B_in = _B_setup()

    return {
        "A_x": _A_in["x"],
        "A_wqkv": _A_in["wqkv"],
        "A_wo": _A_in["wo"],
        "B_x": _B_in["x"],
        "B_w_gate": _B_in["w_gate"],
        "B_w_up": _B_in["w_up"],
        "B_w_down": _B_in["w_down"],
    }

def reference(A_x, A_wqkv, A_wo, B_x, B_w_gate, B_w_up, B_w_down):
    def _A_ref(x, wqkv, wo):
        B, S, D = x.shape
        H = 32; Dh = D // H; W = 256
        qkv = (lambda x, *d: x.permute(*d))((x @ wqkv).reshape(B, S, 3, H, Dh), 2, 0, 3, 1, 4)
        q, k, v = qkv[0], qkv[1], qkv[2]
        scores = torch.einsum("bhqd,bhkd->bhqk", q, k) * (Dh ** -0.5)
        idx = torch.arange(S)
        mask = (idx[:, None] - idx[None, :] >= 0) & (idx[:, None] - idx[None, :] < W)
        scores = torch.where(mask[None, None], scores, -1e9)
        p = _softmax(scores, axis=-1)
        o = torch.einsum("bhqk,bhkd->bhqd", p, v)
        return (lambda x, *d: x.permute(*d))(o, 0, 2, 1, 3).reshape(B, S, D) @ wo

    def _B_ref(x, w_gate, w_up, w_down):
        g = _silu(x @ w_gate)
        u = x @ w_up
        return (g * u) @ w_down

    x = A_x
    xn = _layernorm(x, axis=-1)
    s = _A_ref(xn, A_wqkv, A_wo)
    g = _silu(_B_ref(xn, B_w_gate, B_w_up, B_w_down))
    return x + s * g
```

```asm
; @launch grid=(256,1,1) block=(512,1,1) lds=163840
.amdgcn_target "amdgcn-amd-amdhsa--gfx950"
.text
.p2align 12
.globl recurrent_scan__sliding_block__swiglu_ffn__prompt_kernel
.p2align 8
.type recurrent_scan__sliding_block__swiglu_ffn__prompt_kernel,@function
recurrent_scan__sliding_block__swiglu_ffn__prompt_kernel:
    s_cmp_ge_u32 s2, 256
    s_cbranch_scc1 L_end
    s_load_dwordx2 s[4:5], s[0:1], 0
    s_bitcmp1_b32 s2, 6
    s_cselect_b32 s58, 8, 32
    s_cselect_b32 s59, 8, 40
    s_load_dwordx2 s[36:37], s[0:1], s58
    s_load_dwordx2 s[64:65], s[0:1], s59
    s_load_dwordx2 s[8:9], s[0:1], 8
    s_load_dwordx2 s[20:21], s[0:1], 72
    s_load_dwordx2 s[24:25], s[0:1], 64
    v_lshrrev_b32 v1, 6, v0
    v_and_b32 v0, 63, v0
    v_readfirstlane_b32 s46, v1
    s_and_b32 s44, s2, 1
    s_bfe_u32 s58, s2, 0x30003
    s_lshl3_add_u32 s44, s44, s58
    s_bfe_u32 s59, s2, 0x20001
    s_lshr_b32 s58, s2, 6
    s_lshl2_add_u32 s45, s59, s58
    s_and_b32 s47, s46, 3
    s_mov_b32 s6, 2621440
    s_mov_b32 s7, 0x20000
    s_mul_i32 s77, s59, 768
    s_and_b32 s60, s2, 128
    s_add_u32 s60, s60, s77
    s_and_b32 s61, s45, 14
    s_lshl_b32 s61, s61, 7
    s_movk_i32 s62, 3072
    s_bitcmp1_b32 s2, 6
    s_cselect_b32 s85, s61, s60
    s_cselect_b32 s68, 3840, s62
    s_cselect_b32 s63, 128, 0
    s_mul_i32 s38, s68, 640
    s_mov_b32 s39, 0x20000
    s_mov_b32 s66, s38
    s_mov_b32 s67, 0x20000
    v_lshrrev_b32 v20, 3, v0
    v_and_b32 v21, 7, v0
    v_lshlrev_b32 v21, 4, v21
    s_lshl_b32 s50, s46, 11
    s_lshl3_add_u32 s48, s44, s46
    s_mul_i32 s48, s48, 20480
    v_and_b32 v23, 48, v0
    v_xor_b32 v23, v21, v23
    v_mul_u32_u24 v84, 1280, v20
    v_add_u32 v84, v84, v23
    v_xor_b32 v85, 64, v84
    v_add_u32 v85, 9216, v85
    s_cmp_lt_u32 s46, 4
    s_cbranch_scc1 L_setA
    s_lshl4_add_u32 s58, s44, s45
    s_lshl2_add_u32 s58, s58, s47
    s_mul_i32 s75, s58, 2560
    v_lshrrev_b32 v238, 5, v0
    v_mul_u32_u24 v237, 1280, v238
    v_and_b32 v239, 31, v0
    v_lshl_add_u32 v236, v239, 4, v237
    v_lshl_add_u32 v237, v239, 3, v237
    s_waitcnt lgkmcnt(0)
    buffer_load_dwordx4 v[216:219], v236, s[4:7], s75 offen
    s_add_u32 m0, s50, 65536
    s_nop 0
    buffer_load_dwordx4 v84, s[4:7], s48 offen lds
    buffer_load_dwordx4 v85, s[4:7], s48 offen offset:1024 lds
    s_add_u32 s48, s48, 128
    s_mul_i32 s49, s46, s68
    s_lshl3_add_u32 s49, s49, s85
    s_lshl_b32 s84, s68, 6
    v_and_b32 v22, 16, v0
    v_lshlrev_b32 v22, 2, v22
    s_lshl_b32 s73, s46, 5
    v_and_or_b32 v22, s73, 32, v22
    v_xor_b32 v28, v21, v22
    v_mad_u32_u24 v4, v20, s68, v28
    v_xor_b32 v5, s63, v4
    s_add_u32 m0, s50, 0
    s_nop 0
    buffer_load_dwordx4 v4, s[36:39], s49 offen lds
    s_add_u32 m0, s50, 1024
    s_nop 0
    buffer_load_dwordx4 v5, s[64:67], s49 offen lds
    s_add_u32 s49, s49, s84
    s_branch L_setB
L_setA:
    s_lshr_b32 s58, s44, 1
    s_and_b32 s60, s63, 128
    s_bitcmp1_b32 s44, 0
    s_cselect_b32 s60, s60, 0
    s_add_u32 s60, s60, s85
    s_mul_i32 s59, s58, 80
    s_mul_i32 s59, s59, s68
    s_add_u32 s74, s59, s60
    s_lshl_b32 s82, s68, 3
    v_mad_u32_u24 v86, v20, s68, v21
    s_mov_b32 s42, s38
    s_mov_b32 s43, 0x20000
    s_mov_b32 s22, 25165824
    s_mov_b32 s23, 0x20000
    s_lshl_b32 s59, s58, 2
    s_lshr_b32 s53, 0x11110000, s59
    s_and_b32 s53, s53, 15
    s_cmp_eq_u32 s46, 0
    s_cselect_b32 s53, s53, 15
    s_bitcmp1_b32 s44, 0
    s_waitcnt lgkmcnt(0)
    s_cselect_b64 s[40:41], s[64:65], s[36:37]
    s_cmp_lg_u32 s53, 0
    s_cbranch_scc1 L_ncb0
    buffer_load_dwordx4 v[216:219], v86, s[40:43], s74 offen
    s_add_u32 s74, s74, s82
    buffer_load_dwordx4 v[220:223], v86, s[40:43], s74 offen
    s_add_u32 s74, s74, s82
    buffer_load_dwordx4 v[224:227], v86, s[40:43], s74 offen
    s_add_u32 s74, s74, s82
    buffer_load_dwordx4 v[228:231], v86, s[40:43], s74 offen
    s_add_u32 s74, s74, s82
    buffer_load_dwordx4 v[232:235], v86, s[40:43], s74 offen
    s_add_u32 s74, s74, s82
    buffer_load_dwordx4 v[236:239], v86, s[40:43], s74 offen
    s_add_u32 s74, s74, s82
    buffer_load_dwordx4 v[240:243], v86, s[40:43], s74 offen
    s_add_u32 s74, s74, s82
    buffer_load_dwordx4 v[244:247], v86, s[40:43], s74 offen
    s_add_u32 s74, s74, s82
    buffer_load_dwordx4 v[248:251], v86, s[40:43], s74 offen
    s_add_u32 s74, s74, s82
    buffer_load_dwordx4 v[252:255], v86, s[40:43], s74 offen
L_ncb0:
    s_and_b32 s62, s2, 0xe7
    s_lshl3_add_u32 s62, s62, s46
    s_cmp_lg_u32 s62, 3
    s_cbranch_scc1 L_noclr
    v_lshlrev_b32 v156, 7, v0
    v_mov_b32 v160, 0
    s_lshl_b32 s62, s44, 13
    buffer_store_dword v160, v156, s[20:23], s62 offen sc1
L_noclr:
    s_cmp_lg_u32 s46, 1
    s_cbranch_scc1 L_nopf
    s_getpc_b64 s[60:61]
L_pc:
    s_lshr_b32 s62, s2, 3
    s_mul_i32 s62, s62, 2048
    v_lshl_add_u32 v156, v0, 7, s62
    v_min_u32 v156, L_end-L_pc, v156
    s_mov_b64 exec, 65535
    global_load_dword v157, v156, s[60:61]
    s_mov_b64 exec, -1
L_nopf:
    s_add_u32 m0, s50, 65536
    s_nop 0
    buffer_load_dwordx4 v84, s[4:7], s48 offen lds
    buffer_load_dwordx4 v85, s[4:7], s48 offen offset:1024 lds
    s_add_u32 s48, s48, 128
    s_mul_i32 s49, s46, s68
    s_lshl3_add_u32 s49, s49, s85
    s_lshl_b32 s84, s68, 6
    v_and_b32 v22, 16, v0
    v_lshlrev_b32 v22, 2, v22
    s_lshl_b32 s73, s46, 5
    v_and_or_b32 v22, s73, 32, v22
    v_xor_b32 v28, v21, v22
    v_mad_u32_u24 v4, v20, s68, v28
    v_xor_b32 v5, s63, v4
    s_add_u32 m0, s50, 0
    s_nop 0
    buffer_load_dwordx4 v4, s[36:39], s49 offen lds
    s_add_u32 m0, s50, 1024
    s_nop 0
    buffer_load_dwordx4 v5, s[64:67], s49 offen lds
    s_add_u32 s49, s49, s84
    s_load_dwordx2 s[12:13], s[0:1], 32
    s_load_dwordx2 s[16:17], s[0:1], 40
    s_mov_b32 s10, 2457600
    s_mov_b32 s11, 0x20000
    s_mov_b32 s14, 1966080
    s_mov_b32 s15, 0x20000
    s_mov_b32 s18, 1966080
    s_mov_b32 s19, 0x20000
    s_cmp_lt_u32 s45, 14
    s_cselect_b32 s10, s10, 0
    s_mov_b32 s26, 256
    s_mov_b32 s27, 0x20000
    v_lshrrev_b32 v29, 5, v0
    v_bfe_u32 v30, v0, 4, 1
    v_lshl_add_u32 v29, v30, 1, v29
    v_and_b32 v30, 15, v0
    v_lshlrev_b32 v30, 4, v30
    v_lshl_add_u32 v19, v29, 11, v30
    v_lshl_add_u32 v18, v29, 8, v30
    v_lshlrev_b32 v6, 4, v0
    v_add_u32 v7, 4096, v6
    s_add_u32 s76, s45, 16
    s_lshl_b32 s76, s76, 7
    s_and_b32 s59, s45, 3
    s_lshl_b32 s59, s59, 7
    s_add_u32 s77, s77, s59
    s_add_u32 s77, s77, 256
    s_lshl2_add_u32 s59, s44, s47
    s_mul_i32 s59, s59, 98304
    s_add_u32 s59, s59, 9437184
    s_lshl4_add_u32 s55, s85, s59
    s_lshl4_add_u32 s56, s77, s59
    s_mul_i32 s60, s44, 491520
    s_lshl_b32 s59, s47, 9
    s_add_u32 s60, s60, s59
    s_add_u32 s60, s60, 1048576
    s_lshl_b32 s59, s85, 7
    s_add_u32 s57, s60, s59
    s_lshl_b32 s59, s76, 7
    s_add_u32 s3, s60, s59
    s_cmp_lt_u32 s45, 14
    s_cselect_b32 s3, s3, 2130706432
    s_cmp_lt_u32 s45, 10
    s_mov_b32 s54, 0xbf317218
    s_cselect_b32 s54, 0xbe64f92e, s54
    s_lshl_b32 s52, s2, 7
    s_mul_i32 s59, s45, 10240
    s_add_u32 s59, s59, 131072
    s_lshl_b32 s61, s58, 8
    s_add_u32 s79, s59, s61
    s_and_b32 s62, s61, 0
    s_add_u32 s59, s79, s62
    s_and_b32 s61, s44, 1
    s_lshl_b32 s61, s61, 11
    s_add_u32 s75, s59, s61
    s_cmp_eq_u32 s46, 2
    s_cselect_b32 s75, s79, s75
    s_lshl_b32 s59, s46, 12
    s_add_u32 s75, s75, s59
    s_sub_u32 s59, s46, 1
    s_cmp_le_u32 s59, 1
    s_waitcnt lgkmcnt(0)
    s_cbranch_scc0 L_nol
    s_bitcmp1_b32 s44, 0
    s_cselect_b64 s[40:41], s[16:17], s[12:13]
    s_cselect_b32 s62, -1, 0x22222222
    s_cmp_lt_u32 s45, 14
    s_cselect_b32 s62, s62, -1
    s_movk_i32 s61, 3072
    s_cmp_eq_u32 s46, 2
    s_cselect_b64 s[40:41], s[8:9], s[40:41]
    s_cselect_b32 s62, s62, 0x65656565
    s_cselect_b32 s61, 3840, s61
    s_cselect_b32 s60, s76, s77
    s_lshl_b32 s59, s58, 2
    s_lshr_b32 s53, s62, s59
    s_and_b32 s53, s53, 15
    s_mul_i32 s42, s61, 640
    s_mul_i32 s59, s58, 80
    s_mul_i32 s59, s59, s61
    s_add_u32 s74, s59, s60
    s_lshl_b32 s82, s61, 3
    v_mad_u32_u24 v86, v20, s61, v21
L_nol:
    s_cmp_lg_u32 s53, 1
    s_cbranch_scc1 L_ncb1
    buffer_load_dwordx4 v[216:219], v86, s[40:43], s74 offen
    s_add_u32 s74, s74, s82
    buffer_load_dwordx4 v[220:223], v86, s[40:43], s74 offen
    s_add_u32 s74, s74, s82
    buffer_load_dwordx4 v[224:227], v86, s[40:43], s74 offen
    s_add_u32 s74, s74, s82
    buffer_load_dwordx4 v[228:231], v86, s[40:43], s74 offen
    s_add_u32 s74, s74, s82
    buffer_load_dwordx4 v[232:235], v86, s[40:43], s74 offen
    s_add_u32 s74, s74, s82
    buffer_load_dwordx4 v[236:239], v86, s[40:43], s74 offen
    s_add_u32 s74, s74, s82
    buffer_load_dwordx4 v[240:243], v86, s[40:43], s74 offen
    s_add_u32 s74, s74, s82
    buffer_load_dwordx4 v[244:247], v86, s[40:43], s74 offen
    s_add_u32 s74, s74, s82
    buffer_load_dwordx4 v[248:251], v86, s[40:43], s74 offen
    s_add_u32 s74, s74, s82
    buffer_load_dwordx4 v[252:255], v86, s[40:43], s74 offen
L_ncb1:
    v_and_b32 v30, 1, v0
    v_lshlrev_b32 v30, 4, v30
    s_movk_i32 s61, 0x3f80
    v_lshlrev_b32 v30, v30, s61
    s_mov_b32 vcc_lo, 0x30003
    s_mov_b32 vcc_hi, 0x30003
    v_cndmask_b32 v88, 0, v30, vcc
    s_mov_b32 vcc_lo, 0xc000c
    s_mov_b32 vcc_hi, 0xc000c
    v_cndmask_b32 v89, 0, v30, vcc
    s_mov_b32 vcc_lo, 0x300030
    s_mov_b32 vcc_hi, 0x300030
    v_cndmask_b32 v90, 0, v30, vcc
    s_mov_b32 vcc_lo, 0xc000c0
    s_mov_b32 vcc_hi, 0xc000c0
    v_cndmask_b32 v91, 0, v30, vcc
    v_and_b32 v87, 7, v0
    v_lshlrev_b32 v87, 4, v87
    v_bfe_u32 v30, v0, 4, 1
    v_lshl_add_u32 v87, v30, 3, v87
    v_and_b32 v30, 8, v0
    v_lshl_add_u32 v87, v30, 4, v87
    v_and_b32 v30, 32, v0
    v_lshl_add_u32 v87, v30, 24, v87
    s_and_b32 s61, s44, 2
    s_and_b32 s62, s44, 4
    s_lshl2_add_u32 s61, s61, s62
    s_lshl_b32 s61, s61, 3
    v_xor_b32 v87, s61, v87
    v_lshrrev_b32 v24, 4, v0
    v_bfe_u32 v20, v0, 2, 2
    v_and_b32 v21, 3, v0
    v_lshlrev_b32 v21, 3, v21
    v_lshl_add_u32 v21, v20, 7, v21
    v_and_b32 v22, 1, v24
    v_and_or_b32 v22, v20, 2, v22
    v_lshl_add_u32 v21, v22, 5, v21
    v_lshl_add_u32 v1, v24, 11, v21
    v_xor_b32 v2, 32, v1
    v_mul_u32_u24 v3, 1536, v24
    v_sub_u32 v3, 134144, v3
    v_and_b32 v20, 15, v0
    v_bfe_u32 v21, v0, 1, 3
    v_xor_b32 v21, v21, v24
    v_lshlrev_b32 v21, 4, v21
    v_lshl_add_u32 v21, v20, 7, v21
    s_lshl_b32 s58, s47, 12
    s_add_u32 s58, s58, 65536
    v_add_u32 v80, s58, v21
    v_xor_b32 v81, 64, v80
    s_add_u32 m0, s50, 81920
    s_nop 0
    buffer_load_dwordx4 v84, s[4:7], s48 offen lds
    buffer_load_dwordx4 v85, s[4:7], s48 offen offset:1024 lds
    s_add_u32 s48, s48, 128
    s_add_u32 m0, s50, 16384
    s_nop 0
    buffer_load_dwordx4 v4, s[36:39], s49 offen lds
    s_add_u32 m0, s50, 17408
    s_nop 0
    buffer_load_dwordx4 v5, s[64:67], s49 offen lds
    s_add_u32 s49, s49, s84
    s_cmp_lg_u32 s53, 2
    s_cbranch_scc1 L_ncb2
    buffer_load_dwordx4 v[216:219], v86, s[40:43], s74 offen
    s_add_u32 s74, s74, s82
    buffer_load_dwordx4 v[220:223], v86, s[40:43], s74 offen
    s_add_u32 s74, s74, s82
    buffer_load_dwordx4 v[224:227], v86, s[40:43], s74 offen
    s_add_u32 s74, s74, s82
    buffer_load_dwordx4 v[228:231], v86, s[40:43], s74 offen
    s_add_u32 s74, s74, s82
    buffer_load_dwordx4 v[232:235], v86, s[40:43], s74 offen
    s_add_u32 s74, s74, s82
    buffer_load_dwordx4 v[236:239], v86, s[40:43], s74 offen
    s_add_u32 s74, s74, s82
    buffer_load_dwordx4 v[240:243], v86, s[40:43], s74 offen
    s_add_u32 s74, s74, s82
    buffer_load_dwordx4 v[244:247], v86, s[40:43], s74 offen
    s_add_u32 s74, s74, s82
    buffer_load_dwordx4 v[248:251], v86, s[40:43], s74 offen
    s_add_u32 s74, s74, s82
    buffer_load_dwordx4 v[252:255], v86, s[40:43], s74 offen
L_ncb2:
    s_lshl_b32 s61, s44, 6
    s_and_b32 s62, s2, 0xe7
    s_lshl3_add_u32 s62, s62, s46
    s_cmp_lg_u32 s62, 3
    s_cbranch_scc1 L_nodbg
    s_waitcnt vmcnt(8)
    s_cmp_lg_u32 0, 0
    s_cbranch_scc1 L_nf1
    v_mov_b32 v154, 1
    v_mov_b32 v155, 0
    s_mov_b64 exec, 1
    buffer_store_dword v154, v155, s[24:27], s61 offen sc1
    s_mov_b64 exec, -1
L_nf1:
L_nodbg:
    s_branch L_mainA
L_setB:
    s_load_dwordx2 s[12:13], s[0:1], 32
    s_load_dwordx2 s[16:17], s[0:1], 40
    s_load_dwordx2 s[28:29], s[0:1], 48
    s_load_dwordx2 s[32:33], s[0:1], 16
    s_load_dwordx2 s[40:41], s[0:1], 56
    s_mov_b32 s10, 2457600
    s_mov_b32 s11, 0x20000
    s_mov_b32 s14, 1966080
    s_mov_b32 s15, 0x20000
    s_mov_b32 s18, 1966080
    s_mov_b32 s19, 0x20000
    s_mov_b32 s30, 1966080
    s_mov_b32 s31, 0x20000
    s_mov_b32 s34, 819200
    s_mov_b32 s35, 0x20000
    s_cmp_lt_u32 s45, 14
    s_cselect_b32 s10, s10, 0
    s_mov_b32 s22, 25165824
    s_mov_b32 s23, 0x20000
    s_lshl_b32 s74, s58, 4
    s_add_u32 s74, s74, 65536
    v_lshlrev_b32 v238, 3, v238
    v_lshrrev_b32 v24, 4, v0
    v_bfe_u32 v20, v0, 2, 2
    v_and_b32 v21, 3, v0
    v_lshlrev_b32 v21, 3, v21
    v_lshl_add_u32 v21, v20, 7, v21
    v_and_b32 v22, 1, v24
    v_and_or_b32 v22, v20, 2, v22
    v_lshl_add_u32 v21, v22, 5, v21
    v_lshl_add_u32 v1, v24, 11, v21
    v_xor_b32 v1, 64, v1
    v_xor_b32 v2, 32, v1
    v_mul_u32_u24 v3, 1536, v24
    v_sub_u32 v3, 134144, v3
    v_and_b32 v20, 15, v0
    v_bfe_u32 v21, v0, 1, 3
    v_xor_b32 v21, v21, v24
    v_lshlrev_b32 v21, 4, v21
    v_lshl_add_u32 v21, v20, 7, v21
    s_lshl_b32 s58, s47, 12
    s_add_u32 s58, s58, 65536
    v_add_u32 v80, s58, v21
    v_xor_b32 v81, 64, v80
    v_lshrrev_b32 v29, 5, v0
    v_bfe_u32 v30, v0, 4, 1
    v_lshl_add_u32 v29, v30, 1, v29
    v_and_b32 v30, 15, v0
    v_lshlrev_b32 v30, 4, v30
    v_lshl_add_u32 v19, v29, 11, v30
    v_lshl_add_u32 v18, v29, 8, v30
    v_lshlrev_b32 v6, 4, v0
    v_add_u32 v7, 4096, v6
    s_add_u32 s76, s45, 16
    s_lshl_b32 s76, s76, 7
    s_and_b32 s59, s45, 3
    s_lshl_b32 s59, s59, 7
    s_add_u32 s77, s77, s59
    s_add_u32 s77, s77, 256
    s_lshl2_add_u32 s59, s44, s47
    s_mul_i32 s59, s59, 98304
    s_add_u32 s59, s59, 9438208
    s_lshl4_add_u32 s55, s85, s59
    s_lshl4_add_u32 s56, s77, s59
    s_mul_i32 s60, s44, 491520
    s_lshl_b32 s59, s47, 9
    s_add_u32 s60, s60, s59
    s_add_u32 s60, s60, 1056768
    s_lshl_b32 s59, s85, 7
    s_add_u32 s57, s60, s59
    s_lshl_b32 s59, s76, 7
    s_add_u32 s3, s60, s59
    s_cmp_lt_u32 s45, 14
    s_cselect_b32 s3, s3, 2130706432
    s_cmp_lt_u32 s45, 10
    s_mov_b32 s54, 0xbf317218
    s_cselect_b32 s54, 0xbe64f92e, s54
    s_lshl_b32 s52, s2, 7
    s_mul_i32 s59, s2, 52429
    s_lshr_b32 s59, s59, 19
    s_mul_i32 s61, s59, 10
    s_sub_u32 s24, s2, s61
    s_lshl2_add_u32 s60, s59, s47
    s_mul_i32 s51, s60, 10240
    s_lshl_b32 s61, s24, 7
    s_add_u32 s51, s51, s61
    s_mul_i32 s61, s59, 5120
    s_lshl_b32 s62, s47, 8
    s_add_u32 s61, s61, s62
    s_add_u32 s61, s61, 20971520
    s_cmp_lt_u32 s60, 96
    s_cselect_b32 s25, s61, 2130706432
    s_cselect_b32 s51, s51, 2130706432
    s_add_u32 s26, s25, 122880
    s_mul_i32 s59, s60, 52429
    s_lshr_b32 s59, s59, 18
    s_mul_i32 s61, s59, 5
    s_sub_u32 s61, s60, s61
    s_and_b32 s62, s59, 3
    s_lshr_b32 s59, s59, 2
    s_mul_i32 s59, s59, 5
    s_cmp_gt_u32 s61, 2
    s_subb_u32 s63, s61, 0
    s_cmp_eq_u32 s61, 2
    s_cselect_b32 s63, s62, s63
    s_cselect_b32 s62, 4, s62
    s_add_u32 s59, s59, s62
    s_mul_i32 s59, s59, 5120
    s_lshl_b32 s63, s63, 8
    s_add_u32 s59, s59, s63
    s_add_u32 s59, s59, 21217280
    s_cmp_lt_u32 s60, 80
    s_cselect_b32 s27, s59, 2130706432
    s_bfe_u32 s53, s2, 0x10004
    s_waitcnt lgkmcnt(0)
    buffer_load_dwordx4 v[220:223], v236, s[4:7], s75 offen offset:512
    buffer_load_dwordx2 v[224:225], v237, s[4:7], s75 offen offset:1024
    s_add_u32 m0, s50, 81920
    s_nop 0
    buffer_load_dwordx4 v84, s[4:7], s48 offen lds
    buffer_load_dwordx4 v85, s[4:7], s48 offen offset:1024 lds
    s_add_u32 s48, s48, 128
    s_add_u32 m0, s50, 16384
    s_nop 0
    buffer_load_dwordx4 v4, s[36:39], s49 offen lds
    s_add_u32 m0, s50, 17408
    s_nop 0
    buffer_load_dwordx4 v5, s[64:67], s49 offen lds
    s_add_u32 s49, s49, s84
    s_waitcnt vmcnt(6)
    s_barrier
    ds_read_b128 v[96:99], v80 offset:0
    ds_read_b64_tr_b16 v[32:33], v1 offset:0
    ds_read_b128 v[100:103], v80 offset:2048
    ds_read_b64_tr_b16 v[34:35], v1 offset:512
    ds_read_b64_tr_b16 v[36:37], v2 offset:0
    ds_read_b64_tr_b16 v[38:39], v2 offset:512
    ds_read_b64_tr_b16 v[40:41], v1 offset:1024
    ds_read_b64_tr_b16 v[42:43], v1 offset:1536
    s_waitcnt lgkmcnt(4)
    v_mfma_f32_16x16x32_bf16 v[48:51], v[32:35], v[96:99], 0
    ds_read_b64_tr_b16 v[44:45], v2 offset:1024
    s_add_u32 m0, s50, 98304
    s_nop 0
    buffer_load_dwordx4 v84, s[4:7], s48 offen lds
    v_mfma_f32_16x16x32_bf16 v[64:67], v[32:35], v[100:103], 0
    ds_read_b64_tr_b16 v[46:47], v2 offset:1536
    s_waitcnt lgkmcnt(4)
    v_mfma_f32_16x16x32_bf16 v[52:55], v[36:39], v[96:99], 0
    ds_read_b128 v[104:107], v81 offset:0
    ds_read_b64_tr_b16 v[32:33], v1 offset:8192
    buffer_load_dwordx4 v85, s[4:7], s48 offen offset:1024 lds
    v_mfma_f32_16x16x32_bf16 v[68:71], v[36:39], v[100:103], 0
    ds_read_b128 v[108:111], v81 offset:2048
    ds_read_b64_tr_b16 v[34:35], v1 offset:8704
    s_waitcnt lgkmcnt(6)
    v_mfma_f32_16x16x32_bf16 v[56:59], v[40:43], v[96:99], 0
    ds_read_b64_tr_b16 v[36:37], v2 offset:8192
    s_add_u32 s48, s48, 128
    s_add_u32 m0, s50, 32768
    v_mfma_f32_16x16x32_bf16 v[72:75], v[40:43], v[100:103], 0
    ds_read_b64_tr_b16 v[38:39], v2 offset:8704
    buffer_load_dwordx4 v4, s[36:39], s49 offen lds
    s_waitcnt lgkmcnt(6)
    v_mfma_f32_16x16x32_bf16 v[60:63], v[44:47], v[96:99], 0
    ds_read_b64_tr_b16 v[40:41], v1 offset:9216
    v_mfma_f32_16x16x32_bf16 v[76:79], v[44:47], v[100:103], 0
    ds_read_b64_tr_b16 v[42:43], v1 offset:9728
    s_add_u32 m0, s50, 33792
    s_nop 0
    buffer_load_dwordx4 v5, s[64:67], s49 offen lds
    s_waitcnt lgkmcnt(4)
    v_mfma_f32_16x16x32_bf16 v[48:51], v[32:35], v[104:107], v[48:51]
    ds_read_b64_tr_b16 v[44:45], v2 offset:9216
    v_mfma_f32_16x16x32_bf16 v[64:67], v[32:35], v[108:111], v[64:67]
    ds_read_b64_tr_b16 v[46:47], v2 offset:9728
    s_add_u32 s49, s49, s84
    s_waitcnt lgkmcnt(4)
    v_mfma_f32_16x16x32_bf16 v[52:55], v[36:39], v[104:107], v[52:55]
    v_mfma_f32_16x16x32_bf16 v[68:71], v[36:39], v[108:111], v[68:71]
    s_waitcnt vmcnt(4)
    s_barrier
    ds_read_b128 v[112:115], v80 offset:16384
    ds_read_b64_tr_b16 v[32:33], v1 offset:16384
    ds_read_b128 v[116:119], v80 offset:18432
    ds_read_b64_tr_b16 v[34:35], v1 offset:16896
    s_add_u32 m0, s50, 114688
    s_nop 0
    buffer_load_dwordx4 v84, s[4:7], s48 offen lds
    s_waitcnt lgkmcnt(6)
    v_mfma_f32_16x16x32_bf16 v[56:59], v[40:43], v[104:107], v[56:59]
    ds_read_b64_tr_b16 v[36:37], v2 offset:16384
    v_mfma_f32_16x16x32_bf16 v[72:75], v[40:43], v[108:111], v[72:75]
    ds_read_b64_tr_b16 v[38:39], v2 offset:16896
    s_waitcnt lgkmcnt(6)
    v_mfma_f32_16x16x32_bf16 v[60:63], v[44:47], v[104:107], v[60:63]
    ds_read_b64_tr_b16 v[40:41], v1 offset:17408
    buffer_load_dwordx4 v85, s[4:7], s48 offen offset:1024 lds
    v_mfma_f32_16x16x32_bf16 v[76:79], v[44:47], v[108:111], v[76:79]
    ds_read_b64_tr_b16 v[42:43], v1 offset:17920
    s_waitcnt lgkmcnt(4)
    v_mfma_f32_16x16x32_bf16 v[48:51], v[32:35], v[112:115], v[48:51]
    ds_read_b64_tr_b16 v[44:45], v2 offset:17408
    v_mfma_f32_16x16x32_bf16 v[64:67], v[32:35], v[116:119], v[64:67]
    ds_read_b64_tr_b16 v[46:47], v2 offset:17920
    s_add_u32 s48, s48, 128
    s_waitcnt lgkmcnt(4)
    v_mfma_f32_16x16x32_bf16 v[52:55], v[36:39], v[112:115], v[52:55]
    ds_read_b128 v[120:123], v81 offset:16384
    ds_read_b64_tr_b16 v[32:33], v1 offset:24576
    s_add_u32 m0, s50, 49152
    v_mfma_f32_16x16x32_bf16 v[68:71], v[36:39], v[116:119], v[68:71]
    ds_read_b128 v[124:127], v81 offset:18432
    ds_read_b64_tr_b16 v[34:35], v1 offset:25088
    buffer_load_dwordx4 v4, s[36:39], s49 offen lds
    s_waitcnt lgkmcnt(6)
    v_mfma_f32_16x16x32_bf16 v[56:59], v[40:43], v[112:115], v[56:59]
    ds_read_b64_tr_b16 v[36:37], v2 offset:24576
    v_mfma_f32_16x16x32_bf16 v[72:75], v[40:43], v[116:119], v[72:75]
    ds_read_b64_tr_b16 v[38:39], v2 offset:25088
    s_waitcnt lgkmcnt(6)
    v_mfma_f32_16x16x32_bf16 v[60:63], v[44:47], v[112:115], v[60:63]
    ds_read_b64_tr_b16 v[40:41], v1 offset:25600
    s_add_u32 m0, s50, 50176
    v_mfma_f32_16x16x32_bf16 v[76:79], v[44:47], v[116:119], v[76:79]
    ds_read_b64_tr_b16 v[42:43], v1 offset:26112
    buffer_load_dwordx4 v5, s[64:67], s49 offen lds
    s_waitcnt lgkmcnt(4)
    v_mfma_f32_16x16x32_bf16 v[48:51], v[32:35], v[120:123], v[48:51]
    ds_read_b64_tr_b16 v[44:45], v2 offset:25600
    v_mfma_f32_16x16x32_bf16 v[64:67], v[32:35], v[124:127], v[64:67]
    ds_read_b64_tr_b16 v[46:47], v2 offset:26112
    s_waitcnt lgkmcnt(4)
    v_mfma_f32_16x16x32_bf16 v[52:55], v[36:39], v[120:123], v[52:55]
    s_add_u32 s49, s49, s84
    v_mfma_f32_16x16x32_bf16 v[68:71], v[36:39], v[124:127], v[68:71]
    s_waitcnt vmcnt(4)
    s_barrier
    ds_read_b128 v[128:131], v80 offset:32768
    ds_read_b64_tr_b16 v[32:33], v1 offset:32768
    ds_read_b128 v[132:135], v80 offset:34816
    ds_read_b64_tr_b16 v[34:35], v1 offset:33280
    s_add_u32 m0, s50, 65536
    s_nop 0
    buffer_load_dwordx4 v84, s[4:7], s48 offen lds
    buffer_load_dwordx4 v85, s[4:7], s48 offen offset:1024 lds
    s_add_u32 s48, s48, 128
    s_waitcnt lgkmcnt(6)
    v_mfma_f32_16x16x32_bf16 v[56:59], v[40:43], v[120:123], v[56:59]
    ds_read_b64_tr_b16 v[36:37], v2 offset:32768
    s_add_u32 m0, s50, 0
    s_nop 0
    buffer_load_dwordx4 v4, s[36:39], s49 offen lds
    s_add_u32 m0, s50, 1024
    s_nop 0
    buffer_load_dwordx4 v5, s[64:67], s49 offen lds
    v_mfma_f32_16x16x32_bf16 v[72:75], v[40:43], v[124:127], v[72:75]
    ds_read_b64_tr_b16 v[38:39], v2 offset:33280
    s_add_u32 s49, s49, s84
    v_mov_b32 v226, 0
    v_mov_b32 v227, 0
    s_mov_b32 s60, 0x3f803f80
    v_dot2c_f32_bf16 v226, s60, v216
    v_dot2c_f32_bf16 v227, v216, v216
    s_waitcnt lgkmcnt(6)
    v_mfma_f32_16x16x32_bf16 v[60:63], v[44:47], v[120:123], v[60:63]
    ds_read_b64_tr_b16 v[40:41], v1 offset:33792
    v_dot2c_f32_bf16 v226, s60, v217
    v_dot2c_f32_bf16 v227, v217, v217
    v_dot2c_f32_bf16 v226, s60, v218
    v_dot2c_f32_bf16 v227, v218, v218
    v_mfma_f32_16x16x32_bf16 v[76:79], v[44:47], v[124:127], v[76:79]
    ds_read_b64_tr_b16 v[42:43], v1 offset:34304
    v_dot2c_f32_bf16 v226, s60, v219
    v_dot2c_f32_bf16 v227, v219, v219
    v_dot2c_f32_bf16 v226, s60, v220
    v_dot2c_f32_bf16 v227, v220, v220
    v_dot2c_f32_bf16 v226, s60, v221
    s_waitcnt lgkmcnt(4)
    v_mfma_f32_16x16x32_bf16 v[48:51], v[32:35], v[128:131], v[48:51]
    ds_read_b64_tr_b16 v[44:45], v2 offset:33792
    v_dot2c_f32_bf16 v227, v221, v221
    v_dot2c_f32_bf16 v226, s60, v222
    v_dot2c_f32_bf16 v227, v222, v222
    v_dot2c_f32_bf16 v226, s60, v223
    v_dot2c_f32_bf16 v227, v223, v223
    v_mfma_f32_16x16x32_bf16 v[64:67], v[32:35], v[132:135], v[64:67]
    ds_read_b64_tr_b16 v[46:47], v2 offset:34304
    v_dot2c_f32_bf16 v226, s60, v224
    v_dot2c_f32_bf16 v227, v224, v224
    v_dot2c_f32_bf16 v226, s60, v225
    v_dot2c_f32_bf16 v227, v225, v225
    s_nop 2
    s_waitcnt lgkmcnt(4)
    v_mfma_f32_16x16x32_bf16 v[52:55], v[36:39], v[128:131], v[52:55]
    ds_read_b128 v[136:139], v81 offset:32768
    ds_read_b64_tr_b16 v[32:33], v1 offset:40960
    v_add_f32_dpp v226, v226, v226 quad_perm:[1,0,3,2] row_mask:0xf bank_mask:0xf
    v_add_f32_dpp v227, v227, v227 quad_perm:[1,0,3,2] row_mask:0xf bank_mask:0xf
    s_nop 0
    v_add_f32_dpp v226, v226, v226 quad_perm:[2,3,0,1] row_mask:0xf bank_mask:0xf
    v_add_f32_dpp v227, v227, v227 quad_perm:[2,3,0,1] row_mask:0xf bank_mask:0xf
    s_nop 0
    v_add_f32_dpp v226, v226, v226 row_half_mirror row_mask:0xf bank_mask:0xf
    v_mfma_f32_16x16x32_bf16 v[68:71], v[36:39], v[132:135], v[68:71]
    ds_read_b128 v[140:143], v81 offset:34816
    ds_read_b64_tr_b16 v[34:35], v1 offset:41472
    v_add_f32_dpp v227, v227, v227 row_half_mirror row_mask:0xf bank_mask:0xf
    v_add_f32_dpp v226, v226, v226 row_mirror row_mask:0xf bank_mask:0xf
    s_nop 0
    v_add_f32_dpp v227, v227, v227 row_mirror row_mask:0xf bank_mask:0xf
    v_mov_b32 v216, v226
    s_waitcnt lgkmcnt(6)
    v_mfma_f32_16x16x32_bf16 v[56:59], v[40:43], v[128:131], v[56:59]
    ds_read_b64_tr_b16 v[36:37], v2 offset:40960
    v_mov_b32 v217, v227
    v_permlane16_swap_b32 v226, v216
    s_nop 0
    v_permlane16_swap_b32 v227, v217
    v_add_f32 v226, v226, v216
    v_add_f32 v227, v227, v217
    v_mfma_f32_16x16x32_bf16 v[72:75], v[40:43], v[132:135], v[72:75]
    ds_read_b64_tr_b16 v[38:39], v2 offset:41472
    v_mul_f32 v228, 0xbacccccd, v226
    v_mul_f32 v227, 0x3acccccd, v227
    v_fma_f32 v227, -v228, v228, v227
    v_max_f32 v227, 0, v227
    v_add_f32 v229, 0x3727c5ac, v227
    s_waitcnt lgkmcnt(6)
    v_mfma_f32_16x16x32_bf16 v[60:63], v[44:47], v[128:131], v[60:63]
    ds_read_b64_tr_b16 v[40:41], v1 offset:41984
    v_cvt_pk_bf16_f32 v228, v228, v228
    s_mov_b32 exec_lo, 1
    s_mov_b32 exec_hi, 1
    buffer_store_dwordx2 v[228:229], v238, s[20:23], s74 offen sc1
    s_mov_b64 exec, -1
    v_mfma_f32_16x16x32_bf16 v[76:79], v[44:47], v[132:135], v[76:79]
    ds_read_b64_tr_b16 v[42:43], v1 offset:42496
    s_lshl_b32 s59, s24, 1
    v_lshrrev_b32 v24, 5, v0
    v_add_u32 v24, s59, v24
    v_mul_u32_u24 v25, 52, v24
    v_lshrrev_b32 v25, 8, v25
    s_waitcnt lgkmcnt(4)
    v_mfma_f32_16x16x32_bf16 v[48:51], v[32:35], v[136:139], v[48:51]
    ds_read_b64_tr_b16 v[44:45], v2 offset:41984
    v_mul_u32_u24 v8, 5, v25
    v_sub_u32 v24, v24, v8
    v_bfe_u32 v20, v0, 4, 1
    v_lshl_add_u32 v21, v24, 1, v20
    v_cmp_lt_u32 vcc, 4, v21
    v_mfma_f32_16x16x32_bf16 v[64:67], v[32:35], v[140:143], v[64:67]
    ds_read_b64_tr_b16 v[46:47], v2 offset:42496
    v_mul_u32_u24 v25, 680, v25
    v_add_u32 v9, 334, v21
    v_cndmask_b32 v9, v21, v9, vcc
    v_cmp_eq_u32 vcc, 5, v21
    v_mov_b32 v22, 344
    s_waitcnt lgkmcnt(4)
    v_mfma_f32_16x16x32_bf16 v[52:55], v[36:39], v[136:139], v[52:55]
    v_and_b32 v23, 15, v0
    v_cndmask_b32 v9, v9, v22, vcc
    v_add_lshl_u32 v9, v9, v25, 10
    v_lshl_add_u32 v9, v23, 4, v9
    v_mfma_f32_16x16x32_bf16 v[68:71], v[36:39], v[140:143], v[68:71]
    s_waitcnt vmcnt(5)
    s_barrier
    ds_read_b128 v[144:147], v80 offset:49152
    ds_read_b64_tr_b16 v[32:33], v1 offset:49152
    ds_read_b128 v[148:151], v80 offset:51200
    ds_read_b64_tr_b16 v[34:35], v1 offset:49664
    s_add_u32 m0, s50, 81920
    s_nop 0
    buffer_load_dwordx4 v84, s[4:7], s48 offen lds
    s_waitcnt lgkmcnt(6)
    v_mfma_f32_16x16x32_bf16 v[56:59], v[40:43], v[136:139], v[56:59]
    ds_read_b64_tr_b16 v[36:37], v2 offset:49152
    buffer_load_dwordx4 v85, s[4:7], s48 offen offset:1024 lds
    v_mfma_f32_16x16x32_bf16 v[72:75], v[40:43], v[140:143], v[72:75]
    ds_read_b64_tr_b16 v[38:39], v2 offset:49664
    s_waitcnt lgkmcnt(6)
    v_mfma_f32_16x16x32_bf16 v[60:63], v[44:47], v[136:139], v[60:63]
    ds_read_b64_tr_b16 v[40:41], v1 offset:50176
    s_add_u32 s48, s48, 128
    s_add_u32 m0, s50, 16384
    s_nop 0
    buffer_load_dwordx4 v4, s[36:39], s49 offen lds
    v_mfma_f32_16x16x32_bf16 v[76:79], v[44:47], v[140:143], v[76:79]
    ds_read_b64_tr_b16 v[42:43], v1 offset:50688
    s_waitcnt lgkmcnt(4)
    v_mfma_f32_16x16x32_bf16 v[48:51], v[32:35], v[144:147], v[48:51]
    ds_read_b64_tr_b16 v[44:45], v2 offset:50176
    s_add_u32 m0, s50, 17408
    s_nop 0
    buffer_load_dwordx4 v5, s[64:67], s49 offen lds
    v_mfma_f32_16x16x32_bf16 v[64:67], v[32:35], v[148:151], v[64:67]
    ds_read_b64_tr_b16 v[46:47], v2 offset:50688
    s_add_u32 s49, s49, s84
    s_waitcnt lgkmcnt(4)
    v_mfma_f32_16x16x32_bf16 v[52:55], v[36:39], v[144:147], v[52:55]
    ds_read_b128 v[152:155], v81 offset:49152
    ds_read_b64_tr_b16 v[32:33], v1 offset:57344
    v_and_b32 v21, 3, v0
    v_lshlrev_b32 v22, 4, v21
    v_mfma_f32_16x16x32_bf16 v[68:71], v[36:39], v[148:151], v[68:71]
    ds_read_b128 v[156:159], v81 offset:51200
    ds_read_b64_tr_b16 v[34:35], v1 offset:57856
    v_lshl_add_u32 v22, v20, 3, v22
    s_waitcnt lgkmcnt(6)
    v_mfma_f32_16x16x32_bf16 v[56:59], v[40:43], v[144:147], v[56:59]
    ds_read_b64_tr_b16 v[36:37], v2 offset:57344
    v_cmp_eq_u32 vcc, 2, v24
    v_lshlrev_b32 v21, 3, v21
    v_mfma_f32_16x16x32_bf16 v[72:75], v[40:43], v[148:151], v[72:75]
    ds_read_b64_tr_b16 v[38:39], v2 offset:57856
    v_lshl_add_u32 v21, v20, 5, v21
    s_waitcnt lgkmcnt(6)
    v_mfma_f32_16x16x32_bf16 v[60:63], v[44:47], v[144:147], v[60:63]
    ds_read_b64_tr_b16 v[40:41], v1 offset:58368
    v_cndmask_b32 v8, v22, v21, vcc
    v_bfe_u32 v24, v0, 2, 2
    v_mfma_f32_16x16x32_bf16 v[76:79], v[44:47], v[148:151], v[76:79]
    ds_read_b64_tr_b16 v[42:43], v1 offset:58880
    v_lshl_add_u32 v8, v24, 7, v8
    s_waitcnt lgkmcnt(4)
    v_mfma_f32_16x16x32_bf16 v[48:51], v[32:35], v[152:155], v[48:51]
    ds_read_b64_tr_b16 v[44:45], v2 offset:58368
    v_lshrrev_b32 v24, 5, v0
    v_lshl_add_u32 v8, v24, 6, v8
    v_mfma_f32_16x16x32_bf16 v[64:67], v[32:35], v[156:159], v[64:67]
    ds_read_b64_tr_b16 v[46:47], v2 offset:58880
    s_mul_i32 s59, s47, 3072
    s_add_u32 s59, s59, 144384
    s_waitcnt lgkmcnt(4)
    v_mfma_f32_16x16x32_bf16 v[52:55], v[36:39], v[152:155], v[52:55]
    v_add_u32 v8, s59, v8
    v_mfma_f32_16x16x32_bf16 v[68:71], v[36:39], v[156:159], v[68:71]
    s_waitcnt vmcnt(4)
    s_barrier
    s_cmp_lg_u32 s47, 0
    s_cbranch_scc1 L_nf2
    v_mov_b32 v30, 1
    v_mov_b32 v31, 0
    s_mov_b64 exec, 1
    buffer_store_dword v30, v31, s[20:23], s52 offen sc1
    s_mov_b64 exec, -1
L_nf2:
    ds_read_b128 v[160:163], v80 offset:0
    ds_read_b64_tr_b16 v[32:33], v1 offset:0
    ds_read_b128 v[164:167], v80 offset:2048
    ds_read_b64_tr_b16 v[34:35], v1 offset:512
    s_cmp_lg_u32 s53, 0
    s_cbranch_scc1 L_npk0
    v_lshrrev_b32 v30, 3, v0
    v_mul_u32_u24 v30, 1280, v30
    v_and_b32 v31, 0x70, v6
    v_add_u32 v30, v30, v31
    s_mul_i32 s60, s47, 3072
    s_add_u32 m0, s60, 144384
    s_add_u32 s59, s51, 982016
    buffer_load_dwordx4 v30, s[28:31], s51 offen nt lds
    buffer_load_dwordx4 v30, s[28:31], s59 offen offset:1024 nt lds
    s_add_u32 m0, s60, 146432
    s_nop 0
    buffer_load_dwordx4 v30, s[32:35], s51 offen nt lds
L_npk0:
    s_waitcnt lgkmcnt(6)
    v_mfma_f32_16x16x32_bf16 v[56:59], v[40:43], v[152:155], v[56:59]
    ds_read_b64_tr_b16 v[36:37], v2 offset:0
    v_mfma_f32_16x16x32_bf16 v[72:75], v[40:43], v[156:159], v[72:75]
    ds_read_b64_tr_b16 v[38:39], v2 offset:512
    s_waitcnt lgkmcnt(6)
    v_mfma_f32_16x16x32_bf16 v[60:63], v[44:47], v[152:155], v[60:63]
    ds_read_b64_tr_b16 v[40:41], v1 offset:1024
    v_mfma_f32_16x16x32_bf16 v[76:79], v[44:47], v[156:159], v[76:79]
    ds_read_b64_tr_b16 v[42:43], v1 offset:1536
    s_waitcnt lgkmcnt(4)
    v_mfma_f32_16x16x32_bf16 v[48:51], v[32:35], v[160:163], v[48:51]
    ds_read_b64_tr_b16 v[44:45], v2 offset:1024
    v_mfma_f32_16x16x32_bf16 v[64:67], v[32:35], v[164:167], v[64:67]
    ds_read_b64_tr_b16 v[46:47], v2 offset:1536
    s_waitcnt lgkmcnt(4)
    v_mfma_f32_16x16x32_bf16 v[52:55], v[36:39], v[160:163], v[52:55]
    ds_read_b128 v[168:171], v81 offset:0
    ds_read_b64_tr_b16 v[32:33], v1 offset:8192
    v_mfma_f32_16x16x32_bf16 v[68:71], v[36:39], v[164:167], v[68:71]
    ds_read_b128 v[172:175], v81 offset:2048
    ds_read_b64_tr_b16 v[34:35], v1 offset:8704
    s_add_u32 m0, s50, 98304
    s_waitcnt lgkmcnt(6)
    v_mfma_f32_16x16x32_bf16 v[56:59], v[40:43], v[160:163], v[56:59]
    ds_read_b64_tr_b16 v[36:37], v2 offset:8192
    buffer_load_dwordx4 v84, s[4:7], s48 offen lds
    v_mfma_f32_16x16x32_bf16 v[72:75], v[40:43], v[164:167], v[72:75]
    ds_read_b64_tr_b16 v[38:39], v2 offset:8704
    buffer_load_dwordx4 v85, s[4:7], s48 offen offset:1024 lds
    s_waitcnt lgkmcnt(6)
    v_mfma_f32_16x16x32_bf16 v[60:63], v[44:47], v[160:163], v[60:63]
    ds_read_b64_tr_b16 v[40:41], v1 offset:9216
    s_add_u32 s48, s48, 128
    v_mfma_f32_16x16x32_bf16 v[76:79], v[44:47], v[164:167], v[76:79]
    ds_read_b64_tr_b16 v[42:43], v1 offset:9728
    s_add_u32 m0, s50, 32768
    s_nop 0
    buffer_load_dwordx4 v4, s[36:39], s49 offen lds
    s_waitcnt lgkmcnt(4)
    v_mfma_f32_16x16x32_bf16 v[48:51], v[32:35], v[168:171], v[48:51]
    ds_read_b64_tr_b16 v[44:45], v2 offset:9216
    s_add_u32 m0, s50, 33792
    v_mfma_f32_16x16x32_bf16 v[64:67], v[32:35], v[172:175], v[64:67]
    ds_read_b64_tr_b16 v[46:47], v2 offset:9728
    buffer_load_dwordx4 v5, s[64:67], s49 offen lds
    s_waitcnt lgkmcnt(4)
    v_mfma_f32_16x16x32_bf16 v[52:55], v[36:39], v[168:171], v[52:55]
    s_add_u32 s49, s49, s84
    v_mfma_f32_16x16x32_bf16 v[68:71], v[36:39], v[172:175], v[68:71]
    s_waitcnt vmcnt(7)
    s_sub_u32 s73, s53, 0
    s_cmp_le_u32 s73, 0
    s_cbranch_scc1 L_cw1
    s_waitcnt vmcnt(4)
L_cw1:
    s_barrier
    ds_read_b128 v[176:179], v80 offset:16384
    ds_read_b64_tr_b16 v[32:33], v1 offset:16384
    ds_read_b128 v[180:183], v80 offset:18432
    ds_read_b64_tr_b16 v[34:35], v1 offset:16896
    s_cmp_lg_u32 s53, 1
    s_cbranch_scc1 L_npk1
    v_lshrrev_b32 v30, 3, v0
    v_mul_u32_u24 v30, 1280, v30
    v_and_b32 v31, 0x70, v6
    v_add_u32 v30, v30, v31
    s_mul_i32 s60, s47, 3072
    s_add_u32 m0, s60, 144384
    s_add_u32 s59, s51, 982016
    buffer_load_dwordx4 v30, s[28:31], s51 offen nt lds
    buffer_load_dwordx4 v30, s[28:31], s59 offen offset:1024 nt lds
    s_add_u32 m0, s60, 146432
    s_nop 0
    buffer_load_dwordx4 v30, s[32:35], s51 offen nt lds
L_npk1:
    s_waitcnt lgkmcnt(6)
    v_mfma_f32_16x16x32_bf16 v[56:59], v[40:43], v[168:171], v[56:59]
    ds_read_b64_tr_b16 v[36:37], v2 offset:16384
    v_mfma_f32_16x16x32_bf16 v[72:75], v[40:43], v[172:175], v[72:75]
    ds_read_b64_tr_b16 v[38:39], v2 offset:16896
    s_waitcnt lgkmcnt(6)
    v_mfma_f32_16x16x32_bf16 v[60:63], v[44:47], v[168:171], v[60:63]
    ds_read_b64_tr_b16 v[40:41], v1 offset:17408
    v_mfma_f32_16x16x32_bf16 v[76:79], v[44:47], v[172:175], v[76:79]
    ds_read_b64_tr_b16 v[42:43], v1 offset:17920
    s_waitcnt lgkmcnt(4)
    v_mfma_f32_16x16x32_bf16 v[48:51], v[32:35], v[176:179], v[48:51]
    ds_read_b64_tr_b16 v[44:45], v2 offset:17408
    v_mfma_f32_16x16x32_bf16 v[64:67], v[32:35], v[180:183], v[64:67]
    ds_read_b64_tr_b16 v[46:47], v2 offset:17920
    s_waitcnt lgkmcnt(4)
    v_mfma_f32_16x16x32_bf16 v[52:55], v[36:39], v[176:179], v[52:55]
    ds_read_b128 v[184:187], v81 offset:16384
    ds_read_b64_tr_b16 v[32:33], v1 offset:24576
    v_mfma_f32_16x16x32_bf16 v[68:71], v[36:39], v[180:183], v[68:71]
    ds_read_b128 v[188:191], v81 offset:18432
    ds_read_b64_tr_b16 v[34:35], v1 offset:25088
    s_add_u32 m0, s50, 114688
    s_waitcnt lgkmcnt(6)
    v_mfma_f32_16x16x32_bf16 v[56:59], v[40:43], v[176:179], v[56:59]
    ds_read_b64_tr_b16 v[36:37], v2 offset:24576
    buffer_load_dwordx4 v84, s[4:7], s48 offen lds
    v_mfma_f32_16x16x32_bf16 v[72:75], v[40:43], v[180:183], v[72:75]
    ds_read_b64_tr_b16 v[38:39], v2 offset:25088
    buffer_load_dwordx4 v85, s[4:7], s48 offen offset:1024 lds
    s_waitcnt lgkmcnt(6)
    v_mfma_f32_16x16x32_bf16 v[60:63], v[44:47], v[176:179], v[60:63]
    ds_read_b64_tr_b16 v[40:41], v1 offset:25600
    s_add_u32 s48, s48, 128
    v_mfma_f32_16x16x32_bf16 v[76:79], v[44:47], v[180:183], v[76:79]
    ds_read_b64_tr_b16 v[42:43], v1 offset:26112
    s_add_u32 m0, s50, 49152
    s_nop 0
    buffer_load_dwordx4 v4, s[36:39], s49 offen lds
    s_waitcnt lgkmcnt(4)
    v_mfma_f32_16x16x32_bf16 v[48:51], v[32:35], v[184:187], v[48:51]
    ds_read_b64_tr_b16 v[44:45], v2 offset:25600
    s_add_u32 m0, s50, 50176
    v_mfma_f32_16x16x32_bf16 v[64:67], v[32:35], v[188:191], v[64:67]
    ds_read_b64_tr_b16 v[46:47], v2 offset:26112
    buffer_load_dwordx4 v5, s[64:67], s49 offen lds
    s_waitcnt lgkmcnt(4)
    v_mfma_f32_16x16x32_bf16 v[52:55], v[36:39], v[184:187], v[52:55]
    s_add_u32 s49, s49, s84
    v_mfma_f32_16x16x32_bf16 v[68:71], v[36:39], v[188:191], v[68:71]
    s_waitcnt vmcnt(7)
    s_sub_u32 s73, s53, 1
    s_cmp_le_u32 s73, 0
    s_cbranch_scc1 L_cw2
    s_waitcnt vmcnt(4)
L_cw2:
    s_barrier
    ds_read_b128 v[192:195], v80 offset:32768
    ds_read_b64_tr_b16 v[32:33], v1 offset:32768
    ds_read_b128 v[196:199], v80 offset:34816
    ds_read_b64_tr_b16 v[34:35], v1 offset:33280
    s_add_u32 m0, s50, 65536
    s_nop 0
    buffer_load_dwordx4 v84, s[4:7], s48 offen lds
    s_waitcnt lgkmcnt(6)
    v_mfma_f32_16x16x32_bf16 v[56:59], v[40:43], v[184:187], v[56:59]
    ds_read_b64_tr_b16 v[36:37], v2 offset:32768
    v_mfma_f32_16x16x32_bf16 v[72:75], v[40:43], v[188:191], v[72:75]
    ds_read_b64_tr_b16 v[38:39], v2 offset:33280
    s_waitcnt lgkmcnt(6)
    v_mfma_f32_16x16x32_bf16 v[60:63], v[44:47], v[184:187], v[60:63]
    ds_read_b64_tr_b16 v[40:41], v1 offset:33792
    buffer_load_dwordx4 v85, s[4:7], s48 offen offset:1024 lds
    v_mfma_f32_16x16x32_bf16 v[76:79], v[44:47], v[188:191], v[76:79]
    ds_read_b64_tr_b16 v[42:43], v1 offset:34304
    s_waitcnt lgkmcnt(4)
    v_mfma_f32_16x16x32_bf16 v[48:51], v[32:35], v[192:195], v[48:51]
    ds_read_b64_tr_b16 v[44:45], v2 offset:33792
    v_mfma_f32_16x16x32_bf16 v[64:67], v[32:35], v[196:199], v[64:67]
    ds_read_b64_tr_b16 v[46:47], v2 offset:34304
    s_add_u32 s48, s48, 128
    s_waitcnt lgkmcnt(4)
    v_mfma_f32_16x16x32_bf16 v[52:55], v[36:39], v[192:195], v[52:55]
    ds_read_b128 v[200:203], v81 offset:32768
    ds_read_b64_tr_b16 v[32:33], v1 offset:40960
    s_add_u32 m0, s50, 0
    v_mfma_f32_16x16x32_bf16 v[68:71], v[36:39], v[196:199], v[68:71]
    ds_read_b128 v[204:207], v81 offset:34816
    ds_read_b64_tr_b16 v[34:35], v1 offset:41472
    buffer_load_dwordx4 v4, s[36:39], s49 offen lds
    s_waitcnt lgkmcnt(6)
    v_mfma_f32_16x16x32_bf16 v[56:59], v[40:43], v[192:195], v[56:59]
    ds_read_b64_tr_b16 v[36:37], v2 offset:40960
    v_mfma_f32_16x16x32_bf16 v[72:75], v[40:43], v[196:199], v[72:75]
    ds_read_b64_tr_b16 v[38:39], v2 offset:41472
    s_waitcnt lgkmcnt(6)
    v_mfma_f32_16x16x32_bf16 v[60:63], v[44:47], v[192:195], v[60:63]
    ds_read_b64_tr_b16 v[40:41], v1 offset:41984
    s_add_u32 m0, s50, 1024
    v_mfma_f32_16x16x32_bf16 v[76:79], v[44:47], v[196:199], v[76:79]
    ds_read_b64_tr_b16 v[42:43], v1 offset:42496
    buffer_load_dwordx4 v5, s[64:67], s49 offen lds
    s_waitcnt lgkmcnt(4)
    v_mfma_f32_16x16x32_bf16 v[48:51], v[32:35], v[200:203], v[48:51]
    ds_read_b64_tr_b16 v[44:45], v2 offset:41984
    v_mfma_f32_16x16x32_bf16 v[64:67], v[32:35], v[204:207], v[64:67]
    ds_read_b64_tr_b16 v[46:47], v2 offset:42496
    s_waitcnt lgkmcnt(4)
    v_mfma_f32_16x16x32_bf16 v[52:55], v[36:39], v[200:203], v[52:55]
    s_add_u32 s49, s49, s84
    v_mfma_f32_16x16x32_bf16 v[68:71], v[36:39], v[204:207], v[68:71]
    s_waitcnt vmcnt(4)
    s_barrier
    ds_read_b128 v[208:211], v80 offset:49152
    ds_read_b64_tr_b16 v[32:33], v1 offset:49152
    ds_read_b128 v[212:215], v80 offset:51200
    ds_read_b64_tr_b16 v[34:35], v1 offset:49664
    ds_read_b64_tr_b16 v[24:25], v8 offset:0
    s_waitcnt lgkmcnt(7)
    v_mfma_f32_16x16x32_bf16 v[56:59], v[40:43], v[200:203], v[56:59]
    ds_read_b64_tr_b16 v[36:37], v2 offset:49152
    ds_read_b64_tr_b16 v[26:27], v8 offset:512
    v_mfma_f32_16x16x32_bf16 v[72:75], v[40:43], v[204:207], v[72:75]
    ds_read_b64_tr_b16 v[38:39], v2 offset:49664
    s_add_u32 m0, s50, 81920
    s_nop 0
    buffer_load_dwordx4 v84, s[4:7], s48 offen lds
    s_waitcnt lgkmcnt(8)
    v_mfma_f32_16x16x32_bf16 v[60:63], v[44:47], v[200:203], v[60:63]
    ds_read_b64_tr_b16 v[40:41], v1 offset:50176
    v_mfma_f32_16x16x32_bf16 v[76:79], v[44:47], v[204:207], v[76:79]
    ds_read_b64_tr_b16 v[42:43], v1 offset:50688
    buffer_load_dwordx4 v85, s[4:7], s48 offen offset:1024 lds
    s_waitcnt lgkmcnt(6)
    v_mfma_f32_16x16x32_bf16 v[48:51], v[32:35], v[208:211], v[48:51]
    ds_read_b64_tr_b16 v[44:45], v2 offset:50176
    v_mfma_f32_16x16x32_bf16 v[64:67], v[32:35], v[212:215], v[64:67]
    ds_read_b64_tr_b16 v[46:47], v2 offset:50688
    s_add_u32 s48, s48, 128
    s_waitcnt lgkmcnt(4)
    v_mfma_f32_16x16x32_bf16 v[52:55], v[36:39], v[208:211], v[52:55]
    ds_read_b128 v[216:219], v81 offset:49152
    ds_read_b64_tr_b16 v[32:33], v1 offset:57344
    s_add_u32 m0, s50, 16384
    v_mfma_f32_16x16x32_bf16 v[68:71], v[36:39], v[212:215], v[68:71]
    ds_read_b128 v[220:223], v81 offset:51200
    ds_read_b64_tr_b16 v[34:35], v1 offset:57856
    buffer_load_dwordx4 v4, s[36:39], s49 offen lds
    s_waitcnt lgkmcnt(6)
    v_mfma_f32_16x16x32_bf16 v[56:59], v[40:43], v[208:211], v[56:59]
    ds_read_b64_tr_b16 v[36:37], v2 offset:57344
    v_mfma_f32_16x16x32_bf16 v[72:75], v[40:43], v[212:215], v[72:75]
    ds_read_b64_tr_b16 v[38:39], v2 offset:57856
    s_add_u32 m0, s50, 17408
    s_nop 0
    buffer_load_dwordx4 v5, s[64:67], s49 offen lds
    s_waitcnt lgkmcnt(6)
    v_mfma_f32_16x16x32_bf16 v[60:63], v[44:47], v[208:211], v[60:63]
    ds_read_b64_tr_b16 v[40:41], v1 offset:58368
    v_mfma_f32_16x16x32_bf16 v[76:79], v[44:47], v[212:215], v[76:79]
    ds_read_b64_tr_b16 v[42:43], v1 offset:58880
    s_add_u32 s49, s49, s84
    s_waitcnt lgkmcnt(4)
    v_mfma_f32_16x16x32_bf16 v[48:51], v[32:35], v[216:219], v[48:51]
    ds_read_b64_tr_b16 v[44:45], v2 offset:58368
    buffer_store_dwordx4 v[24:27], v9, s[20:23], s25 offen sc1
    v_mfma_f32_16x16x32_bf16 v[64:67], v[32:35], v[220:223], v[64:67]
    ds_read_b64_tr_b16 v[46:47], v2 offset:58880
    s_waitcnt lgkmcnt(4)
    v_mfma_f32_16x16x32_bf16 v[52:55], v[36:39], v[216:219], v[52:55]
    v_mfma_f32_16x16x32_bf16 v[68:71], v[36:39], v[220:223], v[68:71]
    s_waitcnt vmcnt(5)
    s_barrier
    v_lshrrev_b32 v4, 3, v0
    v_mul_u32_u24 v4, 3840, v4
    v_add_u32 v4, v4, v28
    v_add_u32 v5, 244736, v4
    s_mul_i32 s49, s46, 30720
    s_add_u32 s49, s49, s76
    s_add_u32 m0, s50, 32768
    s_nop 0
    buffer_load_dwordx4 v4, s[8:11], s49 offen lds
    buffer_load_dwordx4 v5, s[8:11], s49 offen offset:1024 lds
    s_add_u32 s49, s49, 491520
    ds_read_b128 v[224:227], v80 offset:0
    ds_read_b64_tr_b16 v[32:33], v1 offset:0
    ds_read_b128 v[228:231], v80 offset:2048
    ds_read_b64_tr_b16 v[34:35], v1 offset:512
    ds_read_b64_tr_b16 v[24:25], v8 offset:1024
    ds_read_b64_tr_b16 v[26:27], v8 offset:1536
    s_waitcnt lgkmcnt(8)
    v_mfma_f32_16x16x32_bf16 v[56:59], v[40:43], v[216:219], v[56:59]
    ds_read_b64_tr_b16 v[36:37], v2 offset:0
    s_lshl_b32 s60, s47, 9
    s_add_u32 m0, s60, 142336
    v_mfma_f32_16x16x32_bf16 v[72:75], v[40:43], v[220:223], v[72:75]
    ds_read_b64_tr_b16 v[38:39], v2 offset:512
    s_mul_i32 s59, s45, 10240
    s_add_u32 s59, s59, s60
    s_add_u32 s61, s59, 139264
    s_waitcnt lgkmcnt(8)
    v_mfma_f32_16x16x32_bf16 v[60:63], v[44:47], v[216:219], v[60:63]
    ds_read_b64_tr_b16 v[40:41], v1 offset:1024
    s_cmp_lt_u32 s45, 14
    s_cselect_b32 s61, s61, 2130706432
    v_mfma_f32_16x16x32_bf16 v[76:79], v[44:47], v[220:223], v[76:79]
    ds_read_b64_tr_b16 v[42:43], v1 offset:1536
    s_mov_b32 exec_hi, 0
    buffer_load_dwordx4 v6, s[20:23], s61 offen sc1 lds
    s_mov_b32 exec_hi, -1
    s_waitcnt lgkmcnt(6)
    v_mfma_f32_16x16x32_bf16 v[48:51], v[32:35], v[224:227], v[48:51]
    ds_read_b64_tr_b16 v[44:45], v2 offset:1024
    v_mfma_f32_16x16x32_bf16 v[64:67], v[32:35], v[228:231], v[64:67]
    ds_read_b64_tr_b16 v[46:47], v2 offset:1536
    s_lshl1_add_u32 m0, s60, 134144
    s_add_u32 s59, s59, s60
    s_add_u32 s59, s59, 131072
    s_waitcnt lgkmcnt(4)
    v_mfma_f32_16x16x32_bf16 v[52:55], v[36:39], v[224:227], v[52:55]
    ds_read_b128 v[232:235], v81 offset:0
    ds_read_b64_tr_b16 v[32:33], v1 offset:8192
    buffer_load_dwordx4 v6, s[20:23], s59 offen sc1 lds
    v_mfma_f32_16x16x32_bf16 v[68:71], v[36:39], v[228:231], v[68:71]
    ds_read_b128 v[236:239], v81 offset:2048
    ds_read_b64_tr_b16 v[34:35], v1 offset:8704
    v_and_b32 v30, 15, v0
    s_waitcnt lgkmcnt(6)
    v_mfma_f32_16x16x32_bf16 v[56:59], v[40:43], v[224:227], v[56:59]
    ds_read_b64_tr_b16 v[36:37], v2 offset:8192
    v_lshlrev_b32 v30, 3, v30
    v_mfma_f32_16x16x32_bf16 v[72:75], v[40:43], v[228:231], v[72:75]
    ds_read_b64_tr_b16 v[38:39], v2 offset:8704
    s_lshl2_add_u32 s59, s44, s47
    s_lshl_b32 s59, s59, 8
    s_add_u32 s59, s59, 65536
    s_waitcnt lgkmcnt(6)
    v_mfma_f32_16x16x32_bf16 v[60:63], v[44:47], v[224:227], v[60:63]
    ds_read_b64_tr_b16 v[40:41], v1 offset:9216
    buffer_load_dwordx2 v[10:11], v30, s[20:23], s59 offen sc1
    v_mfma_f32_16x16x32_bf16 v[76:79], v[44:47], v[228:231], v[76:79]
    ds_read_b64_tr_b16 v[42:43], v1 offset:9728
    buffer_load_dwordx2 v[16:17], v30, s[20:23], s59 offen offset:128 sc1
    s_waitcnt lgkmcnt(4)
    v_mfma_f32_16x16x32_bf16 v[48:51], v[32:35], v[232:235], v[48:51]
    ds_read_b64_tr_b16 v[44:45], v2 offset:9216
    v_mfma_f32_16x16x32_bf16 v[64:67], v[32:35], v[236:239], v[64:67]
    ds_read_b64_tr_b16 v[46:47], v2 offset:9728
    buffer_store_dwordx4 v[24:27], v9, s[20:23], s26 offen sc1
    s_waitcnt lgkmcnt(4)
    v_mfma_f32_16x16x32_bf16 v[52:55], v[36:39], v[232:235], v[52:55]
    v_mfma_f32_16x16x32_bf16 v[68:71], v[36:39], v[236:239], v[68:71]
    s_waitcnt vmcnt(8) lgkmcnt(0)
    s_barrier
    s_add_u32 m0, s50, 49152
    s_nop 0
    buffer_load_dwordx4 v4, s[8:11], s49 offen lds
    buffer_load_dwordx4 v5, s[8:11], s49 offen offset:1024 lds
    s_add_u32 s49, s49, 491520
    s_add_u32 m0, s50, 0
    s_nop 0
    buffer_load_dwordx4 v4, s[8:11], s49 offen lds
    buffer_load_dwordx4 v5, s[8:11], s49 offen offset:1024 lds
    s_add_u32 s49, s49, 491520
    ds_read_b128 v[240:243], v80 offset:16384
    ds_read_b64_tr_b16 v[32:33], v1 offset:16384
    ds_read_b128 v[244:247], v80 offset:18432
    ds_read_b64_tr_b16 v[34:35], v1 offset:16896
    ds_read_b64_tr_b16 v[24:25], v8 offset:2048
    ds_read_b64_tr_b16 v[26:27], v8 offset:2560
    v_mfma_f32_16x16x32_bf16 v[56:59], v[40:43], v[232:235], v[56:59]
    ds_read_b64_tr_b16 v[36:37], v2 offset:16384
    s_bfe_u32 s69, s2, 0x40003
    v_mfma_f32_16x16x32_bf16 v[72:75], v[40:43], v[236:239], v[72:75]
    ds_read_b64_tr_b16 v[38:39], v2 offset:16896
    s_and_b32 s58, s2, 7
    s_lshr_b32 s59, s2, 7
    v_mfma_f32_16x16x32_bf16 v[60:63], v[44:47], v[232:235], v[60:63]
    ds_read_b64_tr_b16 v[40:41], v1 offset:17408
    s_lshl1_add_u32 s70, s58, s59
    s_lshr_b32 s59, s58, 1
    v_mfma_f32_16x16x32_bf16 v[76:79], v[44:47], v[236:239], v[76:79]
    ds_read_b64_tr_b16 v[42:43], v1 offset:17920
    s_bfe_u32 s60, s2, 0x30003
    s_lshl3_add_u32 s71, s59, s60
    s_waitcnt lgkmcnt(6)
    v_mfma_f32_16x16x32_bf16 v[48:51], v[32:35], v[240:243], v[48:51]
    ds_read_b64_tr_b16 v[44:45], v2 offset:17408
    s_and_b32 s59, s2, 1
    s_lshr_b32 s60, s2, 6
    v_mfma_f32_16x16x32_bf16 v[64:67], v[32:35], v[244:247], v[64:67]
    ds_read_b64_tr_b16 v[46:47], v2 offset:17920
    s_lshl2_add_u32 s72, s59, s60
    s_mul_i32 s58, s72, 68
    s_waitcnt lgkmcnt(4)
    v_mfma_f32_16x16x32_bf16 v[52:55], v[36:39], v[240:243], v[52:55]
    ds_read_b128 v[248:251], v81 offset:16384
    ds_read_b64_tr_b16 v[32:33], v1 offset:24576
    s_mul_i32 s59, s47, 12
    s_add_u32 s59, s58, s59
    v_mfma_f32_16x16x32_bf16 v[68:71], v[36:39], v[244:247], v[68:71]
    ds_read_b128 v[252:255], v81 offset:18432
    ds_read_b64_tr_b16 v[34:35], v1 offset:25088
    s_mul_i32 s78, s59, 5120
    s_add_u32 s78, s78, 20971520
    s_waitcnt lgkmcnt(6)
    v_mfma_f32_16x16x32_bf16 v[56:59], v[40:43], v[240:243], v[56:59]
    ds_read_b64_tr_b16 v[36:37], v2 offset:24576
    s_mul_i32 s83, s47, 20480
    s_cmp_eq_u32 s47, 3
    v_mfma_f32_16x16x32_bf16 v[72:75], v[40:43], v[244:247], v[72:75]
    ds_read_b64_tr_b16 v[38:39], v2 offset:25088
    s_cselect_b32 s83, 134144, s83
    s_lshr_b32 s79, s71, 1
    s_waitcnt lgkmcnt(6)
    v_mfma_f32_16x16x32_bf16 v[60:63], v[44:47], v[240:243], v[60:63]
    ds_read_b64_tr_b16 v[40:41], v1 offset:25600
    s_mul_i32 s75, s58, 5120
    s_add_u32 s75, s75, 21217280
    v_mfma_f32_16x16x32_bf16 v[76:79], v[44:47], v[244:247], v[76:79]
    ds_read_b64_tr_b16 v[42:43], v1 offset:26112
    s_mov_b64 s[36:37], s[40:41]
    s_mov_b32 s38, 2621440
    s_waitcnt lgkmcnt(4)
    v_mfma_f32_16x16x32_bf16 v[48:51], v[32:35], v[248:251], v[48:51]
    ds_read_b64_tr_b16 v[44:45], v2 offset:25600
    s_mov_b32 s39, 0x20000
    buffer_store_dwordx4 v[24:27], v9, s[20:23], s27 offen sc1
    v_mfma_f32_16x16x32_bf16 v[64:67], v[32:35], v[252:255], v[64:67]
    ds_read_b64_tr_b16 v[46:47], v2 offset:26112
    s_waitcnt lgkmcnt(4)
    v_mfma_f32_16x16x32_bf16 v[52:55], v[36:39], v[248:251], v[52:55]
    v_mfma_f32_16x16x32_bf16 v[68:71], v[36:39], v[252:255], v[68:71]
    s_waitcnt vmcnt(6) lgkmcnt(0)
    s_barrier
    s_add_u32 m0, s50, 16384
    s_nop 0
    buffer_load_dwordx4 v4, s[8:11], s49 offen lds
    buffer_load_dwordx4 v5, s[8:11], s49 offen offset:1024 lds
    s_add_u32 s49, s49, 491520
    v_mov_b32 v12, v10
    v_mov_b32 v13, v10
    v_mov_b32 v14, v16
    v_mov_b32 v15, v16
    v_rsq_f32 v16, v11
    v_mov_b32 v10, v11
    v_mov_b32 v11, v17
    v_rsq_f32 v17, v17
    v_mul_f32 v16, 0xbfb8aa3b, v16
    v_mul_f32 v17, 0xbfb8aa3b, v17
    ds_read_b64_tr_b16 v[32:33], v1 offset:32768
    ds_read_b64_tr_b16 v[34:35], v1 offset:33280
    s_lshl2_add_u32 s59, s71, s47
    v_mfma_f32_16x16x32_bf16 v[56:59], v[40:43], v[248:251], v[56:59]
    ds_read_b64_tr_b16 v[36:37], v2 offset:32768
    v_mfma_f32_16x16x32_bf16 v[72:75], v[40:43], v[252:255], v[72:75]
    ds_read_b64_tr_b16 v[38:39], v2 offset:33280
    s_mul_i32 s40, s59, 20480
    v_mfma_f32_16x16x32_bf16 v[60:63], v[44:47], v[248:251], v[60:63]
    v_add_u32 v29, v3, v1
    v_mfma_f32_16x16x32_bf16 v[76:79], v[44:47], v[252:255], v[76:79]
    ds_read_b64_tr_b16 v[40:41], v29 offset:0
    s_waitcnt lgkmcnt(3)
    v_mfma_f32_16x16x32_bf16 v[80:83], v[32:35], v[96:99], 0
    v_add_u32 v29, v3, v2
    s_add_u32 s40, s40, 16777216
    v_mfma_f32_16x16x32_bf16 v[88:91], v[32:35], v[100:103], 0
    ds_read_b64_tr_b16 v[44:45], v29 offset:0
    s_waitcnt lgkmcnt(2)
    v_mfma_f32_16x16x32_bf16 v[84:87], v[36:39], v[96:99], 0
    v_add_u32 v29, v3, v1
    v_mfma_f32_16x16x32_bf16 v[92:95], v[36:39], v[100:103], 0
    ds_read_b64_tr_b16 v[32:33], v29 offset:2048
    s_lshl_b32 s41, s47, 10
    s_waitcnt lgkmcnt(2)
    v_mfma_f32_16x16x16_bf16 v[48:51], v[40:41], v[12:13], v[48:51]
    v_add_u32 v29, v3, v2
    v_mfma_f32_16x16x16_bf16 v[64:67], v[40:41], v[14:15], v[64:67]
    ds_read_b64_tr_b16 v[36:37], v29 offset:2048
    s_add_u32 s42, s41, s75
    s_waitcnt lgkmcnt(2)
    v_mfma_f32_16x16x16_bf16 v[52:55], v[44:45], v[12:13], v[52:55]
    ds_read_b64_tr_b16 v[40:41], v1 offset:40960
    v_mfma_f32_16x16x16_bf16 v[68:71], v[44:45], v[14:15], v[68:71]
    ds_read_b64_tr_b16 v[42:43], v1 offset:41472
    s_waitcnt lgkmcnt(3)
    v_mfma_f32_16x16x16_bf16 v[56:59], v[32:33], v[12:13], v[56:59]
    ds_read_b64_tr_b16 v[44:45], v2 offset:40960
    s_mul_i32 s81, s69, 491520
    v_mfma_f32_16x16x16_bf16 v[72:75], v[32:33], v[14:15], v[72:75]
    ds_read_b64_tr_b16 v[46:47], v2 offset:41472
    s_waitcnt lgkmcnt(4)
    v_mfma_f32_16x16x16_bf16 v[60:63], v[36:37], v[12:13], v[60:63]
    ds_read_b64_tr_b16 v[32:33], v1 offset:33792
    v_mfma_f32_16x16x16_bf16 v[76:79], v[36:37], v[14:15], v[76:79]
    ds_read_b64_tr_b16 v[34:35], v1 offset:34304
    s_mul_i32 s59, s70, 10240
    s_waitcnt lgkmcnt(4)
    v_mfma_f32_16x16x32_bf16 v[80:83], v[40:43], v[104:107], v[80:83]
    ds_read_b64_tr_b16 v[36:37], v2 offset:33792
    v_mfma_f32_16x16x32_bf16 v[88:91], v[40:43], v[108:111], v[88:91]
    ds_read_b64_tr_b16 v[38:39], v2 offset:34304
    s_add_u32 s81, s81, s59
    s_waitcnt lgkmcnt(4)
    v_mfma_f32_16x16x32_bf16 v[84:87], v[44:47], v[104:107], v[84:87]
    ds_read_b64_tr_b16 v[40:41], v1 offset:41984
    v_mfma_f32_16x16x32_bf16 v[92:95], v[44:47], v[108:111], v[92:95]
    ds_read_b64_tr_b16 v[42:43], v1 offset:42496
    s_waitcnt lgkmcnt(4)
    v_mfma_f32_16x16x32_bf16 v[80:83], v[32:35], v[112:115], v[80:83]
    ds_read_b64_tr_b16 v[44:45], v2 offset:41984
    s_mul_i32 s82, s46, 768
    v_mfma_f32_16x16x32_bf16 v[88:91], v[32:35], v[116:119], v[88:91]
    ds_read_b64_tr_b16 v[46:47], v2 offset:42496
    s_bitcmp1_b32 s2, 6
    s_cbranch_scc1 L_tyB
    s_waitcnt lgkmcnt(4)
    v_mfma_f32_16x16x32_bf16 v[84:87], v[36:39], v[112:115], v[84:87]
    v_mfma_f32_16x16x32_bf16 v[92:95], v[36:39], v[116:119], v[92:95]
    s_waitcnt vmcnt(2) lgkmcnt(0)
    s_barrier
    s_cmp_lg_u32 s47, 0
    s_cbranch_scc1 L_nf3
    v_mov_b32 v30, 2
    v_mov_b32 v31, 0
    s_mov_b64 exec, 1
    buffer_store_dword v30, v31, s[20:23], s52 offen sc1
    s_mov_b64 exec, -1
L_nf3:
    s_add_u32 m0, s50, 32768
    s_nop 0
    buffer_load_dwordx4 v4, s[8:11], s49 offen lds
    buffer_load_dwordx4 v5, s[8:11], s49 offen offset:1024 lds
    s_add_u32 s49, s49, 491520
    ds_read_b64_tr_b16 v[32:33], v1 offset:49152
    ds_read_b64_tr_b16 v[34:35], v1 offset:49664
    v_mul_f32 v56, v48, v56
    v_mul_f32 v57, v49, v57
    v_mul_f32 v58, v50, v58
    v_mfma_f32_16x16x32_bf16 v[80:83], v[40:43], v[120:123], v[80:83]
    ds_read_b64_tr_b16 v[36:37], v2 offset:49152
    v_mul_f32 v59, v51, v59
    v_mul_f32 v48, v16, v48
    v_mfma_f32_16x16x32_bf16 v[88:91], v[40:43], v[124:127], v[88:91]
    ds_read_b64_tr_b16 v[38:39], v2 offset:49664
    v_mul_f32 v49, v16, v49
    v_mul_f32 v50, v16, v50
    v_mfma_f32_16x16x32_bf16 v[84:87], v[44:47], v[120:123], v[84:87]
    ds_read_b64_tr_b16 v[40:41], v1 offset:57344
    v_mul_f32 v51, v16, v51
    v_exp_f32 v48, v48
    v_mfma_f32_16x16x32_bf16 v[92:95], v[44:47], v[124:127], v[92:95]
    ds_read_b64_tr_b16 v[42:43], v1 offset:57856
    v_exp_f32 v49, v49
    s_waitcnt lgkmcnt(4)
    v_mfma_f32_16x16x32_bf16 v[80:83], v[32:35], v[128:131], v[80:83]
    ds_read_b64_tr_b16 v[44:45], v2 offset:57344
    v_exp_f32 v50, v50
    v_mfma_f32_16x16x32_bf16 v[88:91], v[32:35], v[132:135], v[88:91]
    ds_read_b64_tr_b16 v[46:47], v2 offset:57856
    v_exp_f32 v51, v51
    s_waitcnt lgkmcnt(4)
    v_mfma_f32_16x16x32_bf16 v[84:87], v[36:39], v[128:131], v[84:87]
    ds_read_b64_tr_b16 v[32:33], v1 offset:50176
    v_fma_f32 v48, v48, v10, v10
    v_mfma_f32_16x16x32_bf16 v[92:95], v[36:39], v[132:135], v[92:95]
    ds_read_b64_tr_b16 v[34:35], v1 offset:50688
    v_fma_f32 v49, v49, v10, v10
    v_fma_f32 v50, v50, v10, v10
    v_fma_f32 v51, v51, v10, v10
    s_waitcnt lgkmcnt(4)
    v_mfma_f32_16x16x32_bf16 v[80:83], v[40:43], v[136:139], v[80:83]
    ds_read_b64_tr_b16 v[36:37], v2 offset:50176
    v_rcp_f32 v48, v48
    v_mfma_f32_16x16x32_bf16 v[88:91], v[40:43], v[140:143], v[88:91]
    ds_read_b64_tr_b16 v[38:39], v2 offset:50688
    v_rcp_f32 v49, v49
    s_waitcnt lgkmcnt(4)
    v_mfma_f32_16x16x32_bf16 v[84:87], v[44:47], v[136:139], v[84:87]
    ds_read_b64_tr_b16 v[40:41], v1 offset:58368
    v_rcp_f32 v50, v50
    v_mfma_f32_16x16x32_bf16 v[92:95], v[44:47], v[140:143], v[92:95]
    ds_read_b64_tr_b16 v[42:43], v1 offset:58880
    v_rcp_f32 v51, v51
    s_waitcnt lgkmcnt(4)
    v_mfma_f32_16x16x32_bf16 v[80:83], v[32:35], v[144:147], v[80:83]
    ds_read_b64_tr_b16 v[44:45], v2 offset:58368
    v_mul_f32 v48, v48, v56
    v_mul_f32 v49, v49, v57
    v_mfma_f32_16x16x32_bf16 v[88:91], v[32:35], v[148:151], v[88:91]
    ds_read_b64_tr_b16 v[46:47], v2 offset:58880
    v_mul_f32 v50, v50, v58
    v_mul_f32 v51, v51, v59
    s_waitcnt lgkmcnt(4)
    v_mfma_f32_16x16x32_bf16 v[84:87], v[36:39], v[144:147], v[84:87]
    v_cvt_pk_bf16_f32 v20, v48, v49
    v_cvt_pk_bf16_f32 v21, v50, v51
    v_mfma_f32_16x16x32_bf16 v[92:95], v[36:39], v[148:151], v[92:95]
    s_waitcnt lgkmcnt(0)
    s_barrier
    v_lshrrev_b32 v4, 3, v0
    v_mul_u32_u24 v4, 3072, v4
    v_add_u32 v4, v4, v28
    v_xor_b32 v5, 0, v4
    s_mul_i32 s49, s46, 24576
    s_add_u32 s49, s49, s77
    s_add_u32 m0, s50, 49152
    s_nop 0
    buffer_load_dwordx4 v4, s[12:15], s49 offen lds
    s_add_u32 m0, s50, 50176
    s_nop 0
    buffer_load_dwordx4 v5, s[16:19], s49 offen lds
    s_add_u32 s49, s49, 196608
    ds_read_b64_tr_b16 v[32:33], v1 offset:0
    ds_read_b64_tr_b16 v[34:35], v1 offset:512
    v_mul_f32 v60, v52, v60
    v_mul_f32 v61, v53, v61
    v_mul_f32 v62, v54, v62
    v_mfma_f32_16x16x32_bf16 v[80:83], v[40:43], v[152:155], v[80:83]
    ds_read_b64_tr_b16 v[36:37], v2 offset:0
    v_mul_f32 v63, v55, v63
    v_mul_f32 v52, v16, v52
    v_mfma_f32_16x16x32_bf16 v[88:91], v[40:43], v[156:159], v[88:91]
    ds_read_b64_tr_b16 v[38:39], v2 offset:512
    v_mul_f32 v53, v16, v53
    v_mul_f32 v54, v16, v54
    v_mul_f32 v55, v16, v55
    v_mfma_f32_16x16x32_bf16 v[84:87], v[44:47], v[152:155], v[84:87]
    ds_read_b64_tr_b16 v[40:41], v1 offset:8192
    v_exp_f32 v52, v52
    v_mfma_f32_16x16x32_bf16 v[92:95], v[44:47], v[156:159], v[92:95]
    ds_read_b64_tr_b16 v[42:43], v1 offset:8704
    v_exp_f32 v53, v53
    v_exp_f32 v54, v54
    s_waitcnt lgkmcnt(4)
    v_mfma_f32_16x16x32_bf16 v[80:83], v[32:35], v[160:163], v[80:83]
    ds_read_b64_tr_b16 v[44:45], v2 offset:8192
    v_exp_f32 v55, v55
    v_mfma_f32_16x16x32_bf16 v[88:91], v[32:35], v[164:167], v[88:91]
    ds_read_b64_tr_b16 v[46:47], v2 offset:8704
    v_fma_f32 v52, v52, v10, v10
    s_waitcnt lgkmcnt(4)
    v_mfma_f32_16x16x32_bf16 v[84:87], v[36:39], v[160:163], v[84:87]
    ds_read_b64_tr_b16 v[32:33], v1 offset:1024
    v_fma_f32 v53, v53, v10, v10
    v_fma_f32 v54, v54, v10, v10
    v_fma_f32 v55, v55, v10, v10
    v_mfma_f32_16x16x32_bf16 v[92:95], v[36:39], v[164:167], v[92:95]
    ds_read_b64_tr_b16 v[34:35], v1 offset:1536
    v_rcp_f32 v52, v52
    s_waitcnt lgkmcnt(4)
    v_mfma_f32_16x16x32_bf16 v[80:83], v[40:43], v[168:171], v[80:83]
    ds_read_b64_tr_b16 v[36:37], v2 offset:1024
    v_rcp_f32 v53, v53
    v_rcp_f32 v54, v54
    v_mfma_f32_16x16x32_bf16 v[88:91], v[40:43], v[172:175], v[88:91]
    ds_read_b64_tr_b16 v[38:39], v2 offset:1536
    v_rcp_f32 v55, v55
    s_waitcnt lgkmcnt(4)
    v_mfma_f32_16x16x32_bf16 v[84:87], v[44:47], v[168:171], v[84:87]
    ds_read_b64_tr_b16 v[40:41], v1 offset:9216
    v_mul_f32 v52, v52, v60
    v_mfma_f32_16x16x32_bf16 v[92:95], v[44:47], v[172:175], v[92:95]
    ds_read_b64_tr_b16 v[42:43], v1 offset:9728
    v_mul_f32 v53, v53, v61
    v_mul_f32 v54, v54, v62
    v_mul_f32 v55, v55, v63
    s_waitcnt lgkmcnt(4)
    v_mfma_f32_16x16x32_bf16 v[80:83], v[32:35], v[176:179], v[80:83]
    ds_read_b64_tr_b16 v[44:45], v2 offset:9216
    v_cvt_pk_bf16_f32 v22, v52, v53
    v_cvt_pk_bf16_f32 v23, v54, v55
    v_mfma_f32_16x16x32_bf16 v[88:91], v[32:35], v[180:183], v[88:91]
    ds_read_b64_tr_b16 v[46:47], v2 offset:9728
    s_add_u32 s59, s55, 0
    v_permlane16_swap_b32 v20, v22
    v_permlane16_swap_b32 v21, v23
    s_waitcnt lgkmcnt(4)
    v_mfma_f32_16x16x32_bf16 v[84:87], v[36:39], v[176:179], v[84:87]
    buffer_store_dwordx4 v[20:23], v18, s[20:23], s59 offen sc1
    v_mfma_f32_16x16x32_bf16 v[92:95], v[36:39], v[180:183], v[92:95]
    s_waitcnt vmcnt(5) lgkmcnt(0)
    s_barrier
    s_add_u32 m0, s50, 0
    s_nop 0
    buffer_load_dwordx4 v4, s[12:15], s49 offen lds
    s_add_u32 m0, s50, 1024
    s_nop 0
    buffer_load_dwordx4 v5, s[16:19], s49 offen lds
    s_add_u32 s49, s49, 196608
    ds_read_b64_tr_b16 v[32:33], v1 offset:16384
    ds_read_b64_tr_b16 v[34:35], v1 offset:16896
    v_mul_f32 v72, v64, v72
    v_mul_f32 v73, v65, v73
    v_mul_f32 v74, v66, v74
    v_mfma_f32_16x16x32_bf16 v[80:83], v[40:43], v[184:187], v[80:83]
    ds_read_b64_tr_b16 v[36:37], v2 offset:16384
    v_mul_f32 v75, v67, v75
    v_mul_f32 v64, v17, v64
    v_mfma_f32_16x16x32_bf16 v[88:91], v[40:43], v[188:191], v[88:91]
    ds_read_b64_tr_b16 v[38:39], v2 offset:16896
    v_mul_f32 v65, v17, v65
    v_mul_f32 v66, v17, v66
    v_mfma_f32_16x16x32_bf16 v[84:87], v[44:47], v[184:187], v[84:87]
    ds_read_b64_tr_b16 v[40:41], v1 offset:24576
    v_mul_f32 v67, v17, v67
    v_exp_f32 v64, v64
    v_mfma_f32_16x16x32_bf16 v[92:95], v[44:47], v[188:191], v[92:95]
    ds_read_b64_tr_b16 v[42:43], v1 offset:25088
    v_exp_f32 v65, v65
    s_waitcnt lgkmcnt(4)
    v_mfma_f32_16x16x32_bf16 v[80:83], v[32:35], v[192:195], v[80:83]
    ds_read_b64_tr_b16 v[44:45], v2 offset:24576
    v_exp_f32 v66, v66
    v_mfma_f32_16x16x32_bf16 v[88:91], v[32:35], v[196:199], v[88:91]
    ds_read_b64_tr_b16 v[46:47], v2 offset:25088
    v_exp_f32 v67, v67
    s_waitcnt lgkmcnt(4)
    v_mfma_f32_16x16x32_bf16 v[84:87], v[36:39], v[192:195], v[84:87]
    ds_read_b64_tr_b16 v[32:33], v1 offset:17408
    v_fma_f32 v64, v64, v11, v11
    v_mfma_f32_16x16x32_bf16 v[92:95], v[36:39], v[196:199], v[92:95]
    ds_read_b64_tr_b16 v[34:35], v1 offset:17920
    v_fma_f32 v65, v65, v11, v11
    v_fma_f32 v66, v66, v11, v11
    v_fma_f32 v67, v67, v11, v11
    s_waitcnt lgkmcnt(4)
    v_mfma_f32_16x16x32_bf16 v[80:83], v[40:43], v[200:203], v[80:83]
    ds_read_b64_tr_b16 v[36:37], v2 offset:17408
    v_rcp_f32 v64, v64
    v_mfma_f32_16x16x32_bf16 v[88:91], v[40:43], v[204:207], v[88:91]
    ds_read_b64_tr_b16 v[38:39], v2 offset:17920
    v_rcp_f32 v65, v65
    s_waitcnt lgkmcnt(4)
    v_mfma_f32_16x16x32_bf16 v[84:87], v[44:47], v[200:203], v[84:87]
    ds_read_b64_tr_b16 v[40:41], v1 offset:25600
    v_rcp_f32 v66, v66
    v_mfma_f32_16x16x32_bf16 v[92:95], v[44:47], v[204:207], v[92:95]
    ds_read_b64_tr_b16 v[42:43], v1 offset:26112
    v_rcp_f32 v67, v67
    s_waitcnt lgkmcnt(4)
    v_mfma_f32_16x16x32_bf16 v[80:83], v[32:35], v[208:211], v[80:83]
    ds_read_b64_tr_b16 v[44:45], v2 offset:25600
    v_mul_f32 v64, v64, v72
    v_mul_f32 v65, v65, v73
    v_mfma_f32_16x16x32_bf16 v[88:91], v[32:35], v[212:215], v[88:91]
    ds_read_b64_tr_b16 v[46:47], v2 offset:26112
    v_mul_f32 v66, v66, v74
    v_mul_f32 v67, v67, v75
    s_waitcnt lgkmcnt(4)
    v_mfma_f32_16x16x32_bf16 v[84:87], v[36:39], v[208:211], v[84:87]
    v_cvt_pk_bf16_f32 v20, v64, v65
    v_cvt_pk_bf16_f32 v21, v66, v67
    v_mfma_f32_16x16x32_bf16 v[92:95], v[36:39], v[212:215], v[92:95]
    s_waitcnt vmcnt(5) lgkmcnt(0)
    s_barrier
    s_add_u32 m0, s50, 16384
    s_nop 0
    buffer_load_dwordx4 v4, s[12:15], s49 offen lds
    s_add_u32 m0, s50, 17408
    s_nop 0
    buffer_load_dwordx4 v5, s[16:19], s49 offen lds
    s_add_u32 s49, s49, 196608
    ds_read_b64_tr_b16 v[32:33], v1 offset:32768
    ds_read_b64_tr_b16 v[34:35], v1 offset:33280
    v_mul_f32 v76, v68, v76
    v_mul_f32 v77, v69, v77
    v_mfma_f32_16x16x32_bf16 v[80:83], v[40:43], v[216:219], v[80:83]
    ds_read_b64_tr_b16 v[36:37], v2 offset:32768
    v_mul_f32 v78, v70, v78
    v_mul_f32 v79, v71, v79
    v_mfma_f32_16x16x32_bf16 v[88:91], v[40:43], v[220:223], v[88:91]
    ds_read_b64_tr_b16 v[38:39], v2 offset:33280
    v_mul_f32 v68, v17, v68
    v_mul_f32 v69, v17, v69
    v_mfma_f32_16x16x32_bf16 v[84:87], v[44:47], v[216:219], v[84:87]
    v_add_u32 v29, v3, v1
    v_mul_f32 v70, v17, v70
    v_mul_f32 v71, v17, v71
    v_mfma_f32_16x16x32_bf16 v[92:95], v[44:47], v[220:223], v[92:95]
    ds_read_b64_tr_b16 v[40:41], v29 offset:8192
    v_exp_f32 v68, v68
    s_waitcnt lgkmcnt(3)
    v_mfma_f32_16x16x32_bf16 v[80:83], v[32:35], v[224:227], v[80:83]
    v_add_u32 v29, v3, v2
    v_exp_f32 v69, v69
    v_mfma_f32_16x16x32_bf16 v[88:91], v[32:35], v[228:231], v[88:91]
    ds_read_b64_tr_b16 v[44:45], v29 offset:8192
    v_exp_f32 v70, v70
    s_waitcnt lgkmcnt(2)
    v_mfma_f32_16x16x32_bf16 v[84:87], v[36:39], v[224:227], v[84:87]
    ds_read_b64_tr_b16 v[32:33], v1 offset:40960
    v_exp_f32 v71, v71
    v_mfma_f32_16x16x32_bf16 v[92:95], v[36:39], v[228:231], v[92:95]
    ds_read_b64_tr_b16 v[34:35], v1 offset:41472
    v_fma_f32 v68, v68, v11, v11
    v_fma_f32 v69, v69, v11, v11
    s_waitcnt lgkmcnt(3)
    v_mfma_f32_16x16x16_bf16 v[80:83], v[40:41], v[12:13], v[80:83]
    ds_read_b64_tr_b16 v[36:37], v2 offset:40960
    v_fma_f32 v70, v70, v11, v11
    v_fma_f32 v71, v71, v11, v11
    v_mfma_f32_16x16x16_bf16 v[88:91], v[40:41], v[14:15], v[88:91]
    ds_read_b64_tr_b16 v[38:39], v2 offset:41472
    v_rcp_f32 v68, v68
    s_waitcnt lgkmcnt(4)
    v_mfma_f32_16x16x16_bf16 v[84:87], v[44:45], v[12:13], v[84:87]
    ds_read_b64_tr_b16 v[40:41], v1 offset:33792
    v_rcp_f32 v69, v69
    v_mfma_f32_16x16x16_bf16 v[92:95], v[44:45], v[14:15], v[92:95]
    ds_read_b64_tr_b16 v[42:43], v1 offset:34304
    v_rcp_f32 v70, v70
    s_waitcnt lgkmcnt(4)
    v_mfma_f32_16x16x32_bf16 v[80:83], v[32:35], v[232:235], v[80:83]
    ds_read_b64_tr_b16 v[44:45], v2 offset:33792
    v_rcp_f32 v71, v71
    v_mfma_f32_16x16x32_bf16 v[88:91], v[32:35], v[236:239], v[88:91]
    ds_read_b64_tr_b16 v[46:47], v2 offset:34304
    v_mul_f32 v68, v68, v76
    s_waitcnt lgkmcnt(4)
    v_mfma_f32_16x16x32_bf16 v[84:87], v[36:39], v[232:235], v[84:87]
    ds_read_b64_tr_b16 v[32:33], v1 offset:41984
    v_mul_f32 v69, v69, v77
    v_mul_f32 v70, v70, v78
    v_mfma_f32_16x16x32_bf16 v[92:95], v[36:39], v[236:239], v[92:95]
    ds_read_b64_tr_b16 v[34:35], v1 offset:42496
    v_mul_f32 v71, v71, v79
    v_cvt_pk_bf16_f32 v22, v68, v69
    s_waitcnt lgkmcnt(4)
    v_mfma_f32_16x16x32_bf16 v[80:83], v[40:43], v[240:243], v[80:83]
    ds_read_b64_tr_b16 v[36:37], v2 offset:41984
    v_cvt_pk_bf16_f32 v23, v70, v71
    s_add_u32 s59, s55, 49152
    v_permlane16_swap_b32 v20, v22
    v_mfma_f32_16x16x32_bf16 v[88:91], v[40:43], v[244:247], v[88:91]
    ds_read_b64_tr_b16 v[38:39], v2 offset:42496
    v_permlane16_swap_b32 v21, v23
    buffer_store_dwordx4 v[20:23], v18, s[20:23], s59 offen sc1
    s_nop 1
    s_branch L_tjB
L_tyB:
    s_waitcnt lgkmcnt(4)
    v_mfma_f32_16x16x32_bf16 v[84:87], v[36:39], v[112:115], v[84:87]
    v_mfma_f32_16x16x32_bf16 v[92:95], v[36:39], v[116:119], v[92:95]
    s_waitcnt vmcnt(2) lgkmcnt(0)
    s_barrier
    s_cmp_lg_u32 s47, 0
    s_cbranch_scc1 L_nf4
    v_mov_b32 v30, 2
    v_mov_b32 v31, 0
    s_mov_b64 exec, 1
    buffer_store_dword v30, v31, s[20:23], s52 offen sc1
    s_mov_b64 exec, -1
L_nf4:
    s_add_u32 m0, s50, 32768
    s_nop 0
    buffer_load_dwordx4 v4, s[8:11], s49 offen lds
    buffer_load_dwordx4 v5, s[8:11], s49 offen offset:1024 lds
    s_add_u32 s49, s49, 491520
    ds_read_b64_tr_b16 v[32:33], v1 offset:49152
    ds_read_b64_tr_b16 v[34:35], v1 offset:49664
    v_mul_f32 v30, s54, v16
    v_mul_f32 v48, v30, v48
    v_mfma_f32_16x16x32_bf16 v[80:83], v[40:43], v[120:123], v[80:83]
    ds_read_b64_tr_b16 v[36:37], v2 offset:49152
    v_mul_f32 v49, v30, v49
    v_mfma_f32_16x16x32_bf16 v[88:91], v[40:43], v[124:127], v[88:91]
    ds_read_b64_tr_b16 v[38:39], v2 offset:49664
    v_mul_f32 v50, v30, v50
    v_mfma_f32_16x16x32_bf16 v[84:87], v[44:47], v[120:123], v[84:87]
    ds_read_b64_tr_b16 v[40:41], v1 offset:57344
    v_mul_f32 v51, v30, v51
    v_mfma_f32_16x16x32_bf16 v[92:95], v[44:47], v[124:127], v[92:95]
    ds_read_b64_tr_b16 v[42:43], v1 offset:57856
    v_mul_f32 v52, v30, v52
    s_waitcnt lgkmcnt(4)
    v_mfma_f32_16x16x32_bf16 v[80:83], v[32:35], v[128:131], v[80:83]
    ds_read_b64_tr_b16 v[44:45], v2 offset:57344
    v_mul_f32 v53, v30, v53
    v_mfma_f32_16x16x32_bf16 v[88:91], v[32:35], v[132:135], v[88:91]
    ds_read_b64_tr_b16 v[46:47], v2 offset:57856
    v_mul_f32 v54, v30, v54
    s_waitcnt lgkmcnt(4)
    v_mfma_f32_16x16x32_bf16 v[84:87], v[36:39], v[128:131], v[84:87]
    ds_read_b64_tr_b16 v[32:33], v1 offset:50176
    v_mul_f32 v55, v30, v55
    v_mfma_f32_16x16x32_bf16 v[92:95], v[36:39], v[132:135], v[92:95]
    ds_read_b64_tr_b16 v[34:35], v1 offset:50688
    v_cvt_pk_bf16_f32 v48, v48, v49
    s_waitcnt lgkmcnt(4)
    v_mfma_f32_16x16x32_bf16 v[80:83], v[40:43], v[136:139], v[80:83]
    ds_read_b64_tr_b16 v[36:37], v2 offset:50176
    v_cvt_pk_bf16_f32 v49, v50, v51
    v_mfma_f32_16x16x32_bf16 v[88:91], v[40:43], v[140:143], v[88:91]
    ds_read_b64_tr_b16 v[38:39], v2 offset:50688
    v_cvt_pk_bf16_f32 v50, v52, v53
    v_cvt_pk_bf16_f32 v51, v54, v55
    s_waitcnt lgkmcnt(4)
    v_mfma_f32_16x16x32_bf16 v[84:87], v[44:47], v[136:139], v[84:87]
    ds_read_b64_tr_b16 v[40:41], v1 offset:58368
    s_add_u32 s59, s57, 0
    v_mfma_f32_16x16x32_bf16 v[92:95], v[44:47], v[140:143], v[92:95]
    ds_read_b64_tr_b16 v[42:43], v1 offset:58880
    v_permlane16_swap_b32 v48, v50
    s_waitcnt lgkmcnt(4)
    v_mfma_f32_16x16x32_bf16 v[80:83], v[32:35], v[144:147], v[80:83]
    ds_read_b64_tr_b16 v[44:45], v2 offset:58368
    v_permlane16_swap_b32 v49, v51
    v_mfma_f32_16x16x32_bf16 v[88:91], v[32:35], v[148:151], v[88:91]
    ds_read_b64_tr_b16 v[46:47], v2 offset:58880
    buffer_store_dwordx4 v[48:51], v19, s[20:23], s59 offen sc1
    s_waitcnt lgkmcnt(4)
    v_mfma_f32_16x16x32_bf16 v[84:87], v[36:39], v[144:147], v[84:87]
    v_mfma_f32_16x16x32_bf16 v[92:95], v[36:39], v[148:151], v[92:95]
    s_waitcnt lgkmcnt(0)
    s_barrier
    v_lshrrev_b32 v4, 3, v0
    v_mul_u32_u24 v4, 3072, v4
    v_add_u32 v4, v4, v28
    v_xor_b32 v5, 0, v4
    s_mul_i32 s49, s46, 24576
    s_add_u32 s49, s49, s77
    s_add_u32 m0, s50, 49152
    s_nop 0
    buffer_load_dwordx4 v4, s[12:15], s49 offen lds
    s_add_u32 m0, s50, 50176
    s_nop 0
    buffer_load_dwordx4 v5, s[16:19], s49 offen lds
    s_add_u32 s49, s49, 196608
    ds_read_b64_tr_b16 v[32:33], v1 offset:0
    ds_read_b64_tr_b16 v[34:35], v1 offset:512
    v_mul_f32 v30, s54, v16
    v_mul_f32 v56, v30, v56
    v_mfma_f32_16x16x32_bf16 v[80:83], v[40:43], v[152:155], v[80:83]
    ds_read_b64_tr_b16 v[36:37], v2 offset:0
    v_mul_f32 v57, v30, v57
    v_mfma_f32_16x16x32_bf16 v[88:91], v[40:43], v[156:159], v[88:91]
    ds_read_b64_tr_b16 v[38:39], v2 offset:512
    v_mul_f32 v58, v30, v58
    v_mfma_f32_16x16x32_bf16 v[84:87], v[44:47], v[152:155], v[84:87]
    ds_read_b64_tr_b16 v[40:41], v1 offset:8192
    v_mul_f32 v59, v30, v59
    v_mfma_f32_16x16x32_bf16 v[92:95], v[44:47], v[156:159], v[92:95]
    ds_read_b64_tr_b16 v[42:43], v1 offset:8704
    v_mul_f32 v60, v30, v60
    s_waitcnt lgkmcnt(4)
    v_mfma_f32_16x16x32_bf16 v[80:83], v[32:35], v[160:163], v[80:83]
    ds_read_b64_tr_b16 v[44:45], v2 offset:8192
    v_mul_f32 v61, v30, v61
    v_mfma_f32_16x16x32_bf16 v[88:91], v[32:35], v[164:167], v[88:91]
    ds_read_b64_tr_b16 v[46:47], v2 offset:8704
    v_mul_f32 v62, v30, v62
    s_waitcnt lgkmcnt(4)
    v_mfma_f32_16x16x32_bf16 v[84:87], v[36:39], v[160:163], v[84:87]
    ds_read_b64_tr_b16 v[32:33], v1 offset:1024
    v_mul_f32 v63, v30, v63
    v_mfma_f32_16x16x32_bf16 v[92:95], v[36:39], v[164:167], v[92:95]
    ds_read_b64_tr_b16 v[34:35], v1 offset:1536
    v_cvt_pk_bf16_f32 v56, v56, v57
    s_waitcnt lgkmcnt(4)
    v_mfma_f32_16x16x32_bf16 v[80:83], v[40:43], v[168:171], v[80:83]
    ds_read_b64_tr_b16 v[36:37], v2 offset:1024
    v_cvt_pk_bf16_f32 v57, v58, v59
    v_mfma_f32_16x16x32_bf16 v[88:91], v[40:43], v[172:175], v[88:91]
    ds_read_b64_tr_b16 v[38:39], v2 offset:1536
    v_cvt_pk_bf16_f32 v58, v60, v61
    v_cvt_pk_bf16_f32 v59, v62, v63
    s_waitcnt lgkmcnt(4)
    v_mfma_f32_16x16x32_bf16 v[84:87], v[44:47], v[168:171], v[84:87]
    ds_read_b64_tr_b16 v[40:41], v1 offset:9216
    s_add_u32 s59, s57, 16384
    v_mfma_f32_16x16x32_bf16 v[92:95], v[44:47], v[172:175], v[92:95]
    ds_read_b64_tr_b16 v[42:43], v1 offset:9728
    v_permlane16_swap_b32 v56, v58
    s_waitcnt lgkmcnt(4)
    v_mfma_f32_16x16x32_bf16 v[80:83], v[32:35], v[176:179], v[80:83]
    ds_read_b64_tr_b16 v[44:45], v2 offset:9216
    v_permlane16_swap_b32 v57, v59
    v_mfma_f32_16x16x32_bf16 v[88:91], v[32:35], v[180:183], v[88:91]
    ds_read_b64_tr_b16 v[46:47], v2 offset:9728
    buffer_store_dwordx4 v[56:59], v19, s[20:23], s59 offen sc1
    s_waitcnt lgkmcnt(4)
    v_mfma_f32_16x16x32_bf16 v[84:87], v[36:39], v[176:179], v[84:87]
    v_mfma_f32_16x16x32_bf16 v[92:95], v[36:39], v[180:183], v[92:95]
    s_waitcnt vmcnt(5) lgkmcnt(0)
    s_barrier
    s_add_u32 m0, s50, 0
    s_nop 0
    buffer_load_dwordx4 v4, s[12:15], s49 offen lds
    s_add_u32 m0, s50, 1024
    s_nop 0
    buffer_load_dwordx4 v5, s[16:19], s49 offen lds
    s_add_u32 s49, s49, 196608
    ds_read_b64_tr_b16 v[32:33], v1 offset:16384
    ds_read_b64_tr_b16 v[34:35], v1 offset:16896
    v_mul_f32 v30, s54, v17
    v_mul_f32 v64, v30, v64
    v_mfma_f32_16x16x32_bf16 v[80:83], v[40:43], v[184:187], v[80:83]
    ds_read_b64_tr_b16 v[36:37], v2 offset:16384
    v_mul_f32 v65, v30, v65
    v_mfma_f32_16x16x32_bf16 v[88:91], v[40:43], v[188:191], v[88:91]
    ds_read_b64_tr_b16 v[38:39], v2 offset:16896
    v_mul_f32 v66, v30, v66
    v_mfma_f32_16x16x32_bf16 v[84:87], v[44:47], v[184:187], v[84:87]
    ds_read_b64_tr_b16 v[40:41], v1 offset:24576
    v_mul_f32 v67, v30, v67
    v_mfma_f32_16x16x32_bf16 v[92:95], v[44:47], v[188:191], v[92:95]
    ds_read_b64_tr_b16 v[42:43], v1 offset:25088
    v_mul_f32 v68, v30, v68
    s_waitcnt lgkmcnt(4)
    v_mfma_f32_16x16x32_bf16 v[80:83], v[32:35], v[192:195], v[80:83]
    ds_read_b64_tr_b16 v[44:45], v2 offset:24576
    v_mul_f32 v69, v30, v69
    v_mfma_f32_16x16x32_bf16 v[88:91], v[32:35], v[196:199], v[88:91]
    ds_read_b64_tr_b16 v[46:47], v2 offset:25088
    v_mul_f32 v70, v30, v70
    s_waitcnt lgkmcnt(4)
    v_mfma_f32_16x16x32_bf16 v[84:87], v[36:39], v[192:195], v[84:87]
    ds_read_b64_tr_b16 v[32:33], v1 offset:17408
    v_mul_f32 v71, v30, v71
    v_mfma_f32_16x16x32_bf16 v[92:95], v[36:39], v[196:199], v[92:95]
    ds_read_b64_tr_b16 v[34:35], v1 offset:17920
    v_cvt_pk_bf16_f32 v64, v64, v65
    s_waitcnt lgkmcnt(4)
    v_mfma_f32_16x16x32_bf16 v[80:83], v[40:43], v[200:203], v[80:83]
    ds_read_b64_tr_b16 v[36:37], v2 offset:17408
    v_cvt_pk_bf16_f32 v65, v66, v67
    v_mfma_f32_16x16x32_bf16 v[88:91], v[40:43], v[204:207], v[88:91]
    ds_read_b64_tr_b16 v[38:39], v2 offset:17920
    v_cvt_pk_bf16_f32 v66, v68, v69
    v_cvt_pk_bf16_f32 v67, v70, v71
    s_waitcnt lgkmcnt(4)
    v_mfma_f32_16x16x32_bf16 v[84:87], v[44:47], v[200:203], v[84:87]
    ds_read_b64_tr_b16 v[40:41], v1 offset:25600
    s_add_u32 s59, s57, 256
    v_mfma_f32_16x16x32_bf16 v[92:95], v[44:47], v[204:207], v[92:95]
    ds_read_b64_tr_b16 v[42:43], v1 offset:26112
    v_permlane16_swap_b32 v64, v66
    s_waitcnt lgkmcnt(4)
    v_mfma_f32_16x16x32_bf16 v[80:83], v[32:35], v[208:211], v[80:83]
    ds_read_b64_tr_b16 v[44:45], v2 offset:25600
    v_permlane16_swap_b32 v65, v67
    v_mfma_f32_16x16x32_bf16 v[88:91], v[32:35], v[212:215], v[88:91]
    ds_read_b64_tr_b16 v[46:47], v2 offset:26112
    buffer_store_dwordx4 v[64:67], v19, s[20:23], s59 offen sc1
    s_waitcnt lgkmcnt(4)
    v_mfma_f32_16x16x32_bf16 v[84:87], v[36:39], v[208:211], v[84:87]
    v_mfma_f32_16x16x32_bf16 v[92:95], v[36:39], v[212:215], v[92:95]
    s_waitcnt vmcnt(5) lgkmcnt(0)
    s_barrier
    s_add_u32 m0, s50, 16384
    s_nop 0
    buffer_load_dwordx4 v4, s[12:15], s49 offen lds
    s_add_u32 m0, s50, 17408
    s_nop 0
    buffer_load_dwordx4 v5, s[16:19], s49 offen lds
    s_add_u32 s49, s49, 196608
    ds_read_b64_tr_b16 v[32:33], v1 offset:32768
    ds_read_b64_tr_b16 v[34:35], v1 offset:33280
    v_mul_f32 v30, s54, v17
    v_mfma_f32_16x16x32_bf16 v[80:83], v[40:43], v[216:219], v[80:83]
    ds_read_b64_tr_b16 v[36:37], v2 offset:32768
    v_mul_f32 v72, v30, v72
    v_mfma_f32_16x16x32_bf16 v[88:91], v[40:43], v[220:223], v[88:91]
    ds_read_b64_tr_b16 v[38:39], v2 offset:33280
    v_mul_f32 v73, v30, v73
    v_mfma_f32_16x16x32_bf16 v[84:87], v[44:47], v[216:219], v[84:87]
    v_add_u32 v29, v3, v1
    v_mul_f32 v74, v30, v74
    v_mfma_f32_16x16x32_bf16 v[92:95], v[44:47], v[220:223], v[92:95]
    ds_read_b64_tr_b16 v[40:41], v29 offset:8192
    v_mul_f32 v75, v30, v75
    s_waitcnt lgkmcnt(3)
    v_mfma_f32_16x16x32_bf16 v[80:83], v[32:35], v[224:227], v[80:83]
    v_add_u32 v29, v3, v2
    v_mul_f32 v76, v30, v76
    v_mfma_f32_16x16x32_bf16 v[88:91], v[32:35], v[228:231], v[88:91]
    ds_read_b64_tr_b16 v[44:45], v29 offset:8192
    v_mul_f32 v77, v30, v77
    s_waitcnt lgkmcnt(2)
    v_mfma_f32_16x16x32_bf16 v[84:87], v[36:39], v[224:227], v[84:87]
    ds_read_b64_tr_b16 v[32:33], v1 offset:40960
    v_mfma_f32_16x16x32_bf16 v[92:95], v[36:39], v[228:231], v[92:95]
    ds_read_b64_tr_b16 v[34:35], v1 offset:41472
    v_mul_f32 v78, v30, v78
    s_waitcnt lgkmcnt(3)
    v_mfma_f32_16x16x16_bf16 v[80:83], v[40:41], v[12:13], v[80:83]
    ds_read_b64_tr_b16 v[36:37], v2 offset:40960
    v_mul_f32 v79, v30, v79
    v_mfma_f32_16x16x16_bf16 v[88:91], v[40:41], v[14:15], v[88:91]
    ds_read_b64_tr_b16 v[38:39], v2 offset:41472
    v_cvt_pk_bf16_f32 v72, v72, v73
    s_waitcnt lgkmcnt(4)
    v_mfma_f32_16x16x16_bf16 v[84:87], v[44:45], v[12:13], v[84:87]
    ds_read_b64_tr_b16 v[40:41], v1 offset:33792
    v_cvt_pk_bf16_f32 v73, v74, v75
    v_mfma_f32_16x16x16_bf16 v[92:95], v[44:45], v[14:15], v[92:95]
    ds_read_b64_tr_b16 v[42:43], v1 offset:34304
    v_cvt_pk_bf16_f32 v74, v76, v77
    s_waitcnt lgkmcnt(4)
    v_mfma_f32_16x16x32_bf16 v[80:83], v[32:35], v[232:235], v[80:83]
    ds_read_b64_tr_b16 v[44:45], v2 offset:33792
    v_cvt_pk_bf16_f32 v75, v78, v79
    v_mfma_f32_16x16x32_bf16 v[88:91], v[32:35], v[236:239], v[88:91]
    ds_read_b64_tr_b16 v[46:47], v2 offset:34304
    s_add_u32 s59, s57, 16640
    s_waitcnt lgkmcnt(4)
    v_mfma_f32_16x16x32_bf16 v[84:87], v[36:39], v[232:235], v[84:87]
    ds_read_b64_tr_b16 v[32:33], v1 offset:41984
    v_permlane16_swap_b32 v72, v74
    v_mfma_f32_16x16x32_bf16 v[92:95], v[36:39], v[236:239], v[92:95]
    ds_read_b64_tr_b16 v[34:35], v1 offset:42496
    v_permlane16_swap_b32 v73, v75
    s_waitcnt lgkmcnt(4)
    v_mfma_f32_16x16x32_bf16 v[80:83], v[40:43], v[240:243], v[80:83]
    ds_read_b64_tr_b16 v[36:37], v2 offset:41984
    buffer_store_dwordx4 v[72:75], v19, s[20:23], s59 offen sc1
    v_mfma_f32_16x16x32_bf16 v[88:91], v[40:43], v[244:247], v[88:91]
    ds_read_b64_tr_b16 v[38:39], v2 offset:42496
    s_nop 1
L_tjB:
    s_waitcnt lgkmcnt(4)
    v_mfma_f32_16x16x32_bf16 v[84:87], v[44:47], v[240:243], v[84:87]
    v_mfma_f32_16x16x32_bf16 v[92:95], v[44:47], v[244:247], v[92:95]
    s_waitcnt vmcnt(6) lgkmcnt(0)
    s_barrier
    s_add_u32 m0, s50, 32768
    s_nop 0
    buffer_load_dwordx4 v4, s[12:15], s49 offen lds
    s_add_u32 m0, s50, 33792
    s_nop 0
    buffer_load_dwordx4 v5, s[16:19], s49 offen lds
    s_add_u32 s49, s49, 196608
    ds_read_b64_tr_b16 v[40:41], v1 offset:49152
    ds_read_b64_tr_b16 v[42:43], v1 offset:49664
    v_mfma_f32_16x16x32_bf16 v[80:83], v[32:35], v[248:251], v[80:83]
    ds_read_b64_tr_b16 v[44:45], v2 offset:49152
    v_mfma_f32_16x16x32_bf16 v[88:91], v[32:35], v[252:255], v[88:91]
    ds_read_b64_tr_b16 v[46:47], v2 offset:49664
    v_mfma_f32_16x16x32_bf16 v[84:87], v[36:39], v[248:251], v[84:87]
    ds_read_b64_tr_b16 v[32:33], v1 offset:50176
    v_mfma_f32_16x16x32_bf16 v[92:95], v[36:39], v[252:255], v[92:95]
    ds_read_b64_tr_b16 v[34:35], v1 offset:50688
    s_waitcnt lgkmcnt(4)
    v_mfma_f32_16x16x32_bf16 v[48:51], v[40:43], v[96:99], 0
    ds_read_b64_tr_b16 v[36:37], v2 offset:50176
    v_mfma_f32_16x16x32_bf16 v[64:67], v[40:43], v[100:103], 0
    ds_read_b64_tr_b16 v[38:39], v2 offset:50688
    s_waitcnt lgkmcnt(4)
    v_mfma_f32_16x16x32_bf16 v[52:55], v[44:47], v[96:99], 0
    ds_read_b64_tr_b16 v[40:41], v1 offset:57344
    v_mfma_f32_16x16x32_bf16 v[68:71], v[44:47], v[100:103], 0
    ds_read_b64_tr_b16 v[42:43], v1 offset:57856
    s_waitcnt lgkmcnt(4)
    v_mfma_f32_16x16x32_bf16 v[56:59], v[32:35], v[96:99], 0
    ds_read_b64_tr_b16 v[44:45], v2 offset:57344
    v_mfma_f32_16x16x32_bf16 v[72:75], v[32:35], v[100:103], 0
    ds_read_b64_tr_b16 v[46:47], v2 offset:57856
    s_waitcnt lgkmcnt(4)
    v_mfma_f32_16x16x32_bf16 v[60:63], v[36:39], v[96:99], 0
    ds_read_b64_tr_b16 v[32:33], v1 offset:58368
    v_mfma_f32_16x16x32_bf16 v[76:79], v[36:39], v[100:103], 0
    ds_read_b64_tr_b16 v[34:35], v1 offset:58880
    s_waitcnt lgkmcnt(4)
    v_mfma_f32_16x16x32_bf16 v[48:51], v[40:43], v[104:107], v[48:51]
    ds_read_b64_tr_b16 v[36:37], v2 offset:58368
    v_mfma_f32_16x16x32_bf16 v[64:67], v[40:43], v[108:111], v[64:67]
    ds_read_b64_tr_b16 v[38:39], v2 offset:58880
    s_waitcnt lgkmcnt(4)
    v_mfma_f32_16x16x32_bf16 v[52:55], v[44:47], v[104:107], v[52:55]
    v_mfma_f32_16x16x32_bf16 v[68:71], v[44:47], v[108:111], v[68:71]
    s_waitcnt vmcnt(5) lgkmcnt(0)
    s_barrier
    s_add_u32 m0, s50, 49152
    s_nop 0
    buffer_load_dwordx4 v4, s[12:15], s49 offen lds
    s_add_u32 m0, s50, 50176
    s_nop 0
    buffer_load_dwordx4 v5, s[16:19], s49 offen lds
    s_add_u32 s49, s49, 196608
    ds_read_b64_tr_b16 v[40:41], v1 offset:0
    ds_read_b64_tr_b16 v[42:43], v1 offset:512
    s_lshl_b32 s60, s47, 10
    s_add_u32 m0, s60, 138240
    s_mul_i32 s59, s45, 10240
    s_add_u32 s59, s59, s60
    s_add_u32 s59, s59, 135168
    v_mfma_f32_16x16x32_bf16 v[56:59], v[32:35], v[104:107], v[56:59]
    ds_read_b64_tr_b16 v[44:45], v2 offset:0
    buffer_load_dwordx4 v6, s[20:23], s59 offen sc1 lds
    v_mul_f32 v30, 0xbf317218, v16
    v_mfma_f32_16x16x32_bf16 v[72:75], v[32:35], v[108:111], v[72:75]
    ds_read_b64_tr_b16 v[46:47], v2 offset:512
    v_mul_f32 v80, v30, v80
    v_mul_f32 v81, v30, v81
    v_mfma_f32_16x16x32_bf16 v[60:63], v[36:39], v[104:107], v[60:63]
    ds_read_b64_tr_b16 v[32:33], v1 offset:1024
    v_mul_f32 v82, v30, v82
    v_mul_f32 v83, v30, v83
    v_mul_f32 v84, v30, v84
    v_mfma_f32_16x16x32_bf16 v[76:79], v[36:39], v[108:111], v[76:79]
    ds_read_b64_tr_b16 v[34:35], v1 offset:1536
    v_mul_f32 v85, v30, v85
    v_mul_f32 v86, v30, v86
    s_waitcnt lgkmcnt(4)
    v_mfma_f32_16x16x32_bf16 v[48:51], v[40:43], v[112:115], v[48:51]
    ds_read_b64_tr_b16 v[36:37], v2 offset:1024
    v_mul_f32 v87, v30, v87
    v_cvt_pk_bf16_f32 v80, v80, v81
    v_cvt_pk_bf16_f32 v81, v82, v83
    v_mfma_f32_16x16x32_bf16 v[64:67], v[40:43], v[116:119], v[64:67]
    ds_read_b64_tr_b16 v[38:39], v2 offset:1536
    v_cvt_pk_bf16_f32 v82, v84, v85
    v_cvt_pk_bf16_f32 v83, v86, v87
    s_waitcnt lgkmcnt(4)
    v_mfma_f32_16x16x32_bf16 v[52:55], v[44:47], v[112:115], v[52:55]
    ds_read_b64_tr_b16 v[40:41], v1 offset:8192
    s_add_u32 s59, s3, 0
    v_permlane16_swap_b32 v80, v82
    v_permlane16_swap_b32 v81, v83
    v_mfma_f32_16x16x32_bf16 v[68:71], v[44:47], v[116:119], v[68:71]
    ds_read_b64_tr_b16 v[42:43], v1 offset:8704
    buffer_store_dwordx4 v[80:83], v19, s[20:23], s59 offen sc1
    v_mul_f32 v30, 0xbf317218, v17
    s_waitcnt lgkmcnt(4)
    v_mfma_f32_16x16x32_bf16 v[56:59], v[32:35], v[112:115], v[56:59]
    ds_read_b64_tr_b16 v[44:45], v2 offset:8192
    v_mul_f32 v88, v30, v88
    v_mul_f32 v89, v30, v89
    v_mfma_f32_16x16x32_bf16 v[72:75], v[32:35], v[116:119], v[72:75]
    ds_read_b64_tr_b16 v[46:47], v2 offset:8704
    v_mul_f32 v90, v30, v90
    v_mul_f32 v91, v30, v91
    v_mul_f32 v92, v30, v92
    s_waitcnt lgkmcnt(4)
    v_mfma_f32_16x16x32_bf16 v[60:63], v[36:39], v[112:115], v[60:63]
    ds_read_b64_tr_b16 v[32:33], v1 offset:9216
    v_mul_f32 v93, v30, v93
    v_mul_f32 v94, v30, v94
    v_mfma_f32_16x16x32_bf16 v[76:79], v[36:39], v[116:119], v[76:79]
    ds_read_b64_tr_b16 v[34:35], v1 offset:9728
    v_mul_f32 v95, v30, v95
    v_cvt_pk_bf16_f32 v88, v88, v89
    v_cvt_pk_bf16_f32 v89, v90, v91
    s_waitcnt lgkmcnt(4)
    v_mfma_f32_16x16x32_bf16 v[48:51], v[40:43], v[120:123], v[48:51]
    ds_read_b64_tr_b16 v[36:37], v2 offset:9216
    v_cvt_pk_bf16_f32 v90, v92, v93
    v_cvt_pk_bf16_f32 v91, v94, v95
    v_mfma_f32_16x16x32_bf16 v[64:67], v[40:43], v[124:127], v[64:67]
    ds_read_b64_tr_b16 v[38:39], v2 offset:9728
    s_add_u32 s59, s3, 256
    v_permlane16_swap_b32 v88, v90
    v_permlane16_swap_b32 v89, v91
    s_waitcnt lgkmcnt(4)
    v_mfma_f32_16x16x32_bf16 v[52:55], v[44:47], v[120:123], v[52:55]
    buffer_store_dwordx4 v[88:91], v19, s[20:23], s59 offen sc1
    v_mfma_f32_16x16x32_bf16 v[68:71], v[44:47], v[124:127], v[68:71]
    s_waitcnt vmcnt(8) lgkmcnt(0)
    s_barrier
    s_add_u32 m0, s50, 0
    s_nop 0
    buffer_load_dwordx4 v4, s[12:15], s49 offen lds
    s_add_u32 m0, s50, 1024
    s_nop 0
    buffer_load_dwordx4 v5, s[16:19], s49 offen lds
    s_add_u32 s49, s49, 196608
    ds_read_b64_tr_b16 v[40:41], v1 offset:16384
    ds_read_b64_tr_b16 v[42:43], v1 offset:16896
    s_mul_i32 s59, s46, 48
    v_add_u32 v30, s59, v0
    s_sub_i32 s59, 2, s69
    v_mfma_f32_16x16x32_bf16 v[56:59], v[32:35], v[120:123], v[56:59]
    ds_read_b64_tr_b16 v[44:45], v2 offset:16384
    s_lshl_b32 s59, s59, 7
    v_cmp_le_i32 vcc, s59, v30
    v_mfma_f32_16x16x32_bf16 v[72:75], v[32:35], v[124:127], v[72:75]
    ds_read_b64_tr_b16 v[46:47], v2 offset:16896
    v_mov_b32 v21, 0x3f80
    v_lshlrev_b32 v31, 4, v30
    v_mfma_f32_16x16x32_bf16 v[60:63], v[36:39], v[120:123], v[60:63]
    ds_read_b64_tr_b16 v[32:33], v1 offset:17408
    v_cndmask_b32 v20, 0, v21, vcc
    v_lshrrev_b32 v22, 7, v30
    v_mfma_f32_16x16x32_bf16 v[76:79], v[36:39], v[124:127], v[76:79]
    ds_read_b64_tr_b16 v[34:35], v1 offset:17920
    v_mul_u32_u24 v22, 489472, v22
    v_add_u32 v22, v22, v31
    s_waitcnt lgkmcnt(4)
    v_mfma_f32_16x16x32_bf16 v[48:51], v[40:43], v[128:131], v[48:51]
    ds_read_b64_tr_b16 v[36:37], v2 offset:17408
    v_mov_b32 v23, 2130706432
    v_mfma_f32_16x16x32_bf16 v[64:67], v[40:43], v[132:135], v[64:67]
    ds_read_b64_tr_b16 v[38:39], v2 offset:17920
    v_cndmask_b32 v28, v23, v22, vcc
    s_mov_b32 vcc_lo, 0x11111111
    s_mov_b32 vcc_hi, 0x11111111
    s_waitcnt lgkmcnt(4)
    v_mfma_f32_16x16x32_bf16 v[52:55], v[44:47], v[128:131], v[52:55]
    ds_read_b64_tr_b16 v[40:41], v1 offset:24576
    v_cndmask_b32 v20, 0, v20, vcc
    v_mov_b32 v21, 0
    v_mfma_f32_16x16x32_bf16 v[68:71], v[44:47], v[132:135], v[68:71]
    ds_read_b64_tr_b16 v[42:43], v1 offset:25088
    v_mov_b32 v22, v20
    s_waitcnt lgkmcnt(4)
    v_mfma_f32_16x16x32_bf16 v[56:59], v[32:35], v[128:131], v[56:59]
    ds_read_b64_tr_b16 v[44:45], v2 offset:24576
    v_mov_b32 v23, 0
    v_add_u32 v31, 127680, v31
    v_mfma_f32_16x16x32_bf16 v[72:75], v[32:35], v[132:135], v[72:75]
    ds_read_b64_tr_b16 v[46:47], v2 offset:25088
    ds_write_b128 v31, v[20:23]
    v_mov_b32 v30, 0
    s_waitcnt lgkmcnt(5)
    v_mfma_f32_16x16x32_bf16 v[60:63], v[36:39], v[128:131], v[60:63]
    ds_read_b64_tr_b16 v[32:33], v1 offset:25600
    v_lshlrev_b32 v31, 2, v0
    v_add_u32 v31, 162816, v31
    v_mfma_f32_16x16x32_bf16 v[76:79], v[36:39], v[132:135], v[76:79]
    ds_read_b64_tr_b16 v[34:35], v1 offset:26112
    ds_write_b32 v31, v30
    s_waitcnt lgkmcnt(6)
    v_mfma_f32_16x16x32_bf16 v[48:51], v[40:43], v[136:139], v[48:51]
    ds_read_b64_tr_b16 v[36:37], v2 offset:25600
    s_add_u32 s58, s42, 4096
    buffer_load_dwordx4 v[112:115], v6, s[20:23], s58 offen sc1
    v_mfma_f32_16x16x32_bf16 v[64:67], v[40:43], v[140:143], v[64:67]
    ds_read_b64_tr_b16 v[38:39], v2 offset:26112
    s_add_u32 s58, s42, 8192
    buffer_load_dwordx4 v[116:119], v6, s[20:23], s58 offen sc1
    s_waitcnt lgkmcnt(6)
    v_mfma_f32_16x16x32_bf16 v[52:55], v[44:47], v[136:139], v[52:55]
    v_mfma_f32_16x16x32_bf16 v[68:71], v[44:47], v[140:143], v[68:71]
    s_waitcnt vmcnt(4) lgkmcnt(0)
    s_barrier
    s_cmp_lg_u32 s47, 0
    s_cbranch_scc1 L_nf5
    v_mov_b32 v30, 3
    v_mov_b32 v31, 0
    s_mov_b64 exec, 1
    buffer_store_dword v30, v31, s[20:23], s52 offen sc1
    s_mov_b64 exec, -1
L_nf5:
    s_add_u32 m0, s50, 16384
    s_nop 0
    buffer_load_dwordx4 v4, s[12:15], s49 offen lds
    s_add_u32 m0, s50, 17408
    s_nop 0
    buffer_load_dwordx4 v5, s[16:19], s49 offen lds
    s_add_u32 s49, s49, 196608
    ds_read_b64_tr_b16 v[40:41], v1 offset:32768
    ds_read_b64_tr_b16 v[42:43], v1 offset:33280
    v_mov_b32 v30, 0xffff
    s_lshl_b32 s60, -1, 0
    v_mfma_f32_16x16x32_bf16 v[56:59], v[32:35], v[136:139], v[56:59]
    ds_read_b64_tr_b16 v[44:45], v2 offset:32768
    s_lshl_b32 s61, -1, 4
    v_cndmask_b32 v88, 0, v30, s[60:61]
    v_mfma_f32_16x16x32_bf16 v[72:75], v[32:35], v[140:143], v[72:75]
    ds_read_b64_tr_b16 v[46:47], v2 offset:33280
    s_lshl_b32 s60, -1, 1
    s_lshl_b32 s61, -1, 5
    v_cndmask_b32 v88, v88, -1, s[60:61]
    v_mfma_f32_16x16x32_bf16 v[60:63], v[36:39], v[136:139], v[60:63]
    ds_read_b64_tr_b16 v[32:33], v1 offset:33792
    s_lshl_b32 s60, -1, 2
    v_mfma_f32_16x16x32_bf16 v[76:79], v[36:39], v[140:143], v[76:79]
    ds_read_b64_tr_b16 v[34:35], v1 offset:34304
    s_lshl_b32 s61, -1, 6
    v_cndmask_b32 v89, 0, v30, s[60:61]
    s_waitcnt lgkmcnt(4)
    v_mfma_f32_16x16x32_bf16 v[48:51], v[40:43], v[144:147], v[48:51]
    ds_read_b64_tr_b16 v[36:37], v2 offset:33792
    s_lshl_b32 s60, -1, 3
    s_lshl_b32 s61, -1, 7
    v_cndmask_b32 v89, v89, -1, s[60:61]
    v_mfma_f32_16x16x32_bf16 v[64:67], v[40:43], v[148:151], v[64:67]
    ds_read_b64_tr_b16 v[38:39], v2 offset:34304
    s_lshl_b32 s60, -1, 8
    s_lshl_b32 s61, -1, 12
    s_waitcnt lgkmcnt(4)
    v_mfma_f32_16x16x32_bf16 v[52:55], v[44:47], v[144:147], v[52:55]
    ds_read_b64_tr_b16 v[40:41], v1 offset:40960
    v_cndmask_b32 v90, 0, v30, s[60:61]
    v_mfma_f32_16x16x32_bf16 v[68:71], v[44:47], v[148:151], v[68:71]
    ds_read_b64_tr_b16 v[42:43], v1 offset:41472
    s_lshl_b32 s60, -1, 9
    s_lshl_b32 s61, -1, 13
    v_cndmask_b32 v90, v90, -1, s[60:61]
    s_waitcnt lgkmcnt(4)
    v_mfma_f32_16x16x32_bf16 v[56:59], v[32:35], v[144:147], v[56:59]
    ds_read_b64_tr_b16 v[44:45], v2 offset:40960
    s_lshl_b32 s60, -1, 10
    s_lshl_b32 s61, -1, 14
    v_mfma_f32_16x16x32_bf16 v[72:75], v[32:35], v[148:151], v[72:75]
    ds_read_b64_tr_b16 v[46:47], v2 offset:41472
    v_cndmask_b32 v91, 0, v30, s[60:61]
    s_lshl_b32 s60, -1, 11
    s_waitcnt lgkmcnt(4)
    v_mfma_f32_16x16x32_bf16 v[60:63], v[36:39], v[144:147], v[60:63]
    ds_read_b64_tr_b16 v[32:33], v1 offset:41984
    s_lshl_b32 s61, -1, 15
    v_cndmask_b32 v91, v91, -1, s[60:61]
    v_mfma_f32_16x16x32_bf16 v[76:79], v[36:39], v[148:151], v[76:79]
    ds_read_b64_tr_b16 v[34:35], v1 offset:42496
    s_add_u32 s58, s42, 12288
    buffer_load_dwordx4 v[120:123], v6, s[20:23], s58 offen sc1
    s_waitcnt lgkmcnt(4)
    v_mfma_f32_16x16x32_bf16 v[48:51], v[40:43], v[152:155], v[48:51]
    ds_read_b64_tr_b16 v[36:37], v2 offset:41984
    v_mfma_f32_16x16x32_bf16 v[64:67], v[40:43], v[156:159], v[64:67]
    ds_read_b64_tr_b16 v[38:39], v2 offset:42496
    s_add_u32 s58, s42, 16384
    buffer_load_dwordx4 v[124:127], v6, s[20:23], s58 offen sc1
    s_waitcnt lgkmcnt(4)
    v_mfma_f32_16x16x32_bf16 v[52:55], v[44:47], v[152:155], v[52:55]
    v_mfma_f32_16x16x32_bf16 v[68:71], v[44:47], v[156:159], v[68:71]
    s_waitcnt lgkmcnt(0)
    s_barrier
    s_add_u32 m0, s50, 32768
    s_nop 0
    buffer_load_dwordx4 v4, s[12:15], s49 offen lds
    s_add_u32 m0, s50, 33792
    s_nop 0
    buffer_load_dwordx4 v5, s[16:19], s49 offen lds
    s_add_u32 s49, s49, 196608
    ds_read_b64_tr_b16 v[40:41], v1 offset:49152
    ds_read_b64_tr_b16 v[42:43], v1 offset:49664
    v_mov_b32 v30, 0xffff
    s_lshl_b32 s60, -1, 16
    v_mfma_f32_16x16x32_bf16 v[56:59], v[32:35], v[152:155], v[56:59]
    ds_read_b64_tr_b16 v[44:45], v2 offset:49152
    s_lshl_b32 s61, -1, 20
    v_cndmask_b32 v92, 0, v30, s[60:61]
    v_mfma_f32_16x16x32_bf16 v[72:75], v[32:35], v[156:159], v[72:75]
    ds_read_b64_tr_b16 v[46:47], v2 offset:49664
    s_lshl_b32 s60, -1, 17
    v_mfma_f32_16x16x32_bf16 v[60:63], v[36:39], v[152:155], v[60:63]
    v_add_u32 v29, v3, v1
    s_lshl_b32 s61, -1, 21
    v_cndmask_b32 v92, v92, -1, s[60:61]
    v_mfma_f32_16x16x32_bf16 v[76:79], v[36:39], v[156:159], v[76:79]
    ds_read_b64_tr_b16 v[32:33], v29 offset:4096
    s_lshl_b32 s60, -1, 18
    s_lshl_b32 s61, -1, 22
    s_waitcnt lgkmcnt(3)
    v_mfma_f32_16x16x32_bf16 v[48:51], v[40:43], v[160:163], v[48:51]
    v_add_u32 v29, v3, v2
    v_cndmask_b32 v93, 0, v30, s[60:61]
    v_mfma_f32_16x16x32_bf16 v[64:67], v[40:43], v[164:167], v[64:67]
    ds_read_b64_tr_b16 v[36:37], v29 offset:4096
    s_lshl_b32 s60, -1, 19
    s_lshl_b32 s61, -1, 23
    s_waitcnt lgkmcnt(2)
    v_mfma_f32_16x16x32_bf16 v[52:55], v[44:47], v[160:163], v[52:55]
    ds_read_b64_tr_b16 v[40:41], v1 offset:50176
    v_cndmask_b32 v93, v93, -1, s[60:61]
    v_mfma_f32_16x16x32_bf16 v[68:71], v[44:47], v[164:167], v[68:71]
    ds_read_b64_tr_b16 v[42:43], v1 offset:50688
    s_lshl_b32 s60, -1, 24
    s_lshl_b32 s61, -1, 28
    s_waitcnt lgkmcnt(3)
    v_mfma_f32_16x16x16_bf16 v[48:51], v[32:33], v[12:13], v[48:51]
    ds_read_b64_tr_b16 v[44:45], v2 offset:50176
    v_cndmask_b32 v94, 0, v30, s[60:61]
    s_lshl_b32 s60, -1, 25
    v_mfma_f32_16x16x16_bf16 v[64:67], v[32:33], v[14:15], v[64:67]
    ds_read_b64_tr_b16 v[46:47], v2 offset:50688
    s_lshl_b32 s61, -1, 29
    v_cndmask_b32 v94, v94, -1, s[60:61]
    s_waitcnt lgkmcnt(4)
    v_mfma_f32_16x16x16_bf16 v[52:55], v[36:37], v[12:13], v[52:55]
    ds_read_b64_tr_b16 v[32:33], v1 offset:57344
    s_lshl_b32 s60, -1, 26
    v_mfma_f32_16x16x16_bf16 v[68:71], v[36:37], v[14:15], v[68:71]
    ds_read_b64_tr_b16 v[34:35], v1 offset:57856
    s_lshl_b32 s61, -1, 30
    v_cndmask_b32 v95, 0, v30, s[60:61]
    s_waitcnt lgkmcnt(4)
    v_mfma_f32_16x16x32_bf16 v[56:59], v[40:43], v[160:163], v[56:59]
    ds_read_b64_tr_b16 v[36:37], v2 offset:57344
    s_lshl_b32 s60, -1, 27
    v_mfma_f32_16x16x32_bf16 v[72:75], v[40:43], v[164:167], v[72:75]
    ds_read_b64_tr_b16 v[38:39], v2 offset:57856
    s_lshl_b32 s61, -1, 31
    v_cndmask_b32 v95, v95, -1, s[60:61]
    s_waitcnt lgkmcnt(4)
    v_mfma_f32_16x16x32_bf16 v[60:63], v[44:47], v[160:163], v[60:63]
    ds_read_b64_tr_b16 v[40:41], v1 offset:58368
    s_add_u32 s58, s42, 20480
    buffer_load_dwordx4 v[128:131], v6, s[20:23], s58 offen sc1
    v_mfma_f32_16x16x32_bf16 v[76:79], v[44:47], v[164:167], v[76:79]
    ds_read_b64_tr_b16 v[42:43], v1 offset:58880
    s_waitcnt lgkmcnt(4)
    v_mfma_f32_16x16x32_bf16 v[48:51], v[32:35], v[168:171], v[48:51]
    ds_read_b64_tr_b16 v[44:45], v2 offset:58368
    s_add_u32 s58, s42, 24576
    v_mfma_f32_16x16x32_bf16 v[64:67], v[32:35], v[172:175], v[64:67]
    ds_read_b64_tr_b16 v[46:47], v2 offset:58880
    buffer_load_dwordx4 v[132:135], v6, s[20:23], s58 offen sc1
    s_waitcnt lgkmcnt(4)
    v_mfma_f32_16x16x32_bf16 v[52:55], v[36:39], v[168:171], v[52:55]
    v_mfma_f32_16x16x32_bf16 v[68:71], v[36:39], v[172:175], v[68:71]
    s_waitcnt vmcnt(10) lgkmcnt(0)
    s_barrier
    s_add_u32 m0, s50, 49152
    s_nop 0
    buffer_load_dwordx4 v4, s[12:15], s49 offen lds
    s_add_u32 m0, s50, 50176
    s_nop 0
    buffer_load_dwordx4 v5, s[16:19], s49 offen lds
    s_add_u32 s49, s49, 196608
    ds_read_b64_tr_b16 v[32:33], v1 offset:0
    ds_read_b64_tr_b16 v[34:35], v1 offset:512
    s_add_u32 s58, s42, 28672
    v_mfma_f32_16x16x32_bf16 v[56:59], v[40:43], v[168:171], v[56:59]
    ds_read_b64_tr_b16 v[36:37], v2 offset:0
    v_mfma_f32_16x16x32_bf16 v[72:75], v[40:43], v[172:175], v[72:75]
    ds_read_b64_tr_b16 v[38:39], v2 offset:512
    buffer_load_dwordx4 v[136:139], v6, s[20:23], s58 offen sc1
    v_mfma_f32_16x16x32_bf16 v[60:63], v[44:47], v[168:171], v[60:63]
    v_add_u32 v29, v3, v1
    v_mfma_f32_16x16x32_bf16 v[76:79], v[44:47], v[172:175], v[76:79]
    ds_read_b64_tr_b16 v[40:41], v29 offset:6144
    s_waitcnt lgkmcnt(3)
    v_mfma_f32_16x16x32_bf16 v[48:51], v[32:35], v[176:179], v[48:51]
    v_add_u32 v29, v3, v2
    v_mfma_f32_16x16x32_bf16 v[64:67], v[32:35], v[180:183], v[64:67]
    ds_read_b64_tr_b16 v[44:45], v29 offset:6144
    s_waitcnt lgkmcnt(2)
    v_mfma_f32_16x16x32_bf16 v[52:55], v[36:39], v[176:179], v[52:55]
    ds_read_b64_tr_b16 v[32:33], v1 offset:1024
    v_mfma_f32_16x16x32_bf16 v[68:71], v[36:39], v[180:183], v[68:71]
    ds_read_b64_tr_b16 v[34:35], v1 offset:1536
    s_waitcnt lgkmcnt(3)
    v_mfma_f32_16x16x16_bf16 v[56:59], v[40:41], v[12:13], v[56:59]
    ds_read_b64_tr_b16 v[36:37], v2 offset:1024
    v_mfma_f32_16x16x16_bf16 v[72:75], v[40:41], v[14:15], v[72:75]
    ds_read_b64_tr_b16 v[38:39], v2 offset:1536
    s_add_u32 s58, s42, 32768
    s_waitcnt lgkmcnt(4)
    v_mfma_f32_16x16x16_bf16 v[60:63], v[44:45], v[12:13], v[60:63]
    ds_read_b64_tr_b16 v[40:41], v1 offset:8192
    v_mfma_f32_16x16x16_bf16 v[76:79], v[44:45], v[14:15], v[76:79]
    ds_read_b64_tr_b16 v[42:43], v1 offset:8704
    buffer_load_dwordx4 v[140:143], v6, s[20:23], s58 offen sc1
    s_waitcnt lgkmcnt(4)
    v_mfma_f32_16x16x32_bf16 v[56:59], v[32:35], v[176:179], v[56:59]
    ds_read_b64_tr_b16 v[44:45], v2 offset:8192
    v_mfma_f32_16x16x32_bf16 v[72:75], v[32:35], v[180:183], v[72:75]
    ds_read_b64_tr_b16 v[46:47], v2 offset:8704
    s_waitcnt lgkmcnt(4)
    v_mfma_f32_16x16x32_bf16 v[60:63], v[36:39], v[176:179], v[60:63]
    ds_read_b64_tr_b16 v[32:33], v1 offset:9216
    v_mfma_f32_16x16x32_bf16 v[76:79], v[36:39], v[180:183], v[76:79]
    ds_read_b64_tr_b16 v[34:35], v1 offset:9728
    s_waitcnt lgkmcnt(4)
    v_mfma_f32_16x16x32_bf16 v[48:51], v[40:43], v[184:187], v[48:51]
    ds_read_b64_tr_b16 v[36:37], v2 offset:9216
    v_mfma_f32_16x16x32_bf16 v[64:67], v[40:43], v[188:191], v[64:67]
    ds_read_b64_tr_b16 v[38:39], v2 offset:9728
    s_waitcnt lgkmcnt(4)
    v_mfma_f32_16x16x32_bf16 v[52:55], v[44:47], v[184:187], v[52:55]
    v_mfma_f32_16x16x32_bf16 v[68:71], v[44:47], v[188:191], v[68:71]
    s_waitcnt vmcnt(10) lgkmcnt(0)
    s_barrier
    s_add_u32 m0, s50, 0
    s_nop 0
    buffer_load_dwordx4 v4, s[12:15], s49 offen lds
    s_add_u32 m0, s50, 1024
    s_nop 0
    buffer_load_dwordx4 v5, s[16:19], s49 offen lds
    s_add_u32 s49, s49, 196608
    ds_read_b64_tr_b16 v[40:41], v1 offset:16384
    ds_read_b64_tr_b16 v[42:43], v1 offset:16896
    v_and_b32 v20, 31, v0
    v_lshrrev_b32 v21, 5, v0
    v_mfma_f32_16x16x32_bf16 v[56:59], v[32:35], v[184:187], v[56:59]
    ds_read_b64_tr_b16 v[44:45], v2 offset:16384
    s_lshl_b32 s58, s47, 9
    v_mfma_f32_16x16x32_bf16 v[72:75], v[32:35], v[188:191], v[72:75]
    ds_read_b64_tr_b16 v[46:47], v2 offset:16896
    s_add_u32 s60, s58, 84160
    v_mul_u32_u24 v86, 6208, v21
    v_mfma_f32_16x16x32_bf16 v[60:63], v[36:39], v[184:187], v[60:63]
    ds_read_b64_tr_b16 v[32:33], v1 offset:17408
    v_lshl_add_u32 v86, v20, 4, v86
    v_mfma_f32_16x16x32_bf16 v[76:79], v[36:39], v[188:191], v[76:79]
    ds_read_b64_tr_b16 v[34:35], v1 offset:17920
    v_add_u32 v86, s60, v86
    s_waitcnt lgkmcnt(4)
    v_mfma_f32_16x16x32_bf16 v[48:51], v[40:43], v[192:195], v[48:51]
    ds_read_b64_tr_b16 v[36:37], v2 offset:17408
    s_add_u32 s61, s58, 77960
    v_lshl_add_u32 v87, v20, 4, s61
    v_mfma_f32_16x16x32_bf16 v[64:67], v[40:43], v[196:199], v[64:67]
    ds_read_b64_tr_b16 v[38:39], v2 offset:17920
    s_lshl2_add_u32 s58, s69, s47
    s_waitcnt lgkmcnt(4)
    v_mfma_f32_16x16x32_bf16 v[52:55], v[44:47], v[192:195], v[52:55]
    ds_read_b64_tr_b16 v[40:41], v1 offset:24576
    s_lshr_b32 s59, s70, 2
    s_lshl3_add_u32 s58, s58, s59
    v_mfma_f32_16x16x32_bf16 v[68:71], v[44:47], v[196:199], v[68:71]
    ds_read_b64_tr_b16 v[42:43], v1 offset:25088
    s_mul_i32 s58, s58, 5120
    s_add_u32 s58, s58, 16777728
    s_and_b32 s59, s70, 3
    s_waitcnt lgkmcnt(4)
    v_mfma_f32_16x16x32_bf16 v[56:59], v[32:35], v[192:195], v[56:59]
    ds_read_b64_tr_b16 v[44:45], v2 offset:24576
    s_lshl_b32 s60, s59, 10
    s_add_u32 s57, s58, s60
    v_mfma_f32_16x16x32_bf16 v[72:75], v[32:35], v[196:199], v[72:75]
    ds_read_b64_tr_b16 v[46:47], v2 offset:25088
    s_lshl_b32 s60, s59, 7
    s_add_u32 s3, s58, s60
    s_waitcnt lgkmcnt(4)
    v_mfma_f32_16x16x32_bf16 v[60:63], v[36:39], v[192:195], v[60:63]
    ds_read_b64_tr_b16 v[32:33], v1 offset:25600
    s_add_u32 s3, s3, 4096
    s_add_u32 s58, s42, 36864
    v_mfma_f32_16x16x32_bf16 v[76:79], v[36:39], v[196:199], v[76:79]
    ds_read_b64_tr_b16 v[34:35], v1 offset:26112
    buffer_load_dwordx4 v[144:147], v6, s[20:23], s58 offen sc1
    s_waitcnt lgkmcnt(4)
    v_mfma_f32_16x16x32_bf16 v[48:51], v[40:43], v[200:203], v[48:51]
    ds_read_b64_tr_b16 v[36:37], v2 offset:25600
    s_add_u32 s58, s42, 40960
    v_mfma_f32_16x16x32_bf16 v[64:67], v[40:43], v[204:207], v[64:67]
    ds_read_b64_tr_b16 v[38:39], v2 offset:26112
    buffer_load_dwordx4 v[148:151], v6, s[20:23], s58 offen sc1
    s_waitcnt lgkmcnt(4)
    v_mfma_f32_16x16x32_bf16 v[52:55], v[44:47], v[200:203], v[52:55]
    v_mfma_f32_16x16x32_bf16 v[68:71], v[44:47], v[204:207], v[68:71]
    s_waitcnt vmcnt(10)
    s_barrier
    ds_read_b64_tr_b16 v[40:41], v1 offset:32768
    ds_read_b64_tr_b16 v[42:43], v1 offset:33280
    v_lshrrev_b32 v21, 5, v0
    s_lshl_b32 s58, s47, 9
    v_bfe_u32 v20, v0, 2, 2
    s_waitcnt lgkmcnt(4)
    v_mfma_f32_16x16x32_bf16 v[56:59], v[32:35], v[200:203], v[56:59]
    ds_read_b64_tr_b16 v[44:45], v2 offset:32768
    v_lshl_add_u32 v20, v21, 2, v20
    v_mfma_f32_16x16x32_bf16 v[72:75], v[32:35], v[204:207], v[72:75]
    ds_read_b64_tr_b16 v[46:47], v2 offset:33280
    v_lshlrev_b32 v20, 4, v20
    v_and_b32 v3, 1, v0
    s_waitcnt lgkmcnt(4)
    v_mfma_f32_16x16x32_bf16 v[60:63], v[36:39], v[200:203], v[60:63]
    ds_read_b64_tr_b16 v[32:33], v1 offset:33792
    v_mul_u32_u24 v3, 6208, v3
    v_mfma_f32_16x16x32_bf16 v[76:79], v[36:39], v[204:207], v[76:79]
    ds_read_b64_tr_b16 v[34:35], v1 offset:34304
    v_and_b32 v22, 2, v0
    v_lshl_add_u32 v3, v22, 2, v3
    s_waitcnt lgkmcnt(4)
    v_mfma_f32_16x16x32_bf16 v[48:51], v[40:43], v[208:211], v[48:51]
    ds_read_b64_tr_b16 v[36:37], v2 offset:33792
    s_add_u32 s59, s58, 115200
    v_add3_u32 v3, v3, v20, s59
    v_mfma_f32_16x16x32_bf16 v[64:67], v[40:43], v[212:215], v[64:67]
    ds_read_b64_tr_b16 v[38:39], v2 offset:34304
    s_add_u32 s60, s58, 109000
    v_add_u32 v20, s60, v20
    s_waitcnt lgkmcnt(4)
    v_mfma_f32_16x16x32_bf16 v[52:55], v[44:47], v[208:211], v[52:55]
    ds_read_b64_tr_b16 v[40:41], v1 offset:40960
    s_mov_b32 vcc_lo, 0x33330000
    s_mov_b32 vcc_hi, 0x33330000
    v_mfma_f32_16x16x32_bf16 v[68:71], v[44:47], v[212:215], v[68:71]
    ds_read_b64_tr_b16 v[42:43], v1 offset:41472
    v_cndmask_b32 v3, v3, v20, vcc
    s_add_u32 s59, s58, 127680
    s_waitcnt lgkmcnt(4)
    v_mfma_f32_16x16x32_bf16 v[56:59], v[32:35], v[208:211], v[56:59]
    ds_read_b64_tr_b16 v[44:45], v2 offset:40960
    v_lshl_add_u32 v20, v21, 6, s59
    s_lshl_b64 vcc, vcc, 2
    v_mfma_f32_16x16x32_bf16 v[72:75], v[32:35], v[212:215], v[72:75]
    ds_read_b64_tr_b16 v[46:47], v2 offset:41472
    v_cndmask_b32 v3, v3, v20, vcc
    v_add_u32 v20, 16, v20
    s_waitcnt lgkmcnt(4)
    v_mfma_f32_16x16x32_bf16 v[60:63], v[36:39], v[208:211], v[60:63]
    ds_read_b64_tr_b16 v[32:33], v1 offset:41984
    s_mov_b32 vcc_lo, 0x22220000
    s_mov_b32 vcc_hi, 0x22220000
    v_mfma_f32_16x16x32_bf16 v[76:79], v[36:39], v[212:215], v[76:79]
    ds_read_b64_tr_b16 v[34:35], v1 offset:42496
    v_cndmask_b32 v3, v3, v20, vcc
    s_add_u32 s58, s42, 45056
    s_waitcnt lgkmcnt(4)
    v_mfma_f32_16x16x32_bf16 v[48:51], v[40:43], v[216:219], v[48:51]
    ds_read_b64_tr_b16 v[36:37], v2 offset:41984
    buffer_load_dwordx4 v[152:155], v6, s[20:23], s58 offen sc1
    v_mfma_f32_16x16x32_bf16 v[64:67], v[40:43], v[220:223], v[64:67]
    ds_read_b64_tr_b16 v[38:39], v2 offset:42496
    s_add_u32 s58, s42, 49152
    buffer_load_dwordx4 v[156:159], v6, s[20:23], s58 offen sc1
    s_waitcnt lgkmcnt(4)
    v_mfma_f32_16x16x32_bf16 v[52:55], v[44:47], v[216:219], v[52:55]
    v_mfma_f32_16x16x32_bf16 v[68:71], v[44:47], v[220:223], v[68:71]
    s_waitcnt vmcnt(8)
    s_barrier
    s_add_u32 m0, s82, 65536
    s_add_u32 s59, s81, 229376
    s_mov_b32 exec_hi, 0xffff
    buffer_load_dwordx4 v28, s[20:23], s59 offen sc1 lds
    s_mov_b32 exec_hi, -1
    s_add_u32 m0, s82, 71744
    s_add_u32 s59, s81, 231424
    s_mov_b32 exec_hi, 0xffff
    buffer_load_dwordx4 v28, s[20:23], s59 offen sc1 lds
    s_mov_b32 exec_hi, -1
    s_add_u32 m0, s82, 77952
    s_add_u32 s59, s81, 233472
    s_mov_b32 exec_hi, 0xffff
    buffer_load_dwordx4 v28, s[20:23], s59 offen sc1 lds
    s_mov_b32 exec_hi, -1
    s_add_u32 m0, s82, 84160
    s_add_u32 s59, s81, 235520
    s_mov_b32 exec_hi, 0xffff
    buffer_load_dwordx4 v28, s[20:23], s59 offen sc1 lds
    s_mov_b32 exec_hi, -1
    s_add_u32 m0, s82, 90368
    s_add_u32 s59, s81, 237568
    s_mov_b32 exec_hi, 0xffff
    buffer_load_dwordx4 v28, s[20:23], s59 offen sc1 lds
    s_mov_b32 exec_hi, -1
    ds_read_b64_tr_b16 v[40:41], v1 offset:49152
    ds_read_b64_tr_b16 v[42:43], v1 offset:49664
    v_lshrrev_b32 v21, 5, v0
    s_waitcnt lgkmcnt(4)
    v_mfma_f32_16x16x32_bf16 v[56:59], v[32:35], v[216:219], v[56:59]
    ds_read_b64_tr_b16 v[44:45], v2 offset:49152
    v_mfma_f32_16x16x32_bf16 v[72:75], v[32:35], v[220:223], v[72:75]
    ds_read_b64_tr_b16 v[46:47], v2 offset:49664
    v_bfe_u32 v20, v0, 4, 1
    s_waitcnt lgkmcnt(4)
    v_mfma_f32_16x16x32_bf16 v[60:63], v[36:39], v[216:219], v[60:63]
    ds_read_b64_tr_b16 v[32:33], v1 offset:50176
    v_mfma_f32_16x16x32_bf16 v[76:79], v[36:39], v[220:223], v[76:79]
    ds_read_b64_tr_b16 v[34:35], v1 offset:50688
    v_mul_u32_u24 v20, 20480, v20
    s_waitcnt lgkmcnt(4)
    v_mfma_f32_16x16x32_bf16 v[48:51], v[40:43], v[224:227], v[48:51]
    ds_read_b64_tr_b16 v[36:37], v2 offset:50176
    v_mfma_f32_16x16x32_bf16 v[64:67], v[40:43], v[228:231], v[64:67]
    ds_read_b64_tr_b16 v[38:39], v2 offset:50688
    v_and_b32 v22, 15, v0
    s_waitcnt lgkmcnt(4)
    v_mfma_f32_16x16x32_bf16 v[52:55], v[44:47], v[224:227], v[52:55]
    ds_read_b64_tr_b16 v[40:41], v1 offset:57344
    v_mfma_f32_16x16x32_bf16 v[68:71], v[44:47], v[228:231], v[68:71]
    ds_read_b64_tr_b16 v[42:43], v1 offset:57856
    v_lshl_add_u32 v4, v22, 4, v20
    s_waitcnt lgkmcnt(4)
    v_mfma_f32_16x16x32_bf16 v[56:59], v[32:35], v[224:227], v[56:59]
    ds_read_b64_tr_b16 v[44:45], v2 offset:57344
    v_mfma_f32_16x16x32_bf16 v[72:75], v[32:35], v[228:231], v[72:75]
    ds_read_b64_tr_b16 v[46:47], v2 offset:57856
    v_lshl_add_u32 v4, v21, 8, v4
    s_waitcnt lgkmcnt(4)
    v_mfma_f32_16x16x32_bf16 v[60:63], v[36:39], v[224:227], v[60:63]
    ds_read_b64_tr_b16 v[32:33], v1 offset:58368
    v_mfma_f32_16x16x32_bf16 v[76:79], v[36:39], v[228:231], v[76:79]
    ds_read_b64_tr_b16 v[34:35], v1 offset:58880
    v_lshl_add_u32 v5, v22, 3, v20
    s_waitcnt lgkmcnt(4)
    v_mfma_f32_16x16x32_bf16 v[48:51], v[40:43], v[232:235], v[48:51]
    ds_read_b64_tr_b16 v[36:37], v2 offset:58368
    v_mfma_f32_16x16x32_bf16 v[64:67], v[40:43], v[236:239], v[64:67]
    ds_read_b64_tr_b16 v[38:39], v2 offset:58880
    v_lshl_add_u32 v5, v21, 30, v5
    s_waitcnt lgkmcnt(4)
    v_mfma_f32_16x16x32_bf16 v[52:55], v[44:47], v[232:235], v[52:55]
    v_mfma_f32_16x16x32_bf16 v[68:71], v[44:47], v[236:239], v[68:71]
    s_waitcnt vmcnt(9)
    s_barrier
    s_add_u32 m0, s82, 96576
    s_add_u32 s59, s81, 393216
    s_mov_b32 exec_hi, 0xffff
    buffer_load_dwordx4 v28, s[20:23], s59 offen sc1 lds
    s_mov_b32 exec_hi, -1
    s_add_u32 m0, s82, 102784
    s_add_u32 s59, s81, 395264
    s_mov_b32 exec_hi, 0xffff
    buffer_load_dwordx4 v28, s[20:23], s59 offen sc1 lds
    s_mov_b32 exec_hi, -1
    s_add_u32 m0, s82, 108992
    s_add_u32 s59, s81, 397312
    s_mov_b32 exec_hi, 0xffff
    buffer_load_dwordx4 v28, s[20:23], s59 offen sc1 lds
    s_mov_b32 exec_hi, -1
    s_add_u32 m0, s82, 115200
    s_add_u32 s59, s81, 399360
    s_mov_b32 exec_hi, 0xffff
    buffer_load_dwordx4 v28, s[20:23], s59 offen sc1 lds
    s_mov_b32 exec_hi, -1
    s_add_u32 m0, s82, 121408
    s_add_u32 s59, s81, 401408
    s_mov_b32 exec_hi, 0xffff
    buffer_load_dwordx4 v28, s[20:23], s59 offen sc1 lds
    s_mov_b32 exec_hi, -1
    s_lshl_b32 s59, s47, 9
    s_add_u32 s59, s59, s81
    s_add_u32 s60, s59, 1054720
    s_add_u32 s59, s59, 1052680
    v_lshrrev_b32 v30, 5, v0
    v_and_b32 v19, 0x1f0, v6
    v_lshl_add_u32 v19, v30, 11, v19
    v_lshl_add_u32 v30, v30, 30, v19
    buffer_load_dwordx4 v[80:83], v19, s[20:23], s60 offen sc1
    buffer_load_dwordx2 v[84:85], v30, s[20:23], s59 offen sc1
    ds_read_b64_tr_b16 v[40:41], v1 offset:0
    ds_read_b64_tr_b16 v[42:43], v1 offset:512
    s_waitcnt lgkmcnt(4)
    v_mfma_f32_16x16x32_bf16 v[56:59], v[32:35], v[232:235], v[56:59]
    ds_read_b64_tr_b16 v[44:45], v2 offset:0
    v_mfma_f32_16x16x32_bf16 v[72:75], v[32:35], v[236:239], v[72:75]
    ds_read_b64_tr_b16 v[46:47], v2 offset:512
    s_waitcnt lgkmcnt(4)
    v_mfma_f32_16x16x32_bf16 v[60:63], v[36:39], v[232:235], v[60:63]
    ds_read_b64_tr_b16 v[32:33], v1 offset:1024
    v_mfma_f32_16x16x32_bf16 v[76:79], v[36:39], v[236:239], v[76:79]
    ds_read_b64_tr_b16 v[34:35], v1 offset:1536
    s_waitcnt lgkmcnt(4)
    v_mfma_f32_16x16x32_bf16 v[48:51], v[40:43], v[240:243], v[48:51]
    ds_read_b64_tr_b16 v[36:37], v2 offset:1024
    v_mfma_f32_16x16x32_bf16 v[64:67], v[40:43], v[244:247], v[64:67]
    ds_read_b64_tr_b16 v[38:39], v2 offset:1536
    s_waitcnt lgkmcnt(4)
    v_mfma_f32_16x16x32_bf16 v[52:55], v[44:47], v[240:243], v[52:55]
    ds_read_b64_tr_b16 v[40:41], v1 offset:8192
    v_mfma_f32_16x16x32_bf16 v[68:71], v[44:47], v[244:247], v[68:71]
    ds_read_b64_tr_b16 v[42:43], v1 offset:8704
    s_waitcnt lgkmcnt(4)
    v_mfma_f32_16x16x32_bf16 v[56:59], v[32:35], v[240:243], v[56:59]
    ds_read_b64_tr_b16 v[44:45], v2 offset:8192
    v_mfma_f32_16x16x32_bf16 v[72:75], v[32:35], v[244:247], v[72:75]
    ds_read_b64_tr_b16 v[46:47], v2 offset:8704
    s_waitcnt lgkmcnt(4)
    v_mfma_f32_16x16x32_bf16 v[60:63], v[36:39], v[240:243], v[60:63]
    ds_read_b64_tr_b16 v[32:33], v1 offset:9216
    v_mfma_f32_16x16x32_bf16 v[76:79], v[36:39], v[244:247], v[76:79]
    ds_read_b64_tr_b16 v[34:35], v1 offset:9728
    s_waitcnt lgkmcnt(4)
    v_mfma_f32_16x16x32_bf16 v[48:51], v[40:43], v[248:251], v[48:51]
    ds_read_b64_tr_b16 v[36:37], v2 offset:9216
    v_mfma_f32_16x16x32_bf16 v[64:67], v[40:43], v[252:255], v[64:67]
    ds_read_b64_tr_b16 v[38:39], v2 offset:9728
    s_waitcnt lgkmcnt(4)
    v_mfma_f32_16x16x32_bf16 v[52:55], v[44:47], v[248:251], v[52:55]
    v_mfma_f32_16x16x32_bf16 v[68:71], v[44:47], v[252:255], v[68:71]
    s_waitcnt lgkmcnt(2)
    v_mfma_f32_16x16x32_bf16 v[56:59], v[32:35], v[248:251], v[56:59]
    v_mfma_f32_16x16x32_bf16 v[72:75], v[32:35], v[252:255], v[72:75]
    s_waitcnt lgkmcnt(0)
    v_mfma_f32_16x16x32_bf16 v[60:63], v[36:39], v[248:251], v[60:63]
    v_mfma_f32_16x16x32_bf16 v[76:79], v[36:39], v[252:255], v[76:79]
    s_setprio 1
    s_nop 2
    v_mul_f32 v56, v48, v56
    v_mul_f32 v57, v49, v57
    v_mul_f32 v58, v50, v58
    v_mul_f32 v59, v51, v59
    v_mul_f32 v48, v16, v48
    v_mul_f32 v49, v16, v49
    v_mul_f32 v50, v16, v50
    v_mul_f32 v51, v16, v51
    v_exp_f32 v48, v48
    v_exp_f32 v49, v49
    v_exp_f32 v50, v50
    v_exp_f32 v51, v51
    v_fma_f32 v48, v48, v10, v10
    v_fma_f32 v49, v49, v10, v10
    v_fma_f32 v50, v50, v10, v10
    v_fma_f32 v51, v51, v10, v10
    v_rcp_f32 v48, v48
    v_rcp_f32 v49, v49
    v_rcp_f32 v50, v50
    v_rcp_f32 v51, v51
    v_mul_f32 v48, v48, v56
    v_mul_f32 v49, v49, v57
    v_mul_f32 v50, v50, v58
    v_mul_f32 v51, v51, v59
    v_cvt_pk_bf16_f32 v20, v48, v49
    v_cvt_pk_bf16_f32 v21, v50, v51
    v_mul_f32 v60, v52, v60
    v_mul_f32 v61, v53, v61
    v_mul_f32 v62, v54, v62
    v_mul_f32 v63, v55, v63
    v_mul_f32 v52, v16, v52
    v_mul_f32 v53, v16, v53
    v_mul_f32 v54, v16, v54
    v_mul_f32 v55, v16, v55
    v_exp_f32 v52, v52
    v_exp_f32 v53, v53
    v_exp_f32 v54, v54
    v_exp_f32 v55, v55
    v_fma_f32 v52, v52, v10, v10
    v_fma_f32 v53, v53, v10, v10
    v_fma_f32 v54, v54, v10, v10
    v_fma_f32 v55, v55, v10, v10
    v_rcp_f32 v52, v52
    v_rcp_f32 v53, v53
    v_rcp_f32 v54, v54
    v_rcp_f32 v55, v55
    v_mul_f32 v52, v52, v60
    v_mul_f32 v53, v53, v61
    v_mul_f32 v54, v54, v62
    v_mul_f32 v55, v55, v63
    v_cvt_pk_bf16_f32 v22, v52, v53
    v_cvt_pk_bf16_f32 v23, v54, v55
    s_add_u32 s59, s56, 0
    v_permlane16_swap_b32 v20, v22
    v_permlane16_swap_b32 v21, v23
    buffer_store_dwordx4 v[20:23], v18, s[20:23], s59 offen sc1
    v_mul_f32 v72, v64, v72
    v_mul_f32 v73, v65, v73
    v_mul_f32 v74, v66, v74
    v_mul_f32 v75, v67, v75
    v_mul_f32 v64, v17, v64
    v_mul_f32 v65, v17, v65
    v_mul_f32 v66, v17, v66
    v_mul_f32 v67, v17, v67
    v_exp_f32 v64, v64
    v_exp_f32 v65, v65
    v_exp_f32 v66, v66
    v_exp_f32 v67, v67
    v_fma_f32 v64, v64, v11, v11
    v_fma_f32 v65, v65, v11, v11
    v_fma_f32 v66, v66, v11, v11
    v_fma_f32 v67, v67, v11, v11
    v_rcp_f32 v64, v64
    v_rcp_f32 v65, v65
    v_rcp_f32 v66, v66
    v_rcp_f32 v67, v67
    v_mul_f32 v64, v64, v72
    v_mul_f32 v65, v65, v73
    v_mul_f32 v66, v66, v74
    v_mul_f32 v67, v67, v75
    v_cvt_pk_bf16_f32 v20, v64, v65
    v_cvt_pk_bf16_f32 v21, v66, v67
    v_mul_f32 v76, v68, v76
    v_mul_f32 v77, v69, v77
    v_mul_f32 v78, v70, v78
    v_mul_f32 v79, v71, v79
    v_mul_f32 v68, v17, v68
    v_mul_f32 v69, v17, v69
    v_mul_f32 v70, v17, v70
    v_mul_f32 v71, v17, v71
    v_exp_f32 v68, v68
    v_exp_f32 v69, v69
    v_exp_f32 v70, v70
    v_exp_f32 v71, v71
    v_fma_f32 v68, v68, v11, v11
    v_fma_f32 v69, v69, v11, v11
    v_fma_f32 v70, v70, v11, v11
    v_fma_f32 v71, v71, v11, v11
    v_rcp_f32 v68, v68
    v_rcp_f32 v69, v69
    v_rcp_f32 v70, v70
    v_rcp_f32 v71, v71
    v_mul_f32 v68, v68, v76
    v_mul_f32 v69, v69, v77
    v_mul_f32 v70, v70, v78
    v_mul_f32 v71, v71, v79
    v_cvt_pk_bf16_f32 v22, v68, v69
    v_cvt_pk_bf16_f32 v23, v70, v71
    s_add_u32 s59, s56, 49152
    v_permlane16_swap_b32 v20, v22
    v_permlane16_swap_b32 v21, v23
    buffer_store_dwordx4 v[20:23], v18, s[20:23], s59 offen sc1
    s_waitcnt vmcnt(2)
    s_barrier
    v_lshrrev_b32 v8, 2, v0
    v_mul_u32_u24 v8, 1280, v8
    v_and_b32 v9, 3, v0
    v_lshl_add_u32 v1, v9, 4, v8
    v_lshl_add_u32 v10, v9, 3, v8
    s_lshl2_add_u32 s58, s71, s47
    s_mul_i32 s58, s58, 20480
    s_mul_i32 s59, s72, 160
    s_add_u32 s58, s58, s59
    s_bitcmp1_b32 s72, 0
    s_cselect_b32 s59, 32, 0
    s_cselect_b32 s60, 0, 128
    s_add_u32 s48, s58, s59
    s_add_u32 s49, s58, s60
    s_setprio 3
    ds_read_b128 v[20:23], v86 offset:512
    ds_read_b64 v[24:25], v87 offset:512
    ds_read_b128 v[28:31], v86 offset:1024
    ds_read_b64 v[26:27], v87 offset:1024
    ds_read_b64_tr_b16 v[12:13], v3 offset:512
    ds_read_b64_tr_b16 v[14:15], v3 offset:640
    ds_read_b64_tr_b16 v[16:17], v3 offset:768
    ds_read_b64_tr_b16 v[18:19], v3 offset:896
    s_waitcnt lgkmcnt(6)
    v_mfma_f32_32x32x16_bf16 v[64:79], v[20:23], v[80:83], 0
    v_mfma_f32_32x32x8_bf16 v[64:79], v[24:25], v[84:85], v[64:79]
    s_nop 11
    v_exp_f32 v64, v64
    v_exp_f32 v65, v65
    v_exp_f32 v66, v66
    v_exp_f32 v67, v67
    s_waitcnt lgkmcnt(4)
    v_mfma_f32_32x32x16_bf16 v[48:63], v[28:31], v[80:83], 0
    ds_read_b64_tr_b16 v[40:41], v3 offset:1024
    ds_read_b64_tr_b16 v[42:43], v3 offset:1152
    s_add_u32 m0, s83, 0
    s_add_u32 s58, s78, 20480
    buffer_load_dwordx4 v6, s[20:23], s58 offen sc1 lds
    s_add_u32 m0, s83, 1024
    s_add_u32 s58, s78, 21504
    buffer_load_dwordx4 v6, s[20:23], s58 offen sc1 lds
    v_exp_f32 v68, v68
    v_exp_f32 v69, v69
    v_exp_f32 v70, v70
    v_exp_f32 v71, v71
    v_mfma_f32_32x32x8_bf16 v[48:63], v[26:27], v[84:85], v[48:63]
    ds_read_b64_tr_b16 v[44:45], v3 offset:1280
    ds_read_b64_tr_b16 v[46:47], v3 offset:1408
    v_cvt_pk_bf16_f32 v32, v64, v65
    v_cvt_pk_bf16_f32 v33, v66, v67
    v_cvt_pk_bf16_f32 v34, v68, v69
    v_cvt_pk_bf16_f32 v35, v70, v71
    v_exp_f32 v72, v72
    v_exp_f32 v73, v73
    s_waitcnt lgkmcnt(4)
    v_mfma_f32_32x32x16_bf16 v[96:111], v[12:15], v[32:35], 0
    s_add_u32 m0, s83, 2048
    s_add_u32 s58, s78, 22528
    buffer_load_dwordx4 v6, s[20:23], s58 offen sc1 lds
    v_exp_f32 v74, v74
    v_exp_f32 v75, v75
    v_exp_f32 v76, v76
    v_exp_f32 v77, v77
    v_exp_f32 v78, v78
    v_exp_f32 v79, v79
    v_cvt_pk_bf16_f32 v36, v72, v73
    v_cvt_pk_bf16_f32 v37, v74, v75
    v_cvt_pk_bf16_f32 v38, v76, v77
    v_cvt_pk_bf16_f32 v39, v78, v79
    ds_read_b128 v[20:23], v86 offset:1536
    ds_read_b64 v[24:25], v87 offset:1536
    s_add_u32 m0, s83, 3072
    s_add_u32 s58, s78, 23552
    buffer_load_dwordx4 v6, s[20:23], s58 offen sc1 lds
    v_mfma_f32_32x32x16_bf16 v[96:111], v[16:19], v[36:39], v[96:111]
    s_add_u32 m0, s83, 4096
    s_add_u32 s58, s78, 24576
    buffer_load_dwordx4 v6, s[20:23], s58 offen sc1 lds
    v_exp_f32 v48, v48
    v_exp_f32 v49, v49
    v_exp_f32 v50, v50
    v_exp_f32 v51, v51
    s_waitcnt lgkmcnt(0)
    v_mfma_f32_32x32x16_bf16 v[64:79], v[20:23], v[80:83], 0
    ds_read_b64_tr_b16 v[12:13], v3 offset:1536
    ds_read_b64_tr_b16 v[14:15], v3 offset:1664
    s_add_u32 m0, s83, 5120
    s_add_u32 s58, s78, 25600
    buffer_load_dwordx4 v6, s[20:23], s58 offen sc1 lds
    s_add_u32 m0, s83, 6144
    s_add_u32 s58, s78, 26624
    buffer_load_dwordx4 v6, s[20:23], s58 offen sc1 lds
    v_exp_f32 v52, v52
    v_exp_f32 v53, v53
    v_exp_f32 v54, v54
    v_exp_f32 v55, v55
    v_mfma_f32_32x32x8_bf16 v[64:79], v[24:25], v[84:85], v[64:79]
    ds_read_b64_tr_b16 v[16:17], v3 offset:1792
    ds_read_b64_tr_b16 v[18:19], v3 offset:1920
    v_cvt_pk_bf16_f32 v32, v48, v49
    v_cvt_pk_bf16_f32 v33, v50, v51
    v_cvt_pk_bf16_f32 v34, v52, v53
    v_cvt_pk_bf16_f32 v35, v54, v55
    v_exp_f32 v56, v56
    v_exp_f32 v57, v57
    v_mfma_f32_32x32x16_bf16 v[96:111], v[40:43], v[32:35], v[96:111]
    s_add_u32 m0, s83, 7168
    s_add_u32 s58, s78, 27648
    buffer_load_dwordx4 v6, s[20:23], s58 offen sc1 lds
    v_exp_f32 v58, v58
    v_exp_f32 v59, v59
    v_exp_f32 v60, v60
    v_exp_f32 v61, v61
    v_exp_f32 v62, v62
    v_exp_f32 v63, v63
    v_cvt_pk_bf16_f32 v36, v56, v57
    v_cvt_pk_bf16_f32 v37, v58, v59
    v_cvt_pk_bf16_f32 v38, v60, v61
    v_cvt_pk_bf16_f32 v39, v62, v63
    ds_read_b128 v[28:31], v86 offset:2048
    ds_read_b64 v[26:27], v87 offset:2048
    s_add_u32 m0, s83, 8192
    s_add_u32 s58, s78, 28672
    buffer_load_dwordx4 v6, s[20:23], s58 offen sc1 lds
    v_mfma_f32_32x32x16_bf16 v[96:111], v[44:47], v[36:39], v[96:111]
    s_add_u32 m0, s83, 9216
    s_add_u32 s58, s78, 29696
    buffer_load_dwordx4 v6, s[20:23], s58 offen sc1 lds
    s_waitcnt vmcnt(10)
    v_mov_b32 v2, 162816
    v_mov_b32 v9, 1
    s_mov_b64 exec, 1
    ds_add_rtn_u32 v9, v2, v9 offset:24
    s_mov_b64 exec, -1
    v_exp_f32 v64, v64
    v_exp_f32 v65, v65
    v_exp_f32 v66, v66
    v_exp_f32 v67, v67
    s_waitcnt lgkmcnt(1)
    v_mfma_f32_32x32x16_bf16 v[48:63], v[28:31], v[80:83], 0
    ds_read_b64_tr_b16 v[40:41], v3 offset:2048
    ds_read_b64_tr_b16 v[42:43], v3 offset:2176
    s_add_u32 m0, s83, 10240
    s_add_u32 s58, s78, 30720
    buffer_load_dwordx4 v6, s[20:23], s58 offen sc1 lds
    s_add_u32 m0, s83, 11264
    s_add_u32 s58, s78, 31744
    buffer_load_dwordx4 v6, s[20:23], s58 offen sc1 lds
    v_exp_f32 v68, v68
    v_exp_f32 v69, v69
    v_exp_f32 v70, v70
    v_exp_f32 v71, v71
    s_waitcnt lgkmcnt(2)
    v_readfirstlane_b32 s58, v9
    s_nop 0
    s_cmp_lg_u32 s58, 7
    s_cbranch_scc1 L_nf6
    v_mov_b32 v8, 4
    v_mov_b32 v9, 0
    s_mov_b64 exec, 1
    buffer_store_dword v8, v9, s[20:23], s52 offen sc1
    s_mov_b64 exec, -1
L_nf6:
    v_mfma_f32_32x32x8_bf16 v[48:63], v[26:27], v[84:85], v[48:63]
    ds_read_b64_tr_b16 v[44:45], v3 offset:2304
    ds_read_b64_tr_b16 v[46:47], v3 offset:2432
    v_cvt_pk_bf16_f32 v32, v64, v65
    v_cvt_pk_bf16_f32 v33, v66, v67
    v_cvt_pk_bf16_f32 v34, v68, v69
    v_cvt_pk_bf16_f32 v35, v70, v71
    v_exp_f32 v72, v72
    v_exp_f32 v73, v73
    v_mfma_f32_32x32x16_bf16 v[96:111], v[12:15], v[32:35], v[96:111]
    s_add_u32 m0, s83, 12288
    s_add_u32 s58, s78, 32768
    buffer_load_dwordx4 v6, s[20:23], s58 offen sc1 lds
    v_exp_f32 v74, v74
    v_exp_f32 v75, v75
    v_exp_f32 v76, v76
    v_exp_f32 v77, v77
    v_exp_f32 v78, v78
    v_exp_f32 v79, v79
    v_cvt_pk_bf16_f32 v36, v72, v73
    v_cvt_pk_bf16_f32 v37, v74, v75
    v_cvt_pk_bf16_f32 v38, v76, v77
    v_cvt_pk_bf16_f32 v39, v78, v79
    ds_read_b128 v[20:23], v86 offset:2560
    ds_read_b64 v[24:25], v87 offset:2560
    s_add_u32 m0, s83, 13312
    s_add_u32 s58, s78, 33792
    buffer_load_dwordx4 v6, s[20:23], s58 offen sc1 lds
    v_mfma_f32_32x32x16_bf16 v[96:111], v[16:19], v[36:39], v[96:111]
    s_add_u32 m0, s83, 14336
    s_add_u32 s58, s78, 34816
    buffer_load_dwordx4 v6, s[20:23], s58 offen sc1 lds
    s_setprio 2
    v_exp_f32 v48, v48
    v_exp_f32 v49, v49
    v_exp_f32 v50, v50
    v_exp_f32 v51, v51
    s_waitcnt lgkmcnt(0)
    v_mfma_f32_32x32x16_bf16 v[64:79], v[20:23], v[80:83], 0
    ds_read_b64_tr_b16 v[12:13], v3 offset:2560
    ds_read_b64_tr_b16 v[14:15], v3 offset:2688
    s_add_u32 m0, s83, 15360
    s_add_u32 s58, s78, 35840
    buffer_load_dwordx4 v6, s[20:23], s58 offen sc1 lds
    s_add_u32 m0, s83, 16384
    s_add_u32 s58, s78, 36864
    buffer_load_dwordx4 v6, s[20:23], s58 offen sc1 lds
    v_exp_f32 v52, v52
    v_exp_f32 v53, v53
    v_exp_f32 v54, v54
    v_exp_f32 v55, v55
    v_mfma_f32_32x32x8_bf16 v[64:79], v[24:25], v[84:85], v[64:79]
    ds_read_b64_tr_b16 v[16:17], v3 offset:2816
    ds_read_b64_tr_b16 v[18:19], v3 offset:2944
    v_cvt_pk_bf16_f32 v32, v48, v49
    v_cvt_pk_bf16_f32 v33, v50, v51
    v_cvt_pk_bf16_f32 v34, v52, v53
    v_cvt_pk_bf16_f32 v35, v54, v55
    v_exp_f32 v56, v56
    v_exp_f32 v57, v57
    v_mfma_f32_32x32x16_bf16 v[96:111], v[40:43], v[32:35], v[96:111]
    s_add_u32 m0, s83, 17408
    s_add_u32 s58, s78, 37888
    buffer_load_dwordx4 v6, s[20:23], s58 offen sc1 lds
    v_exp_f32 v58, v58
    v_exp_f32 v59, v59
    v_exp_f32 v60, v60
    v_exp_f32 v61, v61
    v_exp_f32 v62, v62
    v_exp_f32 v63, v63
    v_cvt_pk_bf16_f32 v36, v56, v57
    v_cvt_pk_bf16_f32 v37, v58, v59
    v_cvt_pk_bf16_f32 v38, v60, v61
    v_cvt_pk_bf16_f32 v39, v62, v63
    ds_read_b128 v[28:31], v86 offset:3072
    ds_read_b64 v[26:27], v87 offset:3072
    s_add_u32 m0, s83, 18432
    s_add_u32 s58, s78, 38912
    buffer_load_dwordx4 v6, s[20:23], s58 offen sc1 lds
    v_mfma_f32_32x32x16_bf16 v[96:111], v[44:47], v[36:39], v[96:111]
    s_add_u32 m0, s83, 19456
    s_add_u32 s58, s78, 39936
    buffer_load_dwordx4 v6, s[20:23], s58 offen sc1 lds
    v_exp_f32 v64, v64
    v_exp_f32 v65, v65
    v_exp_f32 v66, v66
    v_exp_f32 v67, v67
    s_waitcnt lgkmcnt(0)
    v_mfma_f32_32x32x16_bf16 v[48:63], v[28:31], v[80:83], 0
    ds_read_b64_tr_b16 v[40:41], v3 offset:3072
    ds_read_b64_tr_b16 v[42:43], v3 offset:3200
    s_add_u32 m0, s41, 61440
    s_add_u32 s58, s42, 0
    buffer_load_dwordx4 v6, s[20:23], s58 offen sc1 lds
    v_exp_f32 v68, v68
    v_exp_f32 v69, v69
    v_exp_f32 v70, v70
    v_exp_f32 v71, v71
    v_mfma_f32_32x32x8_bf16 v[48:63], v[26:27], v[84:85], v[48:63]
    ds_read_b64_tr_b16 v[44:45], v3 offset:3328
    ds_read_b64_tr_b16 v[46:47], v3 offset:3456
    v_cvt_pk_bf16_f32 v32, v64, v65
    v_cvt_pk_bf16_f32 v33, v66, v67
    v_cvt_pk_bf16_f32 v34, v68, v69
    v_cvt_pk_bf16_f32 v35, v70, v71
    v_exp_f32 v72, v72
    v_exp_f32 v73, v73
    v_mfma_f32_32x32x16_bf16 v[96:111], v[12:15], v[32:35], v[96:111]
    s_add_u32 m0, s41, 155648
    s_add_u32 s58, s42, 94208
    buffer_load_dwordx4 v6, s[20:23], s58 offen sc1 lds
    s_add_u32 m0, s41, 159744
    s_add_u32 s58, s42, 98304
    s_cmp_eq_u32 s47, 3
    s_cselect_b32 s59, 1024, 0
    s_sub_u32 s58, s58, s59
    s_sub_u32 m0, m0, s59
    s_nop 0
    buffer_load_dwordx4 v6, s[20:23], s58 offen sc1 lds
    v_exp_f32 v74, v74
    v_exp_f32 v75, v75
    v_exp_f32 v76, v76
    v_exp_f32 v77, v77
    v_exp_f32 v78, v78
    v_exp_f32 v79, v79
    v_cvt_pk_bf16_f32 v36, v72, v73
    v_cvt_pk_bf16_f32 v37, v74, v75
    v_cvt_pk_bf16_f32 v38, v76, v77
    v_cvt_pk_bf16_f32 v39, v78, v79
    ds_read_b128 v[20:23], v86 offset:3584
    ds_read_b64 v[24:25], v87 offset:3584
    buffer_load_dwordx4 v[208:211], v1, s[4:7], s48 offen
    v_mfma_f32_32x32x16_bf16 v[96:111], v[16:19], v[36:39], v[96:111]
    buffer_load_dwordx4 v[212:215], v1, s[4:7], s48 offen offset:64
    s_setprio 1
    v_exp_f32 v48, v48
    v_exp_f32 v49, v49
    v_exp_f32 v50, v50
    v_exp_f32 v51, v51
    s_waitcnt lgkmcnt(0)
    v_mfma_f32_32x32x16_bf16 v[64:79], v[20:23], v[80:83], 0
    ds_read_b64_tr_b16 v[12:13], v3 offset:3584
    ds_read_b64_tr_b16 v[14:15], v3 offset:3712
    buffer_load_dwordx2 v[216:217], v10, s[4:7], s49 offen
    v_exp_f32 v52, v52
    v_exp_f32 v53, v53
    v_exp_f32 v54, v54
    v_exp_f32 v55, v55
    v_mfma_f32_32x32x8_bf16 v[64:79], v[24:25], v[84:85], v[64:79]
    ds_read_b64_tr_b16 v[16:17], v3 offset:3840
    ds_read_b64_tr_b16 v[18:19], v3 offset:3968
    v_cvt_pk_bf16_f32 v32, v48, v49
    v_cvt_pk_bf16_f32 v33, v50, v51
    v_cvt_pk_bf16_f32 v34, v52, v53
    v_cvt_pk_bf16_f32 v35, v54, v55
    v_exp_f32 v56, v56
    v_exp_f32 v57, v57
    v_mfma_f32_32x32x16_bf16 v[96:111], v[40:43], v[32:35], v[96:111]
    s_add_u32 s58, s75, 101376
    buffer_load_dwordx4 v[240:243], v6, s[20:23], s58 offen sc1
    s_add_u32 s58, s42, 53248
    buffer_load_dwordx4 v[160:163], v6, s[20:23], s58 offen sc1
    v_exp_f32 v58, v58
    v_exp_f32 v59, v59
    v_exp_f32 v60, v60
    v_exp_f32 v61, v61
    v_exp_f32 v62, v62
    v_exp_f32 v63, v63
    v_cvt_pk_bf16_f32 v36, v56, v57
    v_cvt_pk_bf16_f32 v37, v58, v59
    v_cvt_pk_bf16_f32 v38, v60, v61
    v_cvt_pk_bf16_f32 v39, v62, v63
    ds_read_b128 v[28:31], v86 offset:0
    ds_read_b64 v[26:27], v87 offset:0
    s_add_u32 s58, s42, 57344
    buffer_load_dwordx4 v[164:167], v6, s[20:23], s58 offen sc1
    v_mfma_f32_32x32x16_bf16 v[96:111], v[44:47], v[36:39], v[96:111]
    s_add_u32 s58, s42, 69632
    buffer_load_dwordx4 v[168:171], v6, s[20:23], s58 offen sc1
    ds_read_b128 v[20:23], v86 offset:4096
    ds_read_b64 v[24:25], v87 offset:4096
    v_exp_f32 v64, v64
    v_exp_f32 v65, v65
    v_exp_f32 v66, v66
    v_exp_f32 v67, v67
    s_waitcnt lgkmcnt(2)
    v_mfma_f32_32x32x16_bf16 v[48:63], v[28:31], v[80:83], 0
    ds_read_b64_tr_b16 v[40:41], v3 offset:0
    ds_read_b64_tr_b16 v[42:43], v3 offset:128
    s_add_u32 s58, s42, 73728
    buffer_load_dwordx4 v[172:175], v6, s[20:23], s58 offen sc1
    v_exp_f32 v68, v68
    v_exp_f32 v69, v69
    v_exp_f32 v70, v70
    v_exp_f32 v71, v71
    v_mfma_f32_32x32x8_bf16 v[48:63], v[26:27], v[84:85], v[48:63]
    ds_read_b64_tr_b16 v[44:45], v3 offset:256
    ds_read_b64_tr_b16 v[46:47], v3 offset:384
    v_cvt_pk_bf16_f32 v32, v64, v65
    v_cvt_pk_bf16_f32 v33, v66, v67
    v_cvt_pk_bf16_f32 v34, v68, v69
    v_cvt_pk_bf16_f32 v35, v70, v71
    v_exp_f32 v72, v72
    v_exp_f32 v73, v73
    v_mfma_f32_32x32x16_bf16 v[96:111], v[12:15], v[32:35], v[96:111]
    s_add_u32 s58, s42, 77824
    buffer_load_dwordx4 v[176:179], v6, s[20:23], s58 offen sc1
    s_add_u32 s58, s42, 81920
    buffer_load_dwordx4 v[180:183], v6, s[20:23], s58 offen sc1
    v_exp_f32 v74, v74
    v_exp_f32 v75, v75
    v_exp_f32 v76, v76
    s_waitcnt lgkmcnt(4)
    v_mfma_f32_32x32x16_bf16 v[192:207], v[20:23], v[80:83], 0
    v_exp_f32 v77, v77
    v_exp_f32 v78, v78
    v_exp_f32 v79, v79
    v_mfma_f32_32x32x8_bf16 v[192:207], v[24:25], v[84:85], v[192:207]
    v_cvt_pk_bf16_f32 v36, v72, v73
    v_cvt_pk_bf16_f32 v37, v74, v75
    v_cvt_pk_bf16_f32 v38, v76, v77
    v_cvt_pk_bf16_f32 v39, v78, v79
    s_add_u32 s58, s42, 86016
    buffer_load_dwordx4 v[184:187], v6, s[20:23], s58 offen sc1
    v_mfma_f32_32x32x16_bf16 v[96:111], v[16:19], v[36:39], v[96:111]
    s_add_u32 s58, s42, 90112
    buffer_load_dwordx4 v[188:191], v6, s[20:23], s58 offen sc1
    s_lshl_b32 s60, -1, 0
    s_lshl_b32 s61, -1, 4
    s_nop 0
    v_cndmask_b32 v48, v48, v192, s[60:61]
    s_lshl_b32 s60, -1, 1
    s_lshl_b32 s61, -1, 5
    v_cndmask_b32 v49, v49, v193, s[60:61]
    s_lshl_b32 s60, -1, 2
    s_lshl_b32 s61, -1, 6
    v_cndmask_b32 v50, v50, v194, s[60:61]
    s_lshl_b32 s60, -1, 3
    s_lshl_b32 s61, -1, 7
    v_cndmask_b32 v51, v51, v195, s[60:61]
    ds_read_b64_tr_b16 v[12:13], v3 offset:4096
    ds_read_b64_tr_b16 v[14:15], v3 offset:4224
    ds_read_b64_tr_b16 v[16:17], v3 offset:4352
    ds_read_b64_tr_b16 v[18:19], v3 offset:4480
    s_lshl_b32 s60, -1, 8
    s_lshl_b32 s61, -1, 12
    v_cndmask_b32 v52, v52, v196, s[60:61]
    s_lshl_b32 s60, -1, 9
    s_lshl_b32 s61, -1, 13
    v_cndmask_b32 v53, v53, v197, s[60:61]
    s_lshl_b32 s60, -1, 10
    s_lshl_b32 s61, -1, 14
    v_cndmask_b32 v54, v54, v198, s[60:61]
    s_lshl_b32 s60, -1, 11
    s_lshl_b32 s61, -1, 15
    v_cndmask_b32 v55, v55, v199, s[60:61]
    s_lshl_b32 s60, -1, 16
    s_lshl_b32 s61, -1, 20
    v_cndmask_b32 v56, v56, v200, s[60:61]
    s_lshl_b32 s60, -1, 17
    s_lshl_b32 s61, -1, 21
    v_cndmask_b32 v57, v57, v201, s[60:61]
    s_lshl_b32 s60, -1, 18
    s_lshl_b32 s61, -1, 22
    v_cndmask_b32 v58, v58, v202, s[60:61]
    s_lshl_b32 s60, -1, 19
    s_lshl_b32 s61, -1, 23
    v_cndmask_b32 v59, v59, v203, s[60:61]
    s_lshl_b32 s60, -1, 24
    s_lshl_b32 s61, -1, 28
    v_cndmask_b32 v60, v60, v204, s[60:61]
    s_lshl_b32 s60, -1, 25
    s_lshl_b32 s61, -1, 29
    v_cndmask_b32 v61, v61, v205, s[60:61]
    s_lshl_b32 s60, -1, 26
    s_lshl_b32 s61, -1, 30
    v_cndmask_b32 v62, v62, v206, s[60:61]
    s_lshl_b32 s60, -1, 27
    s_lshl_b32 s61, -1, 31
    v_cndmask_b32 v63, v63, v207, s[60:61]
    v_exp_f32 v48, v48
    v_exp_f32 v49, v49
    v_exp_f32 v50, v50
    v_exp_f32 v51, v51
    v_exp_f32 v52, v52
    v_exp_f32 v53, v53
    v_exp_f32 v54, v54
    v_exp_f32 v55, v55
    v_cvt_pk_bf16_f32 v32, v48, v49
    v_cvt_pk_bf16_f32 v33, v50, v51
    v_cvt_pk_bf16_f32 v34, v52, v53
    v_cvt_pk_bf16_f32 v35, v54, v55
    v_and_b32 v88, v88, v32
    v_and_b32 v89, v89, v33
    v_and_b32 v90, v90, v34
    v_and_b32 v91, v91, v35
    v_xor_b32 v32, v88, v32
    v_xor_b32 v33, v89, v33
    v_xor_b32 v34, v90, v34
    v_xor_b32 v35, v91, v35
    s_waitcnt lgkmcnt(0)
    v_mfma_f32_32x32x16_bf16 v[96:111], v[12:15], v[88:91], v[96:111]
    v_exp_f32 v56, v56
    v_exp_f32 v57, v57
    v_exp_f32 v58, v58
    v_exp_f32 v59, v59
    s_add_u32 s58, s42, 61440
    buffer_load_dwordx4 v[228:231], v6, s[20:23], s58 offen sc1
    v_mfma_f32_32x32x16_bf16 v[96:111], v[40:43], v[32:35], v[96:111]
    v_exp_f32 v60, v60
    v_exp_f32 v61, v61
    v_exp_f32 v62, v62
    v_exp_f32 v63, v63
    v_cvt_pk_bf16_f32 v36, v56, v57
    v_cvt_pk_bf16_f32 v37, v58, v59
    v_cvt_pk_bf16_f32 v38, v60, v61
    v_cvt_pk_bf16_f32 v39, v62, v63
    v_and_b32 v92, v92, v36
    v_and_b32 v93, v93, v37
    v_and_b32 v94, v94, v38
    v_and_b32 v95, v95, v39
    v_xor_b32 v36, v92, v36
    v_xor_b32 v37, v93, v37
    v_xor_b32 v38, v94, v38
    v_xor_b32 v39, v95, v39
    v_mfma_f32_32x32x16_bf16 v[96:111], v[16:19], v[92:95], v[96:111]
    s_add_u32 s58, s42, 65536
    buffer_load_dwordx4 v[232:235], v6, s[20:23], s58 offen sc1
    v_mfma_f32_32x32x16_bf16 v[96:111], v[44:47], v[36:39], v[96:111]
    v_mov_b32 v8, 0x2b800000
    v_mov_b32 v9, 0x53800000
    s_nop 9
    v_med3_f32 v8, v108, v8, v9
    v_mul_f32 v9, 0, v96
    v_fmac_f32 v9, 0, v97
    v_fmac_f32 v8, 0, v98
    v_fmac_f32 v9, 0, v99
    v_fmac_f32 v8, 0, v100
    v_fmac_f32 v9, 0, v101
    v_fmac_f32 v8, 0, v102
    v_fmac_f32 v9, 0, v103
    v_fmac_f32 v8, 0, v104
    v_fmac_f32 v9, 0, v105
    v_fmac_f32 v8, 0, v106
    v_fmac_f32 v9, 0, v107
    v_add_f32 v8, v8, v9
    v_cmp_eq_f32 vcc, v8, v108
    s_nop 0
    s_cmp_eq_u64 vcc, -1
    s_cbranch_scc1 L_aokB
    s_call_b64 s[62:63], L_fallback
L_aokB:
    v_mov_b32 v9, 1
    s_mov_b64 exec, 1
    ds_add_u32 v2, v9 offset:28
    s_mov_b64 exec, -1
    v_rcp_f32 v8, v108
    s_nop 0
    v_mul_f32 v96, v8, v96
    v_mul_f32 v97, v8, v97
    v_mul_f32 v98, v8, v98
    v_mul_f32 v99, v8, v99
    v_mul_f32 v100, v8, v100
    v_mul_f32 v101, v8, v101
    v_mul_f32 v102, v8, v102
    v_mul_f32 v103, v8, v103
    v_mul_f32 v104, v8, v104
    v_mul_f32 v105, v8, v105
    v_mul_f32 v106, v8, v106
    v_mul_f32 v107, v8, v107
    v_cvt_pk_bf16_f32 v48, v96, v97
    v_cvt_pk_bf16_f32 v49, v98, v99
    v_cvt_pk_bf16_f32 v50, v100, v101
    v_cvt_pk_bf16_f32 v51, v102, v103
    v_cvt_pk_bf16_f32 v52, v104, v105
    v_cvt_pk_bf16_f32 v53, v106, v107
    buffer_store_dwordx4 v[48:51], v4, s[20:23], s57 offen sc1
    buffer_store_dwordx2 v[52:53], v5, s[20:23], s3 offen sc1
    v_mov_b32 v8, 162816
    v_lshlrev_b32 v3, 3, v0
    v_lshrrev_b32 v2, 3, v0
    v_bfe_u32 v11, v0, 2, 1
    v_lshl_add_u32 v2, v11, 7, v2
    s_lshl_b32 s58, s79, 3
    v_add_lshl_u32 v2, v2, s58, 7
    v_add_u32 v4, 61440, v6
    v_add_u32 v5, s41, v4
    v_add_u32 v11, 4096, v5
    s_waitcnt vmcnt(12)
    v_and_b32 v9, 15, v0
    v_lshrrev_b32 v7, 4, v0
    v_lshl_add_u32 v9, v9, 2, v7
    v_lshlrev_b32 v9, 2, v9
    ds_bpermute_b32 v32, v9, v208
    ds_bpermute_b32 v33, v9, v209
    ds_bpermute_b32 v34, v9, v210
    ds_bpermute_b32 v35, v9, v211
    ds_bpermute_b32 v36, v9, v212
    ds_bpermute_b32 v37, v9, v213
    ds_bpermute_b32 v38, v9, v214
    ds_bpermute_b32 v39, v9, v215
    ds_bpermute_b32 v40, v9, v216
    ds_bpermute_b32 v41, v9, v217
    v_and_b32 v7, 3, v0
    v_lshlrev_b32 v7, 6, v7
    v_and_or_b32 v7, v0, 60, v7
    s_waitcnt lgkmcnt(0)
    v_lshlrev_b32 v12, 16, v32
    v_and_b32 v13, 0xffff0000, v32
    v_lshlrev_b32 v14, 16, v33
    v_and_b32 v15, 0xffff0000, v33
    v_lshlrev_b32 v16, 16, v34
    v_and_b32 v17, 0xffff0000, v34
    v_lshlrev_b32 v18, 16, v35
    v_and_b32 v19, 0xffff0000, v35
    v_lshlrev_b32 v20, 16, v36
    v_and_b32 v21, 0xffff0000, v36
    v_lshlrev_b32 v22, 16, v37
    v_and_b32 v23, 0xffff0000, v37
    v_lshlrev_b32 v24, 16, v38
    v_and_b32 v25, 0xffff0000, v38
    v_lshlrev_b32 v26, 16, v39
    v_and_b32 v27, 0xffff0000, v39
    v_lshlrev_b32 v28, 16, v40
    v_and_b32 v29, 0xffff0000, v40
    v_lshlrev_b32 v30, 16, v41
    v_and_b32 v31, 0xffff0000, v41
    s_waitcnt vmcnt(0)
    v_mov_b32 v32, 1
    s_mov_b64 exec, 1
    ds_add_rtn_u32 v32, v8, v32 offset:20
    s_mov_b64 exec, -1
    s_waitcnt lgkmcnt(0)
    v_readfirstlane_b32 s58, v32
    s_nop 0
    s_cmp_lg_u32 s58, 7
    s_cbranch_scc1 L_nf7
    v_mov_b32 v34, 5
    v_mov_b32 v35, 0
    s_mov_b64 exec, 1
    buffer_store_dword v34, v35, s[20:23], s52 offen sc1
    s_mov_b64 exec, -1
L_nf7:
L_lw8:
    ds_read_b32 v9, v8 offset:28
    s_waitcnt lgkmcnt(0)
    v_readfirstlane_b32 s58, v9
    s_nop 0
    s_cmp_ge_u32 s58, 8
    s_cbranch_scc1 L_lwd8
    s_sleep 1
    s_branch L_lw8
L_lwd8:
    s_setprio 0
    ds_write_b128 v11, v[112:115] offset:0
    ds_write_b128 v11, v[116:119] offset:4096
    ds_write_b128 v11, v[120:123] offset:8192
    ds_write_b128 v11, v[124:127] offset:12288
    ds_write_b128 v11, v[128:131] offset:16384
    ds_write_b128 v11, v[132:135] offset:20480
    ds_write_b128 v11, v[136:139] offset:24576
    ds_write_b128 v11, v[140:143] offset:28672
    ds_write_b128 v11, v[144:147] offset:32768
    ds_write_b128 v11, v[148:151] offset:36864
    ds_write_b128 v11, v[152:155] offset:40960
    ds_write_b128 v11, v[156:159] offset:45056
    ds_write_b128 v11, v[160:163] offset:49152
    ds_write_b128 v11, v[164:167] offset:53248
    ds_write_b128 v11, v[228:231] offset:57344
    ds_write_b128 v11, v[232:235] offset:61440
    v_mov_b32 v9, 1
    s_mov_b64 exec, 1
    ds_add_u32 v8, v9 offset:8
    s_mov_b64 exec, -1
L_lw9:
    ds_read_b32 v9, v8 offset:8
    s_waitcnt lgkmcnt(0)
    v_readfirstlane_b32 s58, v9
    s_nop 0
    s_cmp_ge_u32 s58, 4
    s_cbranch_scc1 L_lwd9
    s_sleep 1
    s_branch L_lw9
L_lwd9:
    ds_read_b128 v[52:55], v4 offset:0
    ds_read_b128 v[56:59], v4 offset:1024
    ds_read_b128 v[60:63], v4 offset:2048
    ds_read_b128 v[64:67], v4 offset:3072
    ds_read_b128 v[68:71], v4 offset:4096
    ds_read_b128 v[72:75], v4 offset:5120
    ds_read_b128 v[76:79], v4 offset:6144
    ds_read_b128 v[80:83], v4 offset:7168
    ds_read_b128 v[84:87], v4 offset:8192
    ds_read_b128 v[88:91], v4 offset:9216
    ds_read_b128 v[92:95], v4 offset:10240
    ds_read_b128 v[96:99], v4 offset:11264
    ds_read_b128 v[100:103], v4 offset:12288
    ds_read_b128 v[104:107], v4 offset:13312
    ds_read_b128 v[108:111], v4 offset:14336
    ds_read_b128 v[192:195], v4 offset:15360
    ds_read_b128 v[196:199], v4 offset:16384
    ds_read_b128 v[200:203], v4 offset:17408
    ds_read_b128 v[204:207], v4 offset:18432
    ds_read_b128 v[208:211], v4 offset:19456
    ds_read_b128 v[212:215], v4 offset:20480
    ds_read_b128 v[216:219], v4 offset:21504
    ds_read_b128 v[220:223], v4 offset:22528
    ds_read_b128 v[224:227], v4 offset:23552
    ds_read_b128 v[228:231], v4 offset:24576
    ds_read_b128 v[232:235], v4 offset:25600
    ds_read_b128 v[236:239], v4 offset:26624
    ds_read_b128 v[244:247], v4 offset:27648
    ds_read_b128 v[248:251], v4 offset:28672
    ds_read_b128 v[252:255], v4 offset:29696
    v_mov_b32 v9, 1
    s_mov_b64 exec, 1
    ds_add_u32 v8, v9 offset:16
    s_mov_b64 exec, -1
L_lw10:
    ds_read_b32 v9, v8 offset:16
    s_waitcnt lgkmcnt(0)
    v_readfirstlane_b32 s58, v9
    s_nop 0
    s_cmp_ge_u32 s58, 4
    s_cbranch_scc1 L_lwd10
    s_sleep 1
    s_branch L_lw10
L_lwd10:
    ds_write_b128 v5, v[168:171] offset:0
    ds_write_b128 v5, v[172:175] offset:4096
    ds_write_b128 v5, v[176:179] offset:8192
    ds_write_b128 v5, v[180:183] offset:12288
    ds_write_b128 v5, v[184:187] offset:16384
    ds_write_b128 v5, v[188:191] offset:20480
    v_mov_b32 v9, 1
    s_mov_b64 exec, 1
    ds_add_u32 v8, v9 offset:12
    s_mov_b64 exec, -1
    v_add_u32 v5, 65536, v4
L_lw11:
    ds_read_b32 v9, v8 offset:32
    s_waitcnt lgkmcnt(0)
    v_readfirstlane_b32 s58, v9
    s_nop 0
    s_cmp_ge_u32 s58, 4
    s_cbranch_scc1 L_lwd11
    s_sleep 2
    s_branch L_lw11
L_lwd11:
    buffer_load_dword v11, v2, s[20:23], 0 offen sc1
    s_waitcnt vmcnt(0)
    v_cmp_le_u32 vcc, 5, v11
    s_nop 0
    s_cmp_eq_u64 vcc, -1
    s_cbranch_scc0 L_pslow12
L_pok12:
    s_setprio 0
    s_add_u32 s43, s40, 0
    buffer_load_dwordx4 v[112:115], v6, s[20:23], s43 offen offset:0 sc1
    buffer_load_dwordx4 v[116:119], v6, s[20:23], s43 offen offset:1024 sc1
    buffer_load_dwordx4 v[120:123], v6, s[20:23], s43 offen offset:2048 sc1
    buffer_load_dwordx4 v[124:127], v6, s[20:23], s43 offen offset:3072 sc1
    s_add_u32 s43, s40, 4096
    buffer_load_dwordx2 v[128:129], v3, s[20:23], s43 offen offset:0 sc1
    buffer_load_dwordx2 v[130:131], v3, s[20:23], s43 offen offset:512 sc1
    buffer_load_dwordx4 v[132:135], v6, s[20:23], s43 offen offset:1024 sc1
    buffer_load_dwordx4 v[136:139], v6, s[20:23], s43 offen offset:2048 sc1
    buffer_load_dwordx4 v[140:143], v6, s[20:23], s43 offen offset:3072 sc1
    s_add_u32 s43, s40, 8192
    buffer_load_dwordx4 v[144:147], v6, s[20:23], s43 offen offset:0 sc1
    buffer_load_dwordx2 v[148:149], v3, s[20:23], s43 offen offset:1024 sc1
    buffer_load_dwordx2 v[150:151], v3, s[20:23], s43 offen offset:1536 sc1
    buffer_load_dwordx4 v[152:155], v6, s[20:23], s43 offen offset:2048 sc1
    buffer_load_dwordx4 v[156:159], v6, s[20:23], s43 offen offset:3072 sc1
    s_add_u32 s43, s40, 12288
    buffer_load_dwordx4 v[160:163], v6, s[20:23], s43 offen offset:0 sc1
    buffer_load_dwordx4 v[164:167], v6, s[20:23], s43 offen offset:1024 sc1
    s_setprio 0
    s_waitcnt vmcnt(15)
    v_mfma_f32_16x16x32_bf16 v[32:35], v[52:55], v[112:115], 0
    ds_read_b128 v[52:55], v4 offset:30720
    v_mfma_f32_16x16x32_bf16 v[36:39], v[56:59], v[112:115], 0
    ds_read_b128 v[56:59], v4 offset:31744
    v_mfma_f32_16x16x32_bf16 v[40:43], v[60:63], v[112:115], 0
    ds_read_b128 v[60:63], v4 offset:32768
    v_mfma_f32_16x16x32_bf16 v[44:47], v[64:67], v[112:115], 0
    ds_read_b128 v[64:67], v4 offset:33792
    v_mfma_f32_16x16x32_bf16 v[48:51], v[68:71], v[112:115], 0
    buffer_load_dwordx2 v[168:169], v3, s[20:23], s43 offen offset:2048 sc1
    buffer_load_dwordx2 v[170:171], v3, s[20:23], s43 offen offset:2560 sc1
    ds_read_b128 v[68:71], v4 offset:34816
    s_waitcnt vmcnt(16)
    v_mfma_f32_16x16x32_bf16 v[32:35], v[72:75], v[116:119], v[32:35]
    ds_read_b128 v[72:75], v4 offset:35840
    v_mfma_f32_16x16x32_bf16 v[36:39], v[76:79], v[116:119], v[36:39]
    ds_read_b128 v[76:79], v4 offset:36864
    v_mfma_f32_16x16x32_bf16 v[40:43], v[80:83], v[116:119], v[40:43]
    ds_read_b128 v[80:83], v4 offset:37888
    v_mfma_f32_16x16x32_bf16 v[44:47], v[84:87], v[116:119], v[44:47]
    ds_read_b128 v[84:87], v4 offset:38912
    v_mfma_f32_16x16x32_bf16 v[48:51], v[88:91], v[116:119], v[48:51]
    buffer_load_dwordx4 v[172:175], v6, s[20:23], s43 offen offset:3072 sc1
    ds_read_b128 v[88:91], v4 offset:39936
    s_waitcnt vmcnt(16)
    v_mfma_f32_16x16x32_bf16 v[32:35], v[92:95], v[120:123], v[32:35]
    ds_read_b128 v[92:95], v4 offset:40960
    v_mfma_f32_16x16x32_bf16 v[36:39], v[96:99], v[120:123], v[36:39]
    ds_read_b128 v[96:99], v4 offset:41984
    v_mfma_f32_16x16x32_bf16 v[40:43], v[100:103], v[120:123], v[40:43]
    ds_read_b128 v[100:103], v4 offset:43008
    v_mfma_f32_16x16x32_bf16 v[44:47], v[104:107], v[120:123], v[44:47]
    ds_read_b128 v[104:107], v4 offset:44032
    v_mfma_f32_16x16x32_bf16 v[48:51], v[108:111], v[120:123], v[48:51]
    s_add_u32 s43, s40, 16384
    buffer_load_dwordx4 v[176:179], v6, s[20:23], s43 offen offset:0 sc1
    ds_read_b128 v[108:111], v4 offset:45056
    s_waitcnt vmcnt(16)
    v_mfma_f32_16x16x32_bf16 v[32:35], v[192:195], v[124:127], v[32:35]
    ds_read_b128 v[192:195], v4 offset:46080
    v_mfma_f32_16x16x32_bf16 v[36:39], v[196:199], v[124:127], v[36:39]
    ds_read_b128 v[196:199], v4 offset:47104
    v_mfma_f32_16x16x32_bf16 v[40:43], v[200:203], v[124:127], v[40:43]
    ds_read_b128 v[200:203], v4 offset:48128
    v_mfma_f32_16x16x32_bf16 v[44:47], v[204:207], v[124:127], v[44:47]
    ds_read_b128 v[204:207], v4 offset:49152
    v_mfma_f32_16x16x32_bf16 v[48:51], v[208:211], v[124:127], v[48:51]
    buffer_load_dwordx4 v[180:183], v6, s[20:23], s43 offen offset:1024 sc1
    ds_read_b128 v[208:211], v4 offset:50176
    s_waitcnt vmcnt(15)
    v_mfma_f32_16x16x32_bf16 v[32:35], v[212:215], v[128:131], v[32:35]
    ds_read_b128 v[212:215], v4 offset:51200
    v_mfma_f32_16x16x32_bf16 v[36:39], v[216:219], v[128:131], v[36:39]
    ds_read_b128 v[216:219], v4 offset:52224
    v_mfma_f32_16x16x32_bf16 v[40:43], v[220:223], v[128:131], v[40:43]
    ds_read_b128 v[220:223], v4 offset:53248
    v_mfma_f32_16x16x32_bf16 v[44:47], v[224:227], v[128:131], v[44:47]
    ds_read_b128 v[224:227], v4 offset:54272
    v_mfma_f32_16x16x32_bf16 v[48:51], v[228:231], v[128:131], v[48:51]
    buffer_load_dwordx4 v[184:187], v6, s[20:23], s43 offen offset:2048 sc1
    ds_read_b128 v[228:231], v4 offset:55296
    s_waitcnt vmcnt(15)
    v_mfma_f32_16x16x32_bf16 v[32:35], v[232:235], v[132:135], v[32:35]
    ds_read_b128 v[232:235], v4 offset:56320
    v_mfma_f32_16x16x32_bf16 v[36:39], v[236:239], v[132:135], v[36:39]
    ds_read_b128 v[236:239], v4 offset:57344
    v_mfma_f32_16x16x32_bf16 v[40:43], v[244:247], v[132:135], v[40:43]
    ds_read_b128 v[244:247], v4 offset:58368
    v_mfma_f32_16x16x32_bf16 v[44:47], v[248:251], v[132:135], v[44:47]
    ds_read_b128 v[248:251], v4 offset:59392
    v_mfma_f32_16x16x32_bf16 v[48:51], v[252:255], v[132:135], v[48:51]
    buffer_load_dwordx2 v[188:189], v3, s[20:23], s43 offen offset:3072 sc1
    buffer_load_dwordx2 v[190:191], v3, s[20:23], s43 offen offset:3584 sc1
    ds_read_b128 v[252:255], v4 offset:60416
    s_waitcnt vmcnt(16) lgkmcnt(15)
    v_mfma_f32_16x16x32_bf16 v[32:35], v[52:55], v[136:139], v[32:35]
    ds_read_b128 v[52:55], v4 offset:61440
    v_mfma_f32_16x16x32_bf16 v[36:39], v[56:59], v[136:139], v[36:39]
    ds_read_b128 v[56:59], v4 offset:62464
    v_mfma_f32_16x16x32_bf16 v[40:43], v[60:63], v[136:139], v[40:43]
    ds_read_b128 v[60:63], v4 offset:63488
    v_mfma_f32_16x16x32_bf16 v[44:47], v[64:67], v[136:139], v[44:47]
    ds_read_b128 v[64:67], v4 offset:64512
    v_mfma_f32_16x16x32_bf16 v[48:51], v[68:71], v[136:139], v[48:51]
    ds_read_b128 v[68:71], v5 offset:0
    s_waitcnt vmcnt(15)
    v_mfma_f32_16x16x32_bf16 v[32:35], v[72:75], v[140:143], v[32:35]
    ds_read_b128 v[72:75], v5 offset:1024
    v_mfma_f32_16x16x32_bf16 v[36:39], v[76:79], v[140:143], v[36:39]
    ds_read_b128 v[76:79], v5 offset:2048
    v_mfma_f32_16x16x32_bf16 v[40:43], v[80:83], v[140:143], v[40:43]
    ds_read_b128 v[80:83], v5 offset:3072
    v_mfma_f32_16x16x32_bf16 v[44:47], v[84:87], v[140:143], v[44:47]
L_lw13:
    ds_read_b32 v9, v8 offset:12
    s_waitcnt lgkmcnt(0)
    v_readfirstlane_b32 s58, v9
    s_nop 0
    s_cmp_ge_u32 s58, 4
    s_cbranch_scc1 L_lwd13
    s_branch L_lw13
L_lwd13:
    ds_read_b128 v[84:87], v4 offset:0
    v_mfma_f32_16x16x32_bf16 v[48:51], v[88:91], v[140:143], v[48:51]
    ds_read_b128 v[88:91], v4 offset:1024
    s_waitcnt vmcnt(14)
    v_mfma_f32_16x16x32_bf16 v[32:35], v[92:95], v[144:147], v[32:35]
    ds_read_b128 v[92:95], v4 offset:2048
    v_mfma_f32_16x16x32_bf16 v[36:39], v[96:99], v[144:147], v[36:39]
    ds_read_b128 v[96:99], v4 offset:3072
    v_mfma_f32_16x16x32_bf16 v[40:43], v[100:103], v[144:147], v[40:43]
    ds_read_b128 v[100:103], v4 offset:4096
    v_mfma_f32_16x16x32_bf16 v[44:47], v[104:107], v[144:147], v[44:47]
    ds_read_b128 v[104:107], v4 offset:5120
    v_mfma_f32_16x16x32_bf16 v[48:51], v[108:111], v[144:147], v[48:51]
    ds_read_b128 v[108:111], v4 offset:6144
    s_waitcnt vmcnt(12)
    v_mfma_f32_16x16x32_bf16 v[32:35], v[192:195], v[148:151], v[32:35]
    ds_read_b128 v[192:195], v4 offset:7168
    v_mfma_f32_16x16x32_bf16 v[36:39], v[196:199], v[148:151], v[36:39]
    ds_read_b128 v[196:199], v4 offset:8192
    v_mfma_f32_16x16x32_bf16 v[40:43], v[200:203], v[148:151], v[40:43]
    ds_read_b128 v[200:203], v4 offset:9216
    v_mfma_f32_16x16x32_bf16 v[44:47], v[204:207], v[148:151], v[44:47]
    ds_read_b128 v[204:207], v4 offset:10240
    v_mfma_f32_16x16x32_bf16 v[48:51], v[208:211], v[148:151], v[48:51]
    ds_read_b128 v[208:211], v4 offset:11264
    s_waitcnt vmcnt(11)
    v_mfma_f32_16x16x32_bf16 v[32:35], v[212:215], v[152:155], v[32:35]
    ds_read_b128 v[212:215], v4 offset:12288
    v_mfma_f32_16x16x32_bf16 v[36:39], v[216:219], v[152:155], v[36:39]
    ds_read_b128 v[216:219], v4 offset:13312
    v_mfma_f32_16x16x32_bf16 v[40:43], v[220:223], v[152:155], v[40:43]
    ds_read_b128 v[220:223], v4 offset:14336
    v_mfma_f32_16x16x32_bf16 v[44:47], v[224:227], v[152:155], v[44:47]
    ds_read_b128 v[224:227], v4 offset:15360
    v_mfma_f32_16x16x32_bf16 v[48:51], v[228:231], v[152:155], v[48:51]
    ds_read_b128 v[228:231], v4 offset:16384
    s_waitcnt vmcnt(10)
    v_mfma_f32_16x16x32_bf16 v[32:35], v[232:235], v[156:159], v[32:35]
    ds_read_b128 v[232:235], v4 offset:17408
    v_mfma_f32_16x16x32_bf16 v[36:39], v[236:239], v[156:159], v[36:39]
    ds_read_b128 v[236:239], v4 offset:18432
    v_mfma_f32_16x16x32_bf16 v[40:43], v[244:247], v[156:159], v[40:43]
    ds_read_b128 v[244:247], v4 offset:19456
    v_mfma_f32_16x16x32_bf16 v[44:47], v[248:251], v[156:159], v[44:47]
    ds_read_b128 v[248:251], v4 offset:20480
    v_mfma_f32_16x16x32_bf16 v[48:51], v[252:255], v[156:159], v[48:51]
    ds_read_b128 v[252:255], v4 offset:21504
    s_waitcnt vmcnt(9)
    v_mfma_f32_16x16x32_bf16 v[32:35], v[52:55], v[160:163], v[32:35]
    ds_read_b128 v[52:55], v4 offset:22528
    v_mfma_f32_16x16x32_bf16 v[36:39], v[56:59], v[160:163], v[36:39]
    ds_read_b128 v[56:59], v4 offset:23552
    v_mfma_f32_16x16x32_bf16 v[40:43], v[60:63], v[160:163], v[40:43]
    ds_read_b128 v[60:63], v5 offset:28672
    v_mfma_f32_16x16x32_bf16 v[44:47], v[64:67], v[160:163], v[44:47]
    ds_read_b128 v[64:67], v5 offset:29696
    v_mfma_f32_16x16x32_bf16 v[48:51], v[68:71], v[160:163], v[48:51]
    ds_read_b128 v[68:71], v5 offset:30720
    s_waitcnt vmcnt(8) lgkmcnt(15)
    v_mfma_f32_16x16x32_bf16 v[32:35], v[72:75], v[164:167], v[32:35]
    ds_read_b128 v[72:75], v5 offset:31744
    v_mfma_f32_16x16x32_bf16 v[36:39], v[76:79], v[164:167], v[36:39]
    ds_read_b128 v[76:79], v5 offset:32768
    v_mfma_f32_16x16x32_bf16 v[40:43], v[80:83], v[164:167], v[40:43]
    ds_read_b128 v[80:83], v5 offset:33792
    v_mfma_f32_16x16x32_bf16 v[44:47], v[84:87], v[164:167], v[44:47]
    ds_read_b128 v[84:87], v5 offset:34816
    v_mfma_f32_16x16x32_bf16 v[48:51], v[88:91], v[164:167], v[48:51]
    s_waitcnt vmcnt(6)
    v_mfma_f32_16x16x32_bf16 v[32:35], v[92:95], v[168:171], v[32:35]
    v_mfma_f32_16x16x32_bf16 v[36:39], v[96:99], v[168:171], v[36:39]
    v_mfma_f32_16x16x32_bf16 v[40:43], v[100:103], v[168:171], v[40:43]
    v_mfma_f32_16x16x32_bf16 v[44:47], v[104:107], v[168:171], v[44:47]
    v_mfma_f32_16x16x32_bf16 v[48:51], v[108:111], v[168:171], v[48:51]
    s_waitcnt vmcnt(5)
    v_mfma_f32_16x16x32_bf16 v[32:35], v[192:195], v[172:175], v[32:35]
    v_mfma_f32_16x16x32_bf16 v[36:39], v[196:199], v[172:175], v[36:39]
    v_mfma_f32_16x16x32_bf16 v[40:43], v[200:203], v[172:175], v[40:43]
    v_mfma_f32_16x16x32_bf16 v[44:47], v[204:207], v[172:175], v[44:47]
    v_mfma_f32_16x16x32_bf16 v[48:51], v[208:211], v[172:175], v[48:51]
    s_mul_i32 s59, s47, 15360
    s_add_u32 s59, s59, 0
    v_add_u32 v11, s59, v6
    s_lshl_b32 s58, s47, 2
    v_add_u32 v8, s58, v8
    s_waitcnt vmcnt(4) lgkmcnt(14)
    v_mfma_f32_16x16x32_bf16 v[32:35], v[212:215], v[176:179], v[32:35]
    v_mfma_f32_16x16x32_bf16 v[36:39], v[216:219], v[176:179], v[36:39]
    v_mfma_f32_16x16x32_bf16 v[40:43], v[220:223], v[176:179], v[40:43]
    v_mfma_f32_16x16x32_bf16 v[44:47], v[224:227], v[176:179], v[44:47]
    v_mfma_f32_16x16x32_bf16 v[48:51], v[228:231], v[176:179], v[48:51]
    s_waitcnt vmcnt(3) lgkmcnt(9)
    v_mfma_f32_16x16x32_bf16 v[32:35], v[232:235], v[180:183], v[32:35]
    v_mfma_f32_16x16x32_bf16 v[36:39], v[236:239], v[180:183], v[36:39]
    v_mfma_f32_16x16x32_bf16 v[40:43], v[244:247], v[180:183], v[40:43]
    v_mfma_f32_16x16x32_bf16 v[44:47], v[248:251], v[180:183], v[44:47]
    v_mfma_f32_16x16x32_bf16 v[48:51], v[252:255], v[180:183], v[48:51]
    s_waitcnt vmcnt(2) lgkmcnt(4)
    v_mfma_f32_16x16x32_bf16 v[32:35], v[52:55], v[184:187], v[32:35]
    v_mfma_f32_16x16x32_bf16 v[36:39], v[56:59], v[184:187], v[36:39]
    v_mfma_f32_16x16x32_bf16 v[40:43], v[60:63], v[184:187], v[40:43]
    v_mfma_f32_16x16x32_bf16 v[44:47], v[64:67], v[184:187], v[44:47]
    v_mfma_f32_16x16x32_bf16 v[48:51], v[68:71], v[184:187], v[48:51]
    s_waitcnt vmcnt(0) lgkmcnt(0)
    v_mfma_f32_16x16x32_bf16 v[32:35], v[72:75], v[188:191], v[32:35]
    v_mfma_f32_16x16x32_bf16 v[36:39], v[76:79], v[188:191], v[36:39]
    v_mfma_f32_16x16x32_bf16 v[40:43], v[80:83], v[188:191], v[40:43]
    v_mfma_f32_16x16x32_bf16 v[44:47], v[84:87], v[188:191], v[44:47]
    v_mfma_f32_16x16x32_bf16 v[48:51], v[240:243], v[188:191], v[48:51]
L_lw14:
    ds_read_b32 v9, v8 offset:48
    s_waitcnt lgkmcnt(0)
    v_readfirstlane_b32 s58, v9
    s_nop 0
    s_cmp_ge_u32 s58, 1
    s_cbranch_scc1 L_lwd14
    s_branch L_lw14
L_lwd14:
    ds_read_b128 v[112:115], v11 offset:0
    ds_read_b128 v[116:119], v11 offset:1024
    ds_read_b128 v[120:123], v11 offset:2048
    ds_read_b128 v[124:127], v11 offset:3072
    ds_read_b128 v[128:131], v11 offset:4096
    s_waitcnt lgkmcnt(4)
    v_fmac_f32 v12, v32, v112
    v_fmac_f32 v13, v33, v113
    v_fmac_f32 v14, v34, v114
    v_fmac_f32 v15, v35, v115
    v_cvt_pk_bf16_f32 v220, v12, v13
    v_cvt_pk_bf16_f32 v221, v14, v15
    ds_bpermute_b32 v208, v7, v220
    ds_bpermute_b32 v209, v7, v221
    s_waitcnt lgkmcnt(5)
    v_fmac_f32 v16, v36, v116
    v_fmac_f32 v17, v37, v117
    v_fmac_f32 v18, v38, v118
    v_fmac_f32 v19, v39, v119
    v_cvt_pk_bf16_f32 v222, v16, v17
    v_cvt_pk_bf16_f32 v223, v18, v19
    ds_bpermute_b32 v210, v7, v222
    ds_bpermute_b32 v211, v7, v223
    s_waitcnt lgkmcnt(6)
    v_fmac_f32 v20, v40, v120
    v_fmac_f32 v21, v41, v121
    v_fmac_f32 v22, v42, v122
    v_fmac_f32 v23, v43, v123
    v_cvt_pk_bf16_f32 v224, v20, v21
    v_cvt_pk_bf16_f32 v225, v22, v23
    ds_bpermute_b32 v212, v7, v224
    ds_bpermute_b32 v213, v7, v225
    s_waitcnt lgkmcnt(7)
    v_fmac_f32 v24, v44, v124
    v_fmac_f32 v25, v45, v125
    v_fmac_f32 v26, v46, v126
    v_fmac_f32 v27, v47, v127
    v_cvt_pk_bf16_f32 v226, v24, v25
    v_cvt_pk_bf16_f32 v227, v26, v27
    ds_bpermute_b32 v214, v7, v226
    ds_bpermute_b32 v215, v7, v227
    s_waitcnt lgkmcnt(8)
    v_fmac_f32 v28, v48, v128
    v_fmac_f32 v29, v49, v129
    v_fmac_f32 v30, v50, v130
    v_fmac_f32 v31, v51, v131
    v_cvt_pk_bf16_f32 v228, v28, v29
    v_cvt_pk_bf16_f32 v229, v30, v31
    ds_bpermute_b32 v216, v7, v228
    ds_bpermute_b32 v217, v7, v229
    s_waitcnt lgkmcnt(6)
    buffer_store_dwordx4 v[208:211], v1, s[36:39], s48 offen
    s_waitcnt lgkmcnt(2)
    buffer_store_dwordx4 v[212:215], v1, s[36:39], s48 offen offset:64
    s_waitcnt lgkmcnt(0)
    buffer_store_dwordx2 v[216:217], v10, s[36:39], s49 offen
    s_endpgm
L_mainA:
    s_waitcnt vmcnt(14)
    s_sub_u32 s73, s53, 1
    s_cmp_le_u32 s73, 1
    s_cbranch_scc1 L_cw3
    s_waitcnt vmcnt(4)
L_cw3:
    s_barrier
    ds_read_b128 v[96:99], v80 offset:0
    ds_read_b64_tr_b16 v[32:33], v1 offset:0
    ds_read_b128 v[100:103], v80 offset:2048
    ds_read_b64_tr_b16 v[34:35], v1 offset:512
    ds_read_b64_tr_b16 v[36:37], v2 offset:0
    ds_read_b64_tr_b16 v[38:39], v2 offset:512
    ds_read_b64_tr_b16 v[40:41], v1 offset:1024
    ds_read_b64_tr_b16 v[42:43], v1 offset:1536
    s_waitcnt lgkmcnt(4)
    v_mfma_f32_16x16x32_bf16 v[48:51], v[32:35], v[96:99], 0
    ds_read_b64_tr_b16 v[44:45], v2 offset:1024
    s_add_u32 m0, s50, 98304
    s_nop 0
    buffer_load_dwordx4 v84, s[4:7], s48 offen lds
    v_mfma_f32_16x16x32_bf16 v[64:67], v[32:35], v[100:103], 0
    ds_read_b64_tr_b16 v[46:47], v2 offset:1536
    s_waitcnt lgkmcnt(4)
    v_mfma_f32_16x16x32_bf16 v[52:55], v[36:39], v[96:99], 0
    ds_read_b128 v[104:107], v81 offset:0
    ds_read_b64_tr_b16 v[32:33], v1 offset:8192
    buffer_load_dwordx4 v85, s[4:7], s48 offen offset:1024 lds
    v_mfma_f32_16x16x32_bf16 v[68:71], v[36:39], v[100:103], 0
    ds_read_b128 v[108:111], v81 offset:2048
    ds_read_b64_tr_b16 v[34:35], v1 offset:8704
    s_waitcnt lgkmcnt(6)
    v_mfma_f32_16x16x32_bf16 v[56:59], v[40:43], v[96:99], 0
    ds_read_b64_tr_b16 v[36:37], v2 offset:8192
    s_add_u32 s48, s48, 128
    s_add_u32 m0, s50, 32768
    v_mfma_f32_16x16x32_bf16 v[72:75], v[40:43], v[100:103], 0
    ds_read_b64_tr_b16 v[38:39], v2 offset:8704
    buffer_load_dwordx4 v4, s[36:39], s49 offen lds
    s_waitcnt lgkmcnt(6)
    v_mfma_f32_16x16x32_bf16 v[60:63], v[44:47], v[96:99], 0
    ds_read_b64_tr_b16 v[40:41], v1 offset:9216
    v_mfma_f32_16x16x32_bf16 v[76:79], v[44:47], v[100:103], 0
    ds_read_b64_tr_b16 v[42:43], v1 offset:9728
    s_add_u32 m0, s50, 33792
    s_nop 0
    buffer_load_dwordx4 v5, s[64:67], s49 offen lds
    s_waitcnt lgkmcnt(4)
    v_mfma_f32_16x16x32_bf16 v[48:51], v[32:35], v[104:107], v[48:51]
    ds_read_b64_tr_b16 v[44:45], v2 offset:9216
    v_mfma_f32_16x16x32_bf16 v[64:67], v[32:35], v[108:111], v[64:67]
    ds_read_b64_tr_b16 v[46:47], v2 offset:9728
    s_add_u32 s49, s49, s84
    s_waitcnt lgkmcnt(4)
    v_mfma_f32_16x16x32_bf16 v[52:55], v[36:39], v[104:107], v[52:55]
    v_mfma_f32_16x16x32_bf16 v[68:71], v[36:39], v[108:111], v[68:71]
    s_waitcnt vmcnt(14)
    s_sub_u32 s73, s53, 2
    s_cmp_le_u32 s73, 0
    s_cbranch_scc1 L_cw4
    s_waitcnt vmcnt(4)
L_cw4:
    s_barrier
    ds_read_b128 v[112:115], v80 offset:16384
    ds_read_b64_tr_b16 v[32:33], v1 offset:16384
    ds_read_b128 v[116:119], v80 offset:18432
    ds_read_b64_tr_b16 v[34:35], v1 offset:16896
    s_add_u32 m0, s50, 114688
    s_nop 0
    buffer_load_dwordx4 v84, s[4:7], s48 offen lds
    s_waitcnt lgkmcnt(6)
    v_mfma_f32_16x16x32_bf16 v[56:59], v[40:43], v[104:107], v[56:59]
    ds_read_b64_tr_b16 v[36:37], v2 offset:16384
    v_mfma_f32_16x16x32_bf16 v[72:75], v[40:43], v[108:111], v[72:75]
    ds_read_b64_tr_b16 v[38:39], v2 offset:16896
    s_waitcnt lgkmcnt(6)
    v_mfma_f32_16x16x32_bf16 v[60:63], v[44:47], v[104:107], v[60:63]
    ds_read_b64_tr_b16 v[40:41], v1 offset:17408
    buffer_load_dwordx4 v85, s[4:7], s48 offen offset:1024 lds
    v_mfma_f32_16x16x32_bf16 v[76:79], v[44:47], v[108:111], v[76:79]
    ds_read_b64_tr_b16 v[42:43], v1 offset:17920
    s_waitcnt lgkmcnt(4)
    v_mfma_f32_16x16x32_bf16 v[48:51], v[32:35], v[112:115], v[48:51]
    ds_read_b64_tr_b16 v[44:45], v2 offset:17408
    v_mfma_f32_16x16x32_bf16 v[64:67], v[32:35], v[116:119], v[64:67]
    ds_read_b64_tr_b16 v[46:47], v2 offset:17920
    s_add_u32 s48, s48, 128
    s_waitcnt lgkmcnt(4)
    v_mfma_f32_16x16x32_bf16 v[52:55], v[36:39], v[112:115], v[52:55]
    ds_read_b128 v[120:123], v81 offset:16384
    ds_read_b64_tr_b16 v[32:33], v1 offset:24576
    s_add_u32 m0, s50, 49152
    v_mfma_f32_16x16x32_bf16 v[68:71], v[36:39], v[116:119], v[68:71]
    ds_read_b128 v[124:127], v81 offset:18432
    ds_read_b64_tr_b16 v[34:35], v1 offset:25088
    buffer_load_dwordx4 v4, s[36:39], s49 offen lds
    s_waitcnt lgkmcnt(6)
    v_mfma_f32_16x16x32_bf16 v[56:59], v[40:43], v[112:115], v[56:59]
    ds_read_b64_tr_b16 v[36:37], v2 offset:24576
    v_mfma_f32_16x16x32_bf16 v[72:75], v[40:43], v[116:119], v[72:75]
    ds_read_b64_tr_b16 v[38:39], v2 offset:25088
    s_waitcnt lgkmcnt(6)
    v_mfma_f32_16x16x32_bf16 v[60:63], v[44:47], v[112:115], v[60:63]
    ds_read_b64_tr_b16 v[40:41], v1 offset:25600
    s_add_u32 m0, s50, 50176
    v_mfma_f32_16x16x32_bf16 v[76:79], v[44:47], v[116:119], v[76:79]
    ds_read_b64_tr_b16 v[42:43], v1 offset:26112
    buffer_load_dwordx4 v5, s[64:67], s49 offen lds
    s_waitcnt lgkmcnt(4)
    v_mfma_f32_16x16x32_bf16 v[48:51], v[32:35], v[120:123], v[48:51]
    ds_read_b64_tr_b16 v[44:45], v2 offset:25600
    v_mfma_f32_16x16x32_bf16 v[64:67], v[32:35], v[124:127], v[64:67]
    ds_read_b64_tr_b16 v[46:47], v2 offset:26112
    s_waitcnt lgkmcnt(4)
    v_mfma_f32_16x16x32_bf16 v[52:55], v[36:39], v[120:123], v[52:55]
    s_add_u32 s49, s49, s84
    v_mfma_f32_16x16x32_bf16 v[68:71], v[36:39], v[124:127], v[68:71]
    s_waitcnt vmcnt(4)
    s_barrier
    ds_read_b128 v[128:131], v80 offset:32768
    ds_read_b64_tr_b16 v[32:33], v1 offset:32768
    ds_read_b128 v[132:135], v80 offset:34816
    ds_read_b64_tr_b16 v[34:35], v1 offset:33280
    s_add_u32 m0, s50, 65536
    s_nop 0
    buffer_load_dwordx4 v84, s[4:7], s48 offen lds
    s_waitcnt lgkmcnt(6)
    v_mfma_f32_16x16x32_bf16 v[56:59], v[40:43], v[120:123], v[56:59]
    ds_read_b64_tr_b16 v[36:37], v2 offset:32768
    v_mfma_f32_16x16x32_bf16 v[72:75], v[40:43], v[124:127], v[72:75]
    ds_read_b64_tr_b16 v[38:39], v2 offset:33280
    s_waitcnt lgkmcnt(6)
    v_mfma_f32_16x16x32_bf16 v[60:63], v[44:47], v[120:123], v[60:63]
    ds_read_b64_tr_b16 v[40:41], v1 offset:33792
    buffer_load_dwordx4 v85, s[4:7], s48 offen offset:1024 lds
    v_mfma_f32_16x16x32_bf16 v[76:79], v[44:47], v[124:127], v[76:79]
    ds_read_b64_tr_b16 v[42:43], v1 offset:34304
    s_waitcnt lgkmcnt(4)
    v_mfma_f32_16x16x32_bf16 v[48:51], v[32:35], v[128:131], v[48:51]
    ds_read_b64_tr_b16 v[44:45], v2 offset:33792
    s_add_u32 s48, s48, 128
    v_mfma_f32_16x16x32_bf16 v[64:67], v[32:35], v[132:135], v[64:67]
    ds_read_b64_tr_b16 v[46:47], v2 offset:34304
    s_add_u32 m0, s50, 0
    s_waitcnt lgkmcnt(4)
    v_mfma_f32_16x16x32_bf16 v[52:55], v[36:39], v[128:131], v[52:55]
    ds_read_b128 v[136:139], v81 offset:32768
    ds_read_b64_tr_b16 v[32:33], v1 offset:40960
    buffer_load_dwordx4 v4, s[36:39], s49 offen lds
    v_mfma_f32_16x16x32_bf16 v[68:71], v[36:39], v[132:135], v[68:71]
    ds_read_b128 v[140:143], v81 offset:34816
    ds_read_b64_tr_b16 v[34:35], v1 offset:41472
    s_waitcnt lgkmcnt(6)
    v_mfma_f32_16x16x32_bf16 v[56:59], v[40:43], v[128:131], v[56:59]
    ds_read_b64_tr_b16 v[36:37], v2 offset:40960
    s_add_u32 m0, s50, 1024
    v_mfma_f32_16x16x32_bf16 v[72:75], v[40:43], v[132:135], v[72:75]
    ds_read_b64_tr_b16 v[38:39], v2 offset:41472
    buffer_load_dwordx4 v5, s[64:67], s49 offen lds
    s_waitcnt lgkmcnt(6)
    v_mfma_f32_16x16x32_bf16 v[60:63], v[44:47], v[128:131], v[60:63]
    ds_read_b64_tr_b16 v[40:41], v1 offset:41984
    v_mfma_f32_16x16x32_bf16 v[76:79], v[44:47], v[132:135], v[76:79]
    ds_read_b64_tr_b16 v[42:43], v1 offset:42496
    s_add_u32 s49, s49, s84
    s_waitcnt lgkmcnt(4)
    v_mfma_f32_16x16x32_bf16 v[48:51], v[32:35], v[136:139], v[48:51]
    ds_read_b64_tr_b16 v[44:45], v2 offset:41984
    v_and_b32 v8, 3, v0
    v_mfma_f32_16x16x32_bf16 v[64:67], v[32:35], v[140:143], v[64:67]
    ds_read_b64_tr_b16 v[46:47], v2 offset:42496
    v_lshlrev_b32 v8, 6, v8
    s_waitcnt lgkmcnt(4)
    v_mfma_f32_16x16x32_bf16 v[52:55], v[36:39], v[136:139], v[52:55]
    v_mfma_f32_16x16x32_bf16 v[68:71], v[36:39], v[140:143], v[68:71]
    s_cmp_lg_u32 s53, 5
    s_cbranch_scc1 L_ncb5
    buffer_load_dwordx4 v[216:219], v86, s[40:43], s74 offen
    s_add_u32 s74, s74, s82
    buffer_load_dwordx4 v[220:223], v86, s[40:43], s74 offen
    s_add_u32 s74, s74, s82
    buffer_load_dwordx4 v[224:227], v86, s[40:43], s74 offen
    s_add_u32 s74, s74, s82
    buffer_load_dwordx4 v[228:231], v86, s[40:43], s74 offen
    s_add_u32 s74, s74, s82
    buffer_load_dwordx4 v[232:235], v86, s[40:43], s74 offen
    s_add_u32 s74, s74, s82
    buffer_load_dwordx4 v[236:239], v86, s[40:43], s74 offen
    s_add_u32 s74, s74, s82
    buffer_load_dwordx4 v[240:243], v86, s[40:43], s74 offen
    s_add_u32 s74, s74, s82
    buffer_load_dwordx4 v[244:247], v86, s[40:43], s74 offen
    s_add_u32 s74, s74, s82
    buffer_load_dwordx4 v[248:251], v86, s[40:43], s74 offen
    s_add_u32 s74, s74, s82
    buffer_load_dwordx4 v[252:255], v86, s[40:43], s74 offen
L_ncb5:
    s_sub_u32 s58, s53, 0
    s_cmp_le_u32 s58, 2
    s_cbranch_scc0 L_cu0
    v_mfma_f32_16x16x32_bf16 v[92:95], v[88:91], v[216:219], 0
    v_mfma_f32_16x16x32_bf16 v[92:95], v[88:91], v[220:223], v[92:95]
    v_mfma_f32_16x16x32_bf16 v[92:95], v[88:91], v[224:227], v[92:95]
    v_mfma_f32_16x16x32_bf16 v[92:95], v[88:91], v[228:231], v[92:95]
    v_mfma_f32_16x16x32_bf16 v[92:95], v[88:91], v[232:235], v[92:95]
    v_mfma_f32_16x16x32_bf16 v[92:95], v[88:91], v[236:239], v[92:95]
    v_mfma_f32_16x16x32_bf16 v[92:95], v[88:91], v[240:243], v[92:95]
    v_mfma_f32_16x16x32_bf16 v[92:95], v[88:91], v[244:247], v[92:95]
    v_mfma_f32_16x16x32_bf16 v[92:95], v[88:91], v[248:251], v[92:95]
    v_mfma_f32_16x16x32_bf16 v[92:95], v[88:91], v[252:255], v[92:95]
    s_nop 7
    v_add_f32_dpp v220, v92, v92 row_ror:8 row_mask:0xf bank_mask:0xf
    v_add_f32_dpp v221, v93, v93 row_ror:8 row_mask:0xf bank_mask:0xf
    v_add_f32_dpp v222, v94, v94 row_ror:8 row_mask:0xf bank_mask:0xf
    v_add_f32_dpp v223, v95, v95 row_ror:8 row_mask:0xf bank_mask:0xf
    v_cvt_pk_bf16_f32 v92, v220, v221
    v_cvt_pk_bf16_f32 v93, v222, v223
    v_lshlrev_b32 v216, 16, v92
    v_and_b32 v217, 0xffff0000, v92
    v_lshlrev_b32 v218, 16, v93
    v_and_b32 v219, 0xffff0000, v93
    v_sub_f32 v216, v220, v216
    v_sub_f32 v217, v221, v217
    v_sub_f32 v218, v222, v218
    v_sub_f32 v219, v223, v219
    s_mov_b32 vcc_lo, 0xff00ff00
    s_mov_b32 vcc_hi, 0xff00ff00
    v_cvt_pk_bf16_f32 v94, v216, v217
    v_cvt_pk_bf16_f32 v95, v218, v219
    v_cndmask_b32 v92, v92, v94, vcc
    v_cndmask_b32 v93, v93, v95, vcc
    buffer_store_dwordx2 v[92:93], v87, s[20:23], s75 offen sc1
    s_nop 0
L_cu0:
    s_cmp_lg_u32 s47, 0
    s_cbranch_scc1 L_np15
    buffer_load_dword v9, v8, s[24:27], 0 offen sc1
L_np15:
    s_waitcnt vmcnt(14)
    s_sub_u32 s73, s53, 5
    s_cmp_le_u32 s73, 0
    s_cbranch_scc1 L_cw5
    s_waitcnt vmcnt(4)
L_cw5:
    s_barrier
    ds_read_b128 v[144:147], v80 offset:49152
    ds_read_b64_tr_b16 v[32:33], v1 offset:49152
    ds_read_b128 v[148:151], v80 offset:51200
    ds_read_b64_tr_b16 v[34:35], v1 offset:49664
    s_add_u32 m0, s50, 81920
    s_nop 0
    buffer_load_dwordx4 v84, s[4:7], s48 offen lds
    s_waitcnt lgkmcnt(6)
    v_mfma_f32_16x16x32_bf16 v[56:59], v[40:43], v[136:139], v[56:59]
    ds_read_b64_tr_b16 v[36:37], v2 offset:49152
    v_mfma_f32_16x16x32_bf16 v[72:75], v[40:43], v[140:143], v[72:75]
    ds_read_b64_tr_b16 v[38:39], v2 offset:49664
    s_waitcnt lgkmcnt(6)
    v_mfma_f32_16x16x32_bf16 v[60:63], v[44:47], v[136:139], v[60:63]
    ds_read_b64_tr_b16 v[40:41], v1 offset:50176
    buffer_load_dwordx4 v85, s[4:7], s48 offen offset:1024 lds
    v_mfma_f32_16x16x32_bf16 v[76:79], v[44:47], v[140:143], v[76:79]
    ds_read_b64_tr_b16 v[42:43], v1 offset:50688
    s_waitcnt lgkmcnt(4)
    v_mfma_f32_16x16x32_bf16 v[48:51], v[32:35], v[144:147], v[48:51]
    ds_read_b64_tr_b16 v[44:45], v2 offset:50176
    v_mfma_f32_16x16x32_bf16 v[64:67], v[32:35], v[148:151], v[64:67]
    ds_read_b64_tr_b16 v[46:47], v2 offset:50688
    s_add_u32 s48, s48, 128
    s_waitcnt lgkmcnt(4)
    v_mfma_f32_16x16x32_bf16 v[52:55], v[36:39], v[144:147], v[52:55]
    ds_read_b128 v[152:155], v81 offset:49152
    ds_read_b64_tr_b16 v[32:33], v1 offset:57344
    s_add_u32 m0, s50, 16384
    v_mfma_f32_16x16x32_bf16 v[68:71], v[36:39], v[148:151], v[68:71]
    ds_read_b128 v[156:159], v81 offset:51200
    ds_read_b64_tr_b16 v[34:35], v1 offset:57856
    buffer_load_dwordx4 v4, s[36:39], s49 offen lds
    s_waitcnt lgkmcnt(6)
    v_mfma_f32_16x16x32_bf16 v[56:59], v[40:43], v[144:147], v[56:59]
    ds_read_b64_tr_b16 v[36:37], v2 offset:57344
    v_mfma_f32_16x16x32_bf16 v[72:75], v[40:43], v[148:151], v[72:75]
    ds_read_b64_tr_b16 v[38:39], v2 offset:57856
    s_waitcnt lgkmcnt(6)
    v_mfma_f32_16x16x32_bf16 v[60:63], v[44:47], v[144:147], v[60:63]
    ds_read_b64_tr_b16 v[40:41], v1 offset:58368
    s_add_u32 m0, s50, 17408
    v_mfma_f32_16x16x32_bf16 v[76:79], v[44:47], v[148:151], v[76:79]
    ds_read_b64_tr_b16 v[42:43], v1 offset:58880
    buffer_load_dwordx4 v5, s[64:67], s49 offen lds
    s_waitcnt lgkmcnt(4)
    v_mfma_f32_16x16x32_bf16 v[48:51], v[32:35], v[152:155], v[48:51]
    ds_read_b64_tr_b16 v[44:45], v2 offset:58368
    v_mfma_f32_16x16x32_bf16 v[64:67], v[32:35], v[156:159], v[64:67]
    ds_read_b64_tr_b16 v[46:47], v2 offset:58880
    s_waitcnt lgkmcnt(4)
    v_mfma_f32_16x16x32_bf16 v[52:55], v[36:39], v[152:155], v[52:55]
    s_add_u32 s49, s49, s84
    v_mfma_f32_16x16x32_bf16 v[68:71], v[36:39], v[156:159], v[68:71]
    s_cmp_lg_u32 s53, 6
    s_cbranch_scc1 L_ncb6
    buffer_load_dwordx4 v[216:219], v86, s[40:43], s74 offen
    s_add_u32 s74, s74, s82
    buffer_load_dwordx4 v[220:223], v86, s[40:43], s74 offen
    s_add_u32 s74, s74, s82
    buffer_load_dwordx4 v[224:227], v86, s[40:43], s74 offen
    s_add_u32 s74, s74, s82
    buffer_load_dwordx4 v[228:231], v86, s[40:43], s74 offen
    s_add_u32 s74, s74, s82
    buffer_load_dwordx4 v[232:235], v86, s[40:43], s74 offen
    s_add_u32 s74, s74, s82
    buffer_load_dwordx4 v[236:239], v86, s[40:43], s74 offen
    s_add_u32 s74, s74, s82
    buffer_load_dwordx4 v[240:243], v86, s[40:43], s74 offen
    s_add_u32 s74, s74, s82
    buffer_load_dwordx4 v[244:247], v86, s[40:43], s74 offen
    s_add_u32 s74, s74, s82
    buffer_load_dwordx4 v[248:251], v86, s[40:43], s74 offen
    s_add_u32 s74, s74, s82
    buffer_load_dwordx4 v[252:255], v86, s[40:43], s74 offen
L_ncb6:
    s_cmp_lg_u32 s47, 0
    s_cbranch_scc1 L_pok16
    s_waitcnt vmcnt(4)
    v_cmp_le_u32 vcc, 1, v9
    s_nop 0
    s_cmp_eq_u64 vcc, -1
    s_cbranch_scc0 L_pslow16
L_pok16:
    s_waitcnt vmcnt(13)
    s_sub_u32 s73, s53, 6
    s_cmp_le_u32 s73, 0
    s_cbranch_scc1 L_cw6
    s_waitcnt vmcnt(3)
L_cw6:
    s_barrier
    ds_read_b128 v[160:163], v80 offset:0
    ds_read_b64_tr_b16 v[32:33], v1 offset:0
    ds_read_b128 v[164:167], v80 offset:2048
    ds_read_b64_tr_b16 v[34:35], v1 offset:512
    s_add_u32 m0, s50, 98304
    s_nop 0
    buffer_load_dwordx4 v84, s[4:7], s48 offen lds
    s_waitcnt lgkmcnt(6)
    v_mfma_f32_16x16x32_bf16 v[56:59], v[40:43], v[152:155], v[56:59]
    ds_read_b64_tr_b16 v[36:37], v2 offset:0
    v_mfma_f32_16x16x32_bf16 v[72:75], v[40:43], v[156:159], v[72:75]
    ds_read_b64_tr_b16 v[38:39], v2 offset:512
    buffer_load_dwordx4 v85, s[4:7], s48 offen offset:1024 lds
    s_waitcnt lgkmcnt(6)
    v_mfma_f32_16x16x32_bf16 v[60:63], v[44:47], v[152:155], v[60:63]
    ds_read_b64_tr_b16 v[40:41], v1 offset:1024
    s_add_u32 s48, s48, 128
    v_mfma_f32_16x16x32_bf16 v[76:79], v[44:47], v[156:159], v[76:79]
    ds_read_b64_tr_b16 v[42:43], v1 offset:1536
    s_add_u32 m0, s50, 32768
    s_nop 0
    buffer_load_dwordx4 v4, s[36:39], s49 offen lds
    s_waitcnt lgkmcnt(4)
    v_mfma_f32_16x16x32_bf16 v[48:51], v[32:35], v[160:163], v[48:51]
    ds_read_b64_tr_b16 v[44:45], v2 offset:1024
    v_mfma_f32_16x16x32_bf16 v[64:67], v[32:35], v[164:167], v[64:67]
    ds_read_b64_tr_b16 v[46:47], v2 offset:1536
    s_add_u32 m0, s50, 33792
    s_nop 0
    buffer_load_dwordx4 v5, s[64:67], s49 offen lds
    s_waitcnt lgkmcnt(4)
    v_mfma_f32_16x16x32_bf16 v[52:55], v[36:39], v[160:163], v[52:55]
    ds_read_b128 v[168:171], v81 offset:0
    ds_read_b64_tr_b16 v[32:33], v1 offset:8192
    v_mfma_f32_16x16x32_bf16 v[68:71], v[36:39], v[164:167], v[68:71]
    ds_read_b128 v[172:175], v81 offset:2048
    ds_read_b64_tr_b16 v[34:35], v1 offset:8704
    s_add_u32 s49, s49, s84
    s_bfe_u32 s69, s2, 0x40003
    s_and_b32 s58, s2, 7
    s_waitcnt lgkmcnt(6)
    v_mfma_f32_16x16x32_bf16 v[56:59], v[40:43], v[160:163], v[56:59]
    ds_read_b64_tr_b16 v[36:37], v2 offset:8192
    s_lshr_b32 s59, s2, 7
    s_lshl1_add_u32 s70, s58, s59
    v_mfma_f32_16x16x32_bf16 v[72:75], v[40:43], v[164:167], v[72:75]
    ds_read_b64_tr_b16 v[38:39], v2 offset:8704
    s_lshr_b32 s59, s58, 1
    s_bfe_u32 s60, s2, 0x30003
    s_lshl3_add_u32 s71, s59, s60
    s_waitcnt lgkmcnt(6)
    v_mfma_f32_16x16x32_bf16 v[60:63], v[44:47], v[160:163], v[60:63]
    ds_read_b64_tr_b16 v[40:41], v1 offset:9216
    s_and_b32 s59, s2, 1
    s_lshr_b32 s60, s2, 6
    v_mfma_f32_16x16x32_bf16 v[76:79], v[44:47], v[164:167], v[76:79]
    ds_read_b64_tr_b16 v[42:43], v1 offset:9728
    s_lshl2_add_u32 s72, s59, s60
    s_mul_i32 s58, s72, 68
    s_mul_i32 s59, s47, 12
    s_waitcnt lgkmcnt(4)
    v_mfma_f32_16x16x32_bf16 v[48:51], v[32:35], v[168:171], v[48:51]
    ds_read_b64_tr_b16 v[44:45], v2 offset:9216
    s_add_u32 s59, s58, s59
    s_mul_i32 s78, s59, 5120
    v_mfma_f32_16x16x32_bf16 v[64:67], v[32:35], v[172:175], v[64:67]
    ds_read_b64_tr_b16 v[46:47], v2 offset:9728
    s_add_u32 s78, s78, 20971520
    s_mul_i32 s83, s47, 20480
    s_cmp_eq_u32 s47, 3
    s_waitcnt lgkmcnt(4)
    v_mfma_f32_16x16x32_bf16 v[52:55], v[36:39], v[168:171], v[52:55]
    s_cselect_b32 s83, 134144, s83
    s_lshr_b32 s79, s71, 1
    v_mfma_f32_16x16x32_bf16 v[68:71], v[36:39], v[172:175], v[68:71]
    s_waitcnt vmcnt(14)
    s_sub_u32 s73, s53, 6
    s_cmp_le_u32 s73, 0
    s_cbranch_scc1 L_cw7
    s_waitcnt vmcnt(4)
L_cw7:
    s_barrier
    ds_read_b128 v[176:179], v80 offset:16384
    ds_read_b64_tr_b16 v[32:33], v1 offset:16384
    ds_read_b128 v[180:183], v80 offset:18432
    ds_read_b64_tr_b16 v[34:35], v1 offset:16896
    s_add_u32 m0, s50, 114688
    s_nop 0
    buffer_load_dwordx4 v84, s[4:7], s48 offen lds
    s_waitcnt lgkmcnt(6)
    v_mfma_f32_16x16x32_bf16 v[56:59], v[40:43], v[168:171], v[56:59]
    ds_read_b64_tr_b16 v[36:37], v2 offset:16384
    buffer_load_dwordx4 v85, s[4:7], s48 offen offset:1024 lds
    v_mfma_f32_16x16x32_bf16 v[72:75], v[40:43], v[172:175], v[72:75]
    ds_read_b64_tr_b16 v[38:39], v2 offset:16896
    s_waitcnt lgkmcnt(6)
    v_mfma_f32_16x16x32_bf16 v[60:63], v[44:47], v[168:171], v[60:63]
    ds_read_b64_tr_b16 v[40:41], v1 offset:17408
    s_add_u32 s48, s48, 128
    s_add_u32 m0, s50, 49152
    s_nop 0
    buffer_load_dwordx4 v4, s[36:39], s49 offen lds
    v_mfma_f32_16x16x32_bf16 v[76:79], v[44:47], v[172:175], v[76:79]
    ds_read_b64_tr_b16 v[42:43], v1 offset:17920
    s_waitcnt lgkmcnt(4)
    v_mfma_f32_16x16x32_bf16 v[48:51], v[32:35], v[176:179], v[48:51]
    ds_read_b64_tr_b16 v[44:45], v2 offset:17408
    s_add_u32 m0, s50, 50176
    s_nop 0
    buffer_load_dwordx4 v5, s[64:67], s49 offen lds
    v_mfma_f32_16x16x32_bf16 v[64:67], v[32:35], v[180:183], v[64:67]
    ds_read_b64_tr_b16 v[46:47], v2 offset:17920
    s_waitcnt lgkmcnt(4)
    v_mfma_f32_16x16x32_bf16 v[52:55], v[36:39], v[176:179], v[52:55]
    ds_read_b128 v[184:187], v81 offset:16384
    ds_read_b64_tr_b16 v[32:33], v1 offset:24576
    s_add_u32 s49, s49, s84
    s_mul_i32 s59, s71, 196608
    s_mul_i32 s58, s47, 12288
    v_mfma_f32_16x16x32_bf16 v[68:71], v[36:39], v[180:183], v[68:71]
    ds_read_b128 v[188:191], v81 offset:18432
    ds_read_b64_tr_b16 v[34:35], v1 offset:25088
    s_add_u32 s59, s59, s58
    s_add_u32 s59, s59, 9437184
    s_add_u32 s58, s47, 0
    s_waitcnt lgkmcnt(6)
    v_mfma_f32_16x16x32_bf16 v[56:59], v[40:43], v[176:179], v[56:59]
    ds_read_b64_tr_b16 v[36:37], v2 offset:24576
    s_and_b32 s58, s58, 3
    s_mul_i32 s58, s58, 49152
    s_add_u32 s40, s58, s59
    v_mfma_f32_16x16x32_bf16 v[72:75], v[40:43], v[180:183], v[72:75]
    ds_read_b64_tr_b16 v[38:39], v2 offset:25088
    s_add_u32 s58, s47, 1
    s_and_b32 s58, s58, 3
    s_waitcnt lgkmcnt(6)
    v_mfma_f32_16x16x32_bf16 v[60:63], v[44:47], v[176:179], v[60:63]
    ds_read_b64_tr_b16 v[40:41], v1 offset:25600
    s_mul_i32 s58, s58, 49152
    s_add_u32 s41, s58, s59
    s_add_u32 s58, s47, 2
    v_mfma_f32_16x16x32_bf16 v[76:79], v[44:47], v[180:183], v[76:79]
    ds_read_b64_tr_b16 v[42:43], v1 offset:26112
    s_and_b32 s58, s58, 3
    s_mul_i32 s58, s58, 49152
    s_add_u32 s42, s58, s59
    s_waitcnt lgkmcnt(4)
    v_mfma_f32_16x16x32_bf16 v[48:51], v[32:35], v[184:187], v[48:51]
    ds_read_b64_tr_b16 v[44:45], v2 offset:25600
    s_add_u32 s58, s47, 3
    s_and_b32 s58, s58, 3
    s_mul_i32 s58, s58, 49152
    v_mfma_f32_16x16x32_bf16 v[64:67], v[32:35], v[188:191], v[64:67]
    ds_read_b64_tr_b16 v[46:47], v2 offset:26112
    s_add_u32 s43, s58, s59
    s_mul_i32 s81, s69, 491520
    s_mul_i32 s59, s70, 10240
    s_waitcnt lgkmcnt(4)
    v_mfma_f32_16x16x32_bf16 v[52:55], v[36:39], v[184:187], v[52:55]
    s_add_u32 s81, s81, s59
    s_mul_i32 s82, s46, 768
    v_mfma_f32_16x16x32_bf16 v[68:71], v[36:39], v[188:191], v[68:71]
    s_waitcnt vmcnt(7)
    s_sub_u32 s58, s53, 5
    s_cmp_le_u32 s58, 1
    s_cbranch_scc0 L_cu5
    v_mfma_f32_16x16x32_bf16 v[92:95], v[88:91], v[216:219], 0
    v_mfma_f32_16x16x32_bf16 v[92:95], v[88:91], v[220:223], v[92:95]
    v_mfma_f32_16x16x32_bf16 v[92:95], v[88:91], v[224:227], v[92:95]
    v_mfma_f32_16x16x32_bf16 v[92:95], v[88:91], v[228:231], v[92:95]
    v_mfma_f32_16x16x32_bf16 v[92:95], v[88:91], v[232:235], v[92:95]
    v_mfma_f32_16x16x32_bf16 v[92:95], v[88:91], v[236:239], v[92:95]
    v_mfma_f32_16x16x32_bf16 v[92:95], v[88:91], v[240:243], v[92:95]
    v_mfma_f32_16x16x32_bf16 v[92:95], v[88:91], v[244:247], v[92:95]
    v_mfma_f32_16x16x32_bf16 v[92:95], v[88:91], v[248:251], v[92:95]
    v_mfma_f32_16x16x32_bf16 v[92:95], v[88:91], v[252:255], v[92:95]
    s_nop 7
    v_add_f32_dpp v220, v92, v92 row_ror:8 row_mask:0xf bank_mask:0xf
    v_add_f32_dpp v221, v93, v93 row_ror:8 row_mask:0xf bank_mask:0xf
    v_add_f32_dpp v222, v94, v94 row_ror:8 row_mask:0xf bank_mask:0xf
    v_add_f32_dpp v223, v95, v95 row_ror:8 row_mask:0xf bank_mask:0xf
    v_cvt_pk_bf16_f32 v92, v220, v221
    v_cvt_pk_bf16_f32 v93, v222, v223
    v_lshlrev_b32 v216, 16, v92
    v_and_b32 v217, 0xffff0000, v92
    v_lshlrev_b32 v218, 16, v93
    v_and_b32 v219, 0xffff0000, v93
    v_sub_f32 v216, v220, v216
    v_sub_f32 v217, v221, v217
    v_sub_f32 v218, v222, v218
    v_sub_f32 v219, v223, v219
    s_mov_b32 vcc_lo, 0xff00ff00
    s_mov_b32 vcc_hi, 0xff00ff00
    v_cvt_pk_bf16_f32 v94, v216, v217
    v_cvt_pk_bf16_f32 v95, v218, v219
    v_cndmask_b32 v92, v92, v94, vcc
    v_cndmask_b32 v93, v93, v95, vcc
    buffer_store_dwordx2 v[92:93], v87, s[20:23], s75 offen sc1
    s_nop 0
L_cu5:
    s_waitcnt vmcnt(4)
    s_barrier
    ds_read_b128 v[192:195], v80 offset:32768
    ds_read_b64_tr_b16 v[32:33], v1 offset:32768
    ds_read_b128 v[196:199], v80 offset:34816
    ds_read_b64_tr_b16 v[34:35], v1 offset:33280
    s_add_u32 m0, s50, 65536
    s_nop 0
    buffer_load_dwordx4 v84, s[4:7], s48 offen lds
    s_waitcnt lgkmcnt(6)
    v_mfma_f32_16x16x32_bf16 v[56:59], v[40:43], v[184:187], v[56:59]
    ds_read_b64_tr_b16 v[36:37], v2 offset:32768
    buffer_load_dwordx4 v85, s[4:7], s48 offen offset:1024 lds
    v_mfma_f32_16x16x32_bf16 v[72:75], v[40:43], v[188:191], v[72:75]
    ds_read_b64_tr_b16 v[38:39], v2 offset:33280
    s_waitcnt lgkmcnt(6)
    v_mfma_f32_16x16x32_bf16 v[60:63], v[44:47], v[184:187], v[60:63]
    ds_read_b64_tr_b16 v[40:41], v1 offset:33792
    s_add_u32 s48, s48, 128
    s_add_u32 m0, s50, 0
    s_nop 0
    buffer_load_dwordx4 v4, s[36:39], s49 offen lds
    v_mfma_f32_16x16x32_bf16 v[76:79], v[44:47], v[188:191], v[76:79]
    ds_read_b64_tr_b16 v[42:43], v1 offset:34304
    s_waitcnt lgkmcnt(4)
    v_mfma_f32_16x16x32_bf16 v[48:51], v[32:35], v[192:195], v[48:51]
    ds_read_b64_tr_b16 v[44:45], v2 offset:33792
    s_add_u32 m0, s50, 1024
    s_nop 0
    buffer_load_dwordx4 v5, s[64:67], s49 offen lds
    v_mfma_f32_16x16x32_bf16 v[64:67], v[32:35], v[196:199], v[64:67]
    ds_read_b64_tr_b16 v[46:47], v2 offset:34304
    s_add_u32 s49, s49, s84
    s_waitcnt lgkmcnt(4)
    v_mfma_f32_16x16x32_bf16 v[52:55], v[36:39], v[192:195], v[52:55]
    ds_read_b128 v[200:203], v81 offset:32768
    ds_read_b64_tr_b16 v[32:33], v1 offset:40960
    v_bfe_u32 v30, v0, 2, 2
    v_and_b32 v8, 3, v0
    v_mfma_f32_16x16x32_bf16 v[68:71], v[36:39], v[196:199], v[68:71]
    ds_read_b128 v[204:207], v81 offset:34816
    ds_read_b64_tr_b16 v[34:35], v1 offset:41472
    v_lshlrev_b32 v8, 13, v8
    s_waitcnt lgkmcnt(6)
    v_mfma_f32_16x16x32_bf16 v[56:59], v[40:43], v[192:195], v[56:59]
    ds_read_b64_tr_b16 v[36:37], v2 offset:40960
    v_lshl_add_u32 v8, v30, 8, v8
    v_bfe_u32 v30, v0, 3, 1
    v_mfma_f32_16x16x32_bf16 v[72:75], v[40:43], v[196:199], v[72:75]
    ds_read_b64_tr_b16 v[38:39], v2 offset:41472
    v_and_b32 v31, 7, v0
    s_waitcnt lgkmcnt(6)
    v_mfma_f32_16x16x32_bf16 v[60:63], v[44:47], v[192:195], v[60:63]
    ds_read_b64_tr_b16 v[40:41], v1 offset:41984
    v_lshlrev_b32 v31, 10, v31
    v_lshl_add_u32 v31, v30, 7, v31
    v_mfma_f32_16x16x32_bf16 v[76:79], v[44:47], v[196:199], v[76:79]
    ds_read_b64_tr_b16 v[42:43], v1 offset:42496
    s_lshl_b32 s59, s2, 7
    s_and_b32 s60, s59, 7296
    s_waitcnt lgkmcnt(4)
    v_mfma_f32_16x16x32_bf16 v[48:51], v[32:35], v[200:203], v[48:51]
    ds_read_b64_tr_b16 v[44:45], v2 offset:41984
    s_and_b32 s59, s59, 25344
    v_add_u32 v8, s60, v8
    v_mfma_f32_16x16x32_bf16 v[64:67], v[32:35], v[204:207], v[64:67]
    ds_read_b64_tr_b16 v[46:47], v2 offset:42496
    v_add_u32 v31, s59, v31
    s_mov_b32 vcc_lo, 0xffff0000
    s_waitcnt lgkmcnt(4)
    v_mfma_f32_16x16x32_bf16 v[52:55], v[36:39], v[200:203], v[52:55]
    s_mov_b32 vcc_hi, 0xffff0000
    v_cndmask_b32 v8, v8, v31, vcc
    v_mfma_f32_16x16x32_bf16 v[68:71], v[36:39], v[204:207], v[68:71]
    s_cmp_lg_u32 s47, 0
    s_cbranch_scc1 L_np17
    buffer_load_dword v9, v8, s[20:23], 0 offen sc1
L_np17:
    s_waitcnt vmcnt(4)
    s_barrier
    ds_read_b128 v[208:211], v80 offset:49152
    ds_read_b64_tr_b16 v[32:33], v1 offset:49152
    ds_read_b128 v[212:215], v80 offset:51200
    ds_read_b64_tr_b16 v[34:35], v1 offset:49664
    s_add_u32 m0, s50, 81920
    s_nop 0
    buffer_load_dwordx4 v84, s[4:7], s48 offen lds
    s_waitcnt lgkmcnt(6)
    v_mfma_f32_16x16x32_bf16 v[56:59], v[40:43], v[200:203], v[56:59]
    ds_read_b64_tr_b16 v[36:37], v2 offset:49152
    v_mfma_f32_16x16x32_bf16 v[72:75], v[40:43], v[204:207], v[72:75]
    ds_read_b64_tr_b16 v[38:39], v2 offset:49664
    s_waitcnt lgkmcnt(6)
    v_mfma_f32_16x16x32_bf16 v[60:63], v[44:47], v[200:203], v[60:63]
    ds_read_b64_tr_b16 v[40:41], v1 offset:50176
    buffer_load_dwordx4 v85, s[4:7], s48 offen offset:1024 lds
    v_mfma_f32_16x16x32_bf16 v[76:79], v[44:47], v[204:207], v[76:79]
    ds_read_b64_tr_b16 v[42:43], v1 offset:50688
    s_waitcnt lgkmcnt(4)
    v_mfma_f32_16x16x32_bf16 v[48:51], v[32:35], v[208:211], v[48:51]
    ds_read_b64_tr_b16 v[44:45], v2 offset:50176
    v_mfma_f32_16x16x32_bf16 v[64:67], v[32:35], v[212:215], v[64:67]
    ds_read_b64_tr_b16 v[46:47], v2 offset:50688
    s_add_u32 s48, s48, 128
    s_waitcnt lgkmcnt(4)
    v_mfma_f32_16x16x32_bf16 v[52:55], v[36:39], v[208:211], v[52:55]
    ds_read_b128 v[216:219], v81 offset:49152
    ds_read_b64_tr_b16 v[32:33], v1 offset:57344
    s_add_u32 m0, s50, 16384
    v_mfma_f32_16x16x32_bf16 v[68:71], v[36:39], v[212:215], v[68:71]
    ds_read_b128 v[220:223], v81 offset:51200
    ds_read_b64_tr_b16 v[34:35], v1 offset:57856
    buffer_load_dwordx4 v4, s[36:39], s49 offen lds
    s_waitcnt lgkmcnt(6)
    v_mfma_f32_16x16x32_bf16 v[56:59], v[40:43], v[208:211], v[56:59]
    ds_read_b64_tr_b16 v[36:37], v2 offset:57344
    v_mfma_f32_16x16x32_bf16 v[72:75], v[40:43], v[212:215], v[72:75]
    ds_read_b64_tr_b16 v[38:39], v2 offset:57856
    s_waitcnt lgkmcnt(6)
    v_mfma_f32_16x16x32_bf16 v[60:63], v[44:47], v[208:211], v[60:63]
    ds_read_b64_tr_b16 v[40:41], v1 offset:58368
    s_add_u32 m0, s50, 17408
    v_mfma_f32_16x16x32_bf16 v[76:79], v[44:47], v[212:215], v[76:79]
    ds_read_b64_tr_b16 v[42:43], v1 offset:58880
    buffer_load_dwordx4 v5, s[64:67], s49 offen lds
    s_waitcnt lgkmcnt(4)
    v_mfma_f32_16x16x32_bf16 v[48:51], v[32:35], v[216:219], v[48:51]
    ds_read_b64_tr_b16 v[44:45], v2 offset:58368
    v_mfma_f32_16x16x32_bf16 v[64:67], v[32:35], v[220:223], v[64:67]
    ds_read_b64_tr_b16 v[46:47], v2 offset:58880
    s_waitcnt lgkmcnt(4)
    v_mfma_f32_16x16x32_bf16 v[52:55], v[36:39], v[216:219], v[52:55]
    s_add_u32 s49, s49, s84
    v_mfma_f32_16x16x32_bf16 v[68:71], v[36:39], v[220:223], v[68:71]
    s_cmp_lg_u32 s47, 0
    s_cbranch_scc1 L_pok18
    s_waitcnt vmcnt(4)
    v_cmp_le_u32 vcc, 1, v9
    s_nop 0
    s_cmp_eq_u64 vcc, -1
    s_cbranch_scc0 L_pslow18
L_pok18:
    s_waitcnt vmcnt(4)
    s_barrier
    ds_read_b128 v[224:227], v80 offset:0
    ds_read_b64_tr_b16 v[32:33], v1 offset:0
    ds_read_b128 v[228:231], v80 offset:2048
    ds_read_b64_tr_b16 v[34:35], v1 offset:512
    v_and_b32 v30, 15, v0
    s_waitcnt lgkmcnt(6)
    v_mfma_f32_16x16x32_bf16 v[56:59], v[40:43], v[216:219], v[56:59]
    ds_read_b64_tr_b16 v[36:37], v2 offset:0
    v_mfma_f32_16x16x32_bf16 v[72:75], v[40:43], v[220:223], v[72:75]
    ds_read_b64_tr_b16 v[38:39], v2 offset:512
    v_lshlrev_b32 v30, 3, v30
    s_waitcnt lgkmcnt(6)
    v_mfma_f32_16x16x32_bf16 v[60:63], v[44:47], v[216:219], v[60:63]
    ds_read_b64_tr_b16 v[40:41], v1 offset:1024
    v_mfma_f32_16x16x32_bf16 v[76:79], v[44:47], v[220:223], v[76:79]
    ds_read_b64_tr_b16 v[42:43], v1 offset:1536
    s_lshl2_add_u32 s59, s44, s47
    s_waitcnt lgkmcnt(4)
    v_mfma_f32_16x16x32_bf16 v[48:51], v[32:35], v[224:227], v[48:51]
    ds_read_b64_tr_b16 v[44:45], v2 offset:1024
    s_lshl_b32 s59, s59, 8
    v_mfma_f32_16x16x32_bf16 v[64:67], v[32:35], v[228:231], v[64:67]
    ds_read_b64_tr_b16 v[46:47], v2 offset:1536
    s_add_u32 s59, s59, 65536
    s_waitcnt lgkmcnt(4)
    v_mfma_f32_16x16x32_bf16 v[52:55], v[36:39], v[224:227], v[52:55]
    ds_read_b128 v[232:235], v81 offset:0
    ds_read_b64_tr_b16 v[32:33], v1 offset:8192
    buffer_load_dwordx2 v[10:11], v30, s[20:23], s59 offen sc1
    v_mfma_f32_16x16x32_bf16 v[68:71], v[36:39], v[228:231], v[68:71]
    ds_read_b128 v[236:239], v81 offset:2048
    ds_read_b64_tr_b16 v[34:35], v1 offset:8704
    s_waitcnt lgkmcnt(6)
    v_mfma_f32_16x16x32_bf16 v[56:59], v[40:43], v[224:227], v[56:59]
    ds_read_b64_tr_b16 v[36:37], v2 offset:8192
    v_mfma_f32_16x16x32_bf16 v[72:75], v[40:43], v[228:231], v[72:75]
    ds_read_b64_tr_b16 v[38:39], v2 offset:8704
    s_waitcnt lgkmcnt(6)
    v_mfma_f32_16x16x32_bf16 v[60:63], v[44:47], v[224:227], v[60:63]
    ds_read_b64_tr_b16 v[40:41], v1 offset:9216
    buffer_load_dwordx2 v[16:17], v30, s[20:23], s59 offen offset:128 sc1
    v_mfma_f32_16x16x32_bf16 v[76:79], v[44:47], v[228:231], v[76:79]
    ds_read_b64_tr_b16 v[42:43], v1 offset:9728
    s_waitcnt lgkmcnt(4)
    v_mfma_f32_16x16x32_bf16 v[48:51], v[32:35], v[232:235], v[48:51]
    ds_read_b64_tr_b16 v[44:45], v2 offset:9216
    v_mfma_f32_16x16x32_bf16 v[64:67], v[32:35], v[236:239], v[64:67]
    ds_read_b64_tr_b16 v[46:47], v2 offset:9728
    s_waitcnt lgkmcnt(4)
    v_mfma_f32_16x16x32_bf16 v[52:55], v[36:39], v[232:235], v[52:55]
    v_mfma_f32_16x16x32_bf16 v[68:71], v[36:39], v[236:239], v[68:71]
    v_lshrrev_b32 v4, 3, v0
    v_mul_u32_u24 v4, 3840, v4
    v_add_u32 v4, v4, v28
    v_add_u32 v5, 244736, v4
    s_mul_i32 s49, s46, 30720
    s_add_u32 s49, s49, s76
    s_add_u32 m0, s50, 32768
    s_nop 0
    buffer_load_dwordx4 v4, s[8:11], s49 offen lds
    buffer_load_dwordx4 v5, s[8:11], s49 offen offset:1024 lds
    s_add_u32 s49, s49, 491520
    s_waitcnt vmcnt(4) lgkmcnt(0)
    s_barrier
    ds_read_b128 v[240:243], v80 offset:16384
    ds_read_b64_tr_b16 v[32:33], v1 offset:16384
    ds_read_b128 v[244:247], v80 offset:18432
    ds_read_b64_tr_b16 v[34:35], v1 offset:16896
    v_bfe_u32 v30, v0, 3, 1
    v_mfma_f32_16x16x32_bf16 v[56:59], v[40:43], v[232:235], v[56:59]
    ds_read_b64_tr_b16 v[36:37], v2 offset:16384
    v_and_b32 v31, 7, v0
    v_mfma_f32_16x16x32_bf16 v[72:75], v[40:43], v[236:239], v[72:75]
    ds_read_b64_tr_b16 v[38:39], v2 offset:16896
    v_lshlrev_b32 v31, 10, v31
    v_mfma_f32_16x16x32_bf16 v[60:63], v[44:47], v[232:235], v[60:63]
    ds_read_b64_tr_b16 v[40:41], v1 offset:17408
    v_mfma_f32_16x16x32_bf16 v[76:79], v[44:47], v[236:239], v[76:79]
    ds_read_b64_tr_b16 v[42:43], v1 offset:17920
    v_lshl_add_u32 v31, v30, 7, v31
    s_waitcnt lgkmcnt(4)
    v_mfma_f32_16x16x32_bf16 v[48:51], v[32:35], v[240:243], v[48:51]
    ds_read_b64_tr_b16 v[44:45], v2 offset:17408
    s_lshl_b32 s59, s2, 7
    v_mfma_f32_16x16x32_bf16 v[64:67], v[32:35], v[244:247], v[64:67]
    ds_read_b64_tr_b16 v[46:47], v2 offset:17920
    s_and_b32 s59, s59, 25344
    v_add_u32 v31, s59, v31
    s_waitcnt lgkmcnt(4)
    v_mfma_f32_16x16x32_bf16 v[52:55], v[36:39], v[240:243], v[52:55]
    ds_read_b128 v[248:251], v81 offset:16384
    ds_read_b64_tr_b16 v[32:33], v1 offset:24576
    v_mfma_f32_16x16x32_bf16 v[68:71], v[36:39], v[244:247], v[68:71]
    ds_read_b128 v[252:255], v81 offset:18432
    ds_read_b64_tr_b16 v[34:35], v1 offset:25088
    s_mul_i32 s59, s72, 5
    s_lshr_b32 s59, s59, 2
    s_waitcnt lgkmcnt(6)
    v_mfma_f32_16x16x32_bf16 v[56:59], v[40:43], v[240:243], v[56:59]
    ds_read_b64_tr_b16 v[36:37], v2 offset:24576
    v_lshrrev_b32 v8, 1, v0
    v_mfma_f32_16x16x32_bf16 v[72:75], v[40:43], v[244:247], v[72:75]
    ds_read_b64_tr_b16 v[38:39], v2 offset:25088
    v_lshl_add_u32 v8, v8, 3, v0
    s_waitcnt lgkmcnt(6)
    v_mfma_f32_16x16x32_bf16 v[60:63], v[44:47], v[240:243], v[60:63]
    ds_read_b64_tr_b16 v[40:41], v1 offset:25600
    v_mfma_f32_16x16x32_bf16 v[76:79], v[44:47], v[244:247], v[76:79]
    ds_read_b64_tr_b16 v[42:43], v1 offset:26112
    v_add_lshl_u32 v8, v8, s59, 7
    s_waitcnt lgkmcnt(4)
    v_mfma_f32_16x16x32_bf16 v[48:51], v[32:35], v[248:251], v[48:51]
    ds_read_b64_tr_b16 v[44:45], v2 offset:25600
    s_mov_b32 vcc_lo, 0
    v_mfma_f32_16x16x32_bf16 v[64:67], v[32:35], v[252:255], v[64:67]
    ds_read_b64_tr_b16 v[46:47], v2 offset:26112
    s_mov_b32 vcc_hi, 0xffff0000
    v_cndmask_b32 v8, v8, v31, vcc
    s_waitcnt lgkmcnt(4)
    v_mfma_f32_16x16x32_bf16 v[52:55], v[36:39], v[248:251], v[52:55]
    v_mfma_f32_16x16x32_bf16 v[68:71], v[36:39], v[252:255], v[68:71]
    s_add_u32 m0, s50, 49152
    s_nop 0
    buffer_load_dwordx4 v4, s[8:11], s49 offen lds
    buffer_load_dwordx4 v5, s[8:11], s49 offen offset:1024 lds
    s_add_u32 s49, s49, 491520
    s_add_u32 m0, s50, 0
    s_nop 0
    buffer_load_dwordx4 v4, s[8:11], s49 offen lds
    buffer_load_dwordx4 v5, s[8:11], s49 offen offset:1024 lds
    s_add_u32 s49, s49, 491520
    s_waitcnt vmcnt(4) lgkmcnt(0)
    s_barrier
    v_mov_b32 v12, v10
    v_mov_b32 v13, v10
    v_mov_b32 v14, v16
    v_mov_b32 v15, v16
    v_rsq_f32 v16, v11
    v_mov_b32 v10, v11
    v_mov_b32 v11, v17
    v_rsq_f32 v17, v17
    v_mul_f32 v16, 0xbfb8aa3b, v16
    v_mul_f32 v17, 0xbfb8aa3b, v17
    ds_read_b64_tr_b16 v[32:33], v1 offset:32768
    ds_read_b64_tr_b16 v[34:35], v1 offset:33280
    v_mfma_f32_16x16x32_bf16 v[56:59], v[40:43], v[248:251], v[56:59]
    ds_read_b64_tr_b16 v[36:37], v2 offset:32768
    v_mfma_f32_16x16x32_bf16 v[72:75], v[40:43], v[252:255], v[72:75]
    ds_read_b64_tr_b16 v[38:39], v2 offset:33280
    v_mfma_f32_16x16x32_bf16 v[60:63], v[44:47], v[248:251], v[60:63]
    v_add_u32 v29, v3, v1
    v_mfma_f32_16x16x32_bf16 v[76:79], v[44:47], v[252:255], v[76:79]
    ds_read_b64_tr_b16 v[40:41], v29 offset:0
    s_waitcnt lgkmcnt(3)
    v_mfma_f32_16x16x32_bf16 v[80:83], v[32:35], v[96:99], 0
    v_add_u32 v29, v3, v2
    v_mfma_f32_16x16x32_bf16 v[88:91], v[32:35], v[100:103], 0
    ds_read_b64_tr_b16 v[44:45], v29 offset:0
    s_waitcnt lgkmcnt(2)
    v_mfma_f32_16x16x32_bf16 v[84:87], v[36:39], v[96:99], 0
    v_add_u32 v29, v3, v1
    v_mfma_f32_16x16x32_bf16 v[92:95], v[36:39], v[100:103], 0
    ds_read_b64_tr_b16 v[32:33], v29 offset:2048
    s_waitcnt lgkmcnt(2)
    v_mfma_f32_16x16x16_bf16 v[48:51], v[40:41], v[12:13], v[48:51]
    v_add_u32 v29, v3, v2
    v_mfma_f32_16x16x16_bf16 v[64:67], v[40:41], v[14:15], v[64:67]
    ds_read_b64_tr_b16 v[36:37], v29 offset:2048
    s_waitcnt lgkmcnt(2)
    v_mfma_f32_16x16x16_bf16 v[52:55], v[44:45], v[12:13], v[52:55]
    ds_read_b64_tr_b16 v[40:41], v1 offset:40960
    v_mfma_f32_16x16x16_bf16 v[68:71], v[44:45], v[14:15], v[68:71]
    ds_read_b64_tr_b16 v[42:43], v1 offset:41472
    s_waitcnt lgkmcnt(3)
    v_mfma_f32_16x16x16_bf16 v[56:59], v[32:33], v[12:13], v[56:59]
    ds_read_b64_tr_b16 v[44:45], v2 offset:40960
    v_mfma_f32_16x16x16_bf16 v[72:75], v[32:33], v[14:15], v[72:75]
    ds_read_b64_tr_b16 v[46:47], v2 offset:41472
    s_waitcnt lgkmcnt(4)
    v_mfma_f32_16x16x16_bf16 v[60:63], v[36:37], v[12:13], v[60:63]
    ds_read_b64_tr_b16 v[32:33], v1 offset:33792
    v_mfma_f32_16x16x16_bf16 v[76:79], v[36:37], v[14:15], v[76:79]
    ds_read_b64_tr_b16 v[34:35], v1 offset:34304
    s_waitcnt lgkmcnt(4)
    v_mfma_f32_16x16x32_bf16 v[80:83], v[40:43], v[104:107], v[80:83]
    ds_read_b64_tr_b16 v[36:37], v2 offset:33792
    v_mfma_f32_16x16x32_bf16 v[88:91], v[40:43], v[108:111], v[88:91]
    ds_read_b64_tr_b16 v[38:39], v2 offset:34304
    s_waitcnt lgkmcnt(4)
    v_mfma_f32_16x16x32_bf16 v[84:87], v[44:47], v[104:107], v[84:87]
    ds_read_b64_tr_b16 v[40:41], v1 offset:41984
    v_mfma_f32_16x16x32_bf16 v[92:95], v[44:47], v[108:111], v[92:95]
    ds_read_b64_tr_b16 v[42:43], v1 offset:42496
    s_waitcnt lgkmcnt(4)
    v_mfma_f32_16x16x32_bf16 v[80:83], v[32:35], v[112:115], v[80:83]
    ds_read_b64_tr_b16 v[44:45], v2 offset:41984
    v_mfma_f32_16x16x32_bf16 v[88:91], v[32:35], v[116:119], v[88:91]
    ds_read_b64_tr_b16 v[46:47], v2 offset:42496
    s_add_u32 m0, s50, 16384
    s_nop 0
    buffer_load_dwordx4 v4, s[8:11], s49 offen lds
    buffer_load_dwordx4 v5, s[8:11], s49 offen offset:1024 lds
    s_add_u32 s49, s49, 491520
    s_bitcmp1_b32 s2, 6
    s_cbranch_scc1 L_tyA
    s_waitcnt lgkmcnt(4)
    v_mfma_f32_16x16x32_bf16 v[84:87], v[36:39], v[112:115], v[84:87]
    v_mfma_f32_16x16x32_bf16 v[92:95], v[36:39], v[116:119], v[92:95]
    s_waitcnt vmcnt(4) lgkmcnt(0)
    s_barrier
    ds_read_b64_tr_b16 v[32:33], v1 offset:49152
    ds_read_b64_tr_b16 v[34:35], v1 offset:49664
    v_mul_f32 v56, v48, v56
    v_mul_f32 v57, v49, v57
    v_mul_f32 v58, v50, v58
    v_mfma_f32_16x16x32_bf16 v[80:83], v[40:43], v[120:123], v[80:83]
    ds_read_b64_tr_b16 v[36:37], v2 offset:49152
    v_mul_f32 v59, v51, v59
    v_mul_f32 v48, v16, v48
    v_mfma_f32_16x16x32_bf16 v[88:91], v[40:43], v[124:127], v[88:91]
    ds_read_b64_tr_b16 v[38:39], v2 offset:49664
    v_mul_f32 v49, v16, v49
    v_mul_f32 v50, v16, v50
    v_mfma_f32_16x16x32_bf16 v[84:87], v[44:47], v[120:123], v[84:87]
    ds_read_b64_tr_b16 v[40:41], v1 offset:57344
    v_mul_f32 v51, v16, v51
    v_exp_f32 v48, v48
    v_mfma_f32_16x16x32_bf16 v[92:95], v[44:47], v[124:127], v[92:95]
    ds_read_b64_tr_b16 v[42:43], v1 offset:57856
    v_exp_f32 v49, v49
    s_waitcnt lgkmcnt(4)
    v_mfma_f32_16x16x32_bf16 v[80:83], v[32:35], v[128:131], v[80:83]
    ds_read_b64_tr_b16 v[44:45], v2 offset:57344
    v_exp_f32 v50, v50
    v_mfma_f32_16x16x32_bf16 v[88:91], v[32:35], v[132:135], v[88:91]
    ds_read_b64_tr_b16 v[46:47], v2 offset:57856
    v_exp_f32 v51, v51
    s_waitcnt lgkmcnt(4)
    v_mfma_f32_16x16x32_bf16 v[84:87], v[36:39], v[128:131], v[84:87]
    ds_read_b64_tr_b16 v[32:33], v1 offset:50176
    v_fma_f32 v48, v48, v10, v10
    v_mfma_f32_16x16x32_bf16 v[92:95], v[36:39], v[132:135], v[92:95]
    ds_read_b64_tr_b16 v[34:35], v1 offset:50688
    v_fma_f32 v49, v49, v10, v10
    v_fma_f32 v50, v50, v10, v10
    v_fma_f32 v51, v51, v10, v10
    s_waitcnt lgkmcnt(4)
    v_mfma_f32_16x16x32_bf16 v[80:83], v[40:43], v[136:139], v[80:83]
    ds_read_b64_tr_b16 v[36:37], v2 offset:50176
    v_rcp_f32 v48, v48
    v_mfma_f32_16x16x32_bf16 v[88:91], v[40:43], v[140:143], v[88:91]
    ds_read_b64_tr_b16 v[38:39], v2 offset:50688
    v_rcp_f32 v49, v49
    s_waitcnt lgkmcnt(4)
    v_mfma_f32_16x16x32_bf16 v[84:87], v[44:47], v[136:139], v[84:87]
    ds_read_b64_tr_b16 v[40:41], v1 offset:58368
    v_rcp_f32 v50, v50
    v_mfma_f32_16x16x32_bf16 v[92:95], v[44:47], v[140:143], v[92:95]
    ds_read_b64_tr_b16 v[42:43], v1 offset:58880
    v_rcp_f32 v51, v51
    s_waitcnt lgkmcnt(4)
    v_mfma_f32_16x16x32_bf16 v[80:83], v[32:35], v[144:147], v[80:83]
    ds_read_b64_tr_b16 v[44:45], v2 offset:58368
    v_mul_f32 v48, v48, v56
    v_mul_f32 v49, v49, v57
    v_mfma_f32_16x16x32_bf16 v[88:91], v[32:35], v[148:151], v[88:91]
    ds_read_b64_tr_b16 v[46:47], v2 offset:58880
    v_mul_f32 v50, v50, v58
    v_mul_f32 v51, v51, v59
    s_waitcnt lgkmcnt(4)
    v_mfma_f32_16x16x32_bf16 v[84:87], v[36:39], v[144:147], v[84:87]
    v_cvt_pk_bf16_f32 v20, v48, v49
    v_cvt_pk_bf16_f32 v21, v50, v51
    v_mfma_f32_16x16x32_bf16 v[92:95], v[36:39], v[148:151], v[92:95]
    s_add_u32 m0, s50, 32768
    s_nop 0
    buffer_load_dwordx4 v4, s[8:11], s49 offen lds
    buffer_load_dwordx4 v5, s[8:11], s49 offen offset:1024 lds
    s_add_u32 s49, s49, 491520
    s_waitcnt vmcnt(4) lgkmcnt(0)
    s_barrier
    ds_read_b64_tr_b16 v[32:33], v1 offset:0
    ds_read_b64_tr_b16 v[34:35], v1 offset:512
    v_mul_f32 v60, v52, v60
    v_mul_f32 v61, v53, v61
    v_mul_f32 v62, v54, v62
    v_mfma_f32_16x16x32_bf16 v[80:83], v[40:43], v[152:155], v[80:83]
    ds_read_b64_tr_b16 v[36:37], v2 offset:0
    v_mul_f32 v63, v55, v63
    v_mul_f32 v52, v16, v52
    v_mfma_f32_16x16x32_bf16 v[88:91], v[40:43], v[156:159], v[88:91]
    ds_read_b64_tr_b16 v[38:39], v2 offset:512
    v_mul_f32 v53, v16, v53
    v_mul_f32 v54, v16, v54
    v_mul_f32 v55, v16, v55
    v_mfma_f32_16x16x32_bf16 v[84:87], v[44:47], v[152:155], v[84:87]
    ds_read_b64_tr_b16 v[40:41], v1 offset:8192
    v_exp_f32 v52, v52
    v_mfma_f32_16x16x32_bf16 v[92:95], v[44:47], v[156:159], v[92:95]
    ds_read_b64_tr_b16 v[42:43], v1 offset:8704
    v_exp_f32 v53, v53
    v_exp_f32 v54, v54
    s_waitcnt lgkmcnt(4)
    v_mfma_f32_16x16x32_bf16 v[80:83], v[32:35], v[160:163], v[80:83]
    ds_read_b64_tr_b16 v[44:45], v2 offset:8192
    v_exp_f32 v55, v55
    v_mfma_f32_16x16x32_bf16 v[88:91], v[32:35], v[164:167], v[88:91]
    ds_read_b64_tr_b16 v[46:47], v2 offset:8704
    v_fma_f32 v52, v52, v10, v10
    s_waitcnt lgkmcnt(4)
    v_mfma_f32_16x16x32_bf16 v[84:87], v[36:39], v[160:163], v[84:87]
    ds_read_b64_tr_b16 v[32:33], v1 offset:1024
    v_fma_f32 v53, v53, v10, v10
    v_fma_f32 v54, v54, v10, v10
    v_fma_f32 v55, v55, v10, v10
    v_mfma_f32_16x16x32_bf16 v[92:95], v[36:39], v[164:167], v[92:95]
    ds_read_b64_tr_b16 v[34:35], v1 offset:1536
    v_rcp_f32 v52, v52
    s_waitcnt lgkmcnt(4)
    v_mfma_f32_16x16x32_bf16 v[80:83], v[40:43], v[168:171], v[80:83]
    ds_read_b64_tr_b16 v[36:37], v2 offset:1024
    v_rcp_f32 v53, v53
    v_rcp_f32 v54, v54
    v_mfma_f32_16x16x32_bf16 v[88:91], v[40:43], v[172:175], v[88:91]
    ds_read_b64_tr_b16 v[38:39], v2 offset:1536
    v_rcp_f32 v55, v55
    s_waitcnt lgkmcnt(4)
    v_mfma_f32_16x16x32_bf16 v[84:87], v[44:47], v[168:171], v[84:87]
    ds_read_b64_tr_b16 v[40:41], v1 offset:9216
    v_mul_f32 v52, v52, v60
    v_mfma_f32_16x16x32_bf16 v[92:95], v[44:47], v[172:175], v[92:95]
    ds_read_b64_tr_b16 v[42:43], v1 offset:9728
    v_mul_f32 v53, v53, v61
    v_mul_f32 v54, v54, v62
    v_mul_f32 v55, v55, v63
    s_waitcnt lgkmcnt(4)
    v_mfma_f32_16x16x32_bf16 v[80:83], v[32:35], v[176:179], v[80:83]
    ds_read_b64_tr_b16 v[44:45], v2 offset:9216
    v_cvt_pk_bf16_f32 v22, v52, v53
    v_cvt_pk_bf16_f32 v23, v54, v55
    v_mfma_f32_16x16x32_bf16 v[88:91], v[32:35], v[180:183], v[88:91]
    ds_read_b64_tr_b16 v[46:47], v2 offset:9728
    s_add_u32 s59, s55, 0
    v_permlane16_swap_b32 v20, v22
    v_permlane16_swap_b32 v21, v23
    s_waitcnt lgkmcnt(4)
    v_mfma_f32_16x16x32_bf16 v[84:87], v[36:39], v[176:179], v[84:87]
    buffer_store_dwordx4 v[20:23], v18, s[20:23], s59 offen sc1
    v_mfma_f32_16x16x32_bf16 v[92:95], v[36:39], v[180:183], v[92:95]
    v_lshrrev_b32 v4, 3, v0
    v_mul_u32_u24 v4, 3072, v4
    v_add_u32 v4, v4, v28
    v_xor_b32 v5, 0, v4
    s_mul_i32 s49, s46, 24576
    s_add_u32 s49, s49, s77
    s_add_u32 m0, s50, 49152
    s_nop 0
    buffer_load_dwordx4 v4, s[12:15], s49 offen lds
    s_add_u32 m0, s50, 50176
    s_nop 0
    buffer_load_dwordx4 v5, s[16:19], s49 offen lds
    s_add_u32 s49, s49, 196608
    s_waitcnt vmcnt(5) lgkmcnt(0)
    s_barrier
    ds_read_b64_tr_b16 v[32:33], v1 offset:16384
    ds_read_b64_tr_b16 v[34:35], v1 offset:16896
    v_mul_f32 v72, v64, v72
    v_mul_f32 v73, v65, v73
    v_mul_f32 v74, v66, v74
    v_mfma_f32_16x16x32_bf16 v[80:83], v[40:43], v[184:187], v[80:83]
    ds_read_b64_tr_b16 v[36:37], v2 offset:16384
    v_mul_f32 v75, v67, v75
    v_mul_f32 v64, v17, v64
    v_mfma_f32_16x16x32_bf16 v[88:91], v[40:43], v[188:191], v[88:91]
    ds_read_b64_tr_b16 v[38:39], v2 offset:16896
    v_mul_f32 v65, v17, v65
    v_mul_f32 v66, v17, v66
    v_mfma_f32_16x16x32_bf16 v[84:87], v[44:47], v[184:187], v[84:87]
    ds_read_b64_tr_b16 v[40:41], v1 offset:24576
    v_mul_f32 v67, v17, v67
    v_exp_f32 v64, v64
    v_mfma_f32_16x16x32_bf16 v[92:95], v[44:47], v[188:191], v[92:95]
    ds_read_b64_tr_b16 v[42:43], v1 offset:25088
    v_exp_f32 v65, v65
    s_waitcnt lgkmcnt(4)
    v_mfma_f32_16x16x32_bf16 v[80:83], v[32:35], v[192:195], v[80:83]
    ds_read_b64_tr_b16 v[44:45], v2 offset:24576
    v_exp_f32 v66, v66
    v_mfma_f32_16x16x32_bf16 v[88:91], v[32:35], v[196:199], v[88:91]
    ds_read_b64_tr_b16 v[46:47], v2 offset:25088
    v_exp_f32 v67, v67
    s_waitcnt lgkmcnt(4)
    v_mfma_f32_16x16x32_bf16 v[84:87], v[36:39], v[192:195], v[84:87]
    ds_read_b64_tr_b16 v[32:33], v1 offset:17408
    v_fma_f32 v64, v64, v11, v11
    v_mfma_f32_16x16x32_bf16 v[92:95], v[36:39], v[196:199], v[92:95]
    ds_read_b64_tr_b16 v[34:35], v1 offset:17920
    v_fma_f32 v65, v65, v11, v11
    v_fma_f32 v66, v66, v11, v11
    v_fma_f32 v67, v67, v11, v11
    s_waitcnt lgkmcnt(4)
    v_mfma_f32_16x16x32_bf16 v[80:83], v[40:43], v[200:203], v[80:83]
    ds_read_b64_tr_b16 v[36:37], v2 offset:17408
    v_rcp_f32 v64, v64
    v_mfma_f32_16x16x32_bf16 v[88:91], v[40:43], v[204:207], v[88:91]
    ds_read_b64_tr_b16 v[38:39], v2 offset:17920
    v_rcp_f32 v65, v65
    s_waitcnt lgkmcnt(4)
    v_mfma_f32_16x16x32_bf16 v[84:87], v[44:47], v[200:203], v[84:87]
    ds_read_b64_tr_b16 v[40:41], v1 offset:25600
    v_rcp_f32 v66, v66
    v_mfma_f32_16x16x32_bf16 v[92:95], v[44:47], v[204:207], v[92:95]
    ds_read_b64_tr_b16 v[42:43], v1 offset:26112
    v_rcp_f32 v67, v67
    s_waitcnt lgkmcnt(4)
    v_mfma_f32_16x16x32_bf16 v[80:83], v[32:35], v[208:211], v[80:83]
    ds_read_b64_tr_b16 v[44:45], v2 offset:25600
    v_mul_f32 v64, v64, v72
    v_mul_f32 v65, v65, v73
    v_mfma_f32_16x16x32_bf16 v[88:91], v[32:35], v[212:215], v[88:91]
    ds_read_b64_tr_b16 v[46:47], v2 offset:26112
    v_mul_f32 v66, v66, v74
    v_mul_f32 v67, v67, v75
    s_waitcnt lgkmcnt(4)
    v_mfma_f32_16x16x32_bf16 v[84:87], v[36:39], v[208:211], v[84:87]
    v_cvt_pk_bf16_f32 v20, v64, v65
    v_cvt_pk_bf16_f32 v21, v66, v67
    v_mfma_f32_16x16x32_bf16 v[92:95], v[36:39], v[212:215], v[92:95]
    s_add_u32 m0, s50, 0
    s_nop 0
    buffer_load_dwordx4 v4, s[12:15], s49 offen lds
    s_add_u32 m0, s50, 1024
    s_nop 0
    buffer_load_dwordx4 v5, s[16:19], s49 offen lds
    s_add_u32 s49, s49, 196608
    s_waitcnt vmcnt(5) lgkmcnt(0)
    s_barrier
    ds_read_b64_tr_b16 v[32:33], v1 offset:32768
    ds_read_b64_tr_b16 v[34:35], v1 offset:33280
    v_mul_f32 v76, v68, v76
    v_mul_f32 v77, v69, v77
    v_mfma_f32_16x16x32_bf16 v[80:83], v[40:43], v[216:219], v[80:83]
    ds_read_b64_tr_b16 v[36:37], v2 offset:32768
    v_mul_f32 v78, v70, v78
    v_mul_f32 v79, v71, v79
    v_mfma_f32_16x16x32_bf16 v[88:91], v[40:43], v[220:223], v[88:91]
    ds_read_b64_tr_b16 v[38:39], v2 offset:33280
    v_mul_f32 v68, v17, v68
    v_mul_f32 v69, v17, v69
    v_mfma_f32_16x16x32_bf16 v[84:87], v[44:47], v[216:219], v[84:87]
    v_add_u32 v29, v3, v1
    v_mul_f32 v70, v17, v70
    v_mul_f32 v71, v17, v71
    v_mfma_f32_16x16x32_bf16 v[92:95], v[44:47], v[220:223], v[92:95]
    ds_read_b64_tr_b16 v[40:41], v29 offset:8192
    v_exp_f32 v68, v68
    s_waitcnt lgkmcnt(3)
    v_mfma_f32_16x16x32_bf16 v[80:83], v[32:35], v[224:227], v[80:83]
    v_add_u32 v29, v3, v2
    v_exp_f32 v69, v69
    v_mfma_f32_16x16x32_bf16 v[88:91], v[32:35], v[228:231], v[88:91]
    ds_read_b64_tr_b16 v[44:45], v29 offset:8192
    v_exp_f32 v70, v70
    s_waitcnt lgkmcnt(2)
    v_mfma_f32_16x16x32_bf16 v[84:87], v[36:39], v[224:227], v[84:87]
    ds_read_b64_tr_b16 v[32:33], v1 offset:40960
    v_exp_f32 v71, v71
    v_mfma_f32_16x16x32_bf16 v[92:95], v[36:39], v[228:231], v[92:95]
    ds_read_b64_tr_b16 v[34:35], v1 offset:41472
    v_fma_f32 v68, v68, v11, v11
    v_fma_f32 v69, v69, v11, v11
    s_waitcnt lgkmcnt(3)
    v_mfma_f32_16x16x16_bf16 v[80:83], v[40:41], v[12:13], v[80:83]
    ds_read_b64_tr_b16 v[36:37], v2 offset:40960
    v_fma_f32 v70, v70, v11, v11
    v_fma_f32 v71, v71, v11, v11
    v_mfma_f32_16x16x16_bf16 v[88:91], v[40:41], v[14:15], v[88:91]
    ds_read_b64_tr_b16 v[38:39], v2 offset:41472
    v_rcp_f32 v68, v68
    s_waitcnt lgkmcnt(4)
    v_mfma_f32_16x16x16_bf16 v[84:87], v[44:45], v[12:13], v[84:87]
    ds_read_b64_tr_b16 v[40:41], v1 offset:33792
    v_rcp_f32 v69, v69
    v_mfma_f32_16x16x16_bf16 v[92:95], v[44:45], v[14:15], v[92:95]
    ds_read_b64_tr_b16 v[42:43], v1 offset:34304
    v_rcp_f32 v70, v70
    s_waitcnt lgkmcnt(4)
    v_mfma_f32_16x16x32_bf16 v[80:83], v[32:35], v[232:235], v[80:83]
    ds_read_b64_tr_b16 v[44:45], v2 offset:33792
    v_rcp_f32 v71, v71
    v_mfma_f32_16x16x32_bf16 v[88:91], v[32:35], v[236:239], v[88:91]
    ds_read_b64_tr_b16 v[46:47], v2 offset:34304
    v_mul_f32 v68, v68, v76
    s_waitcnt lgkmcnt(4)
    v_mfma_f32_16x16x32_bf16 v[84:87], v[36:39], v[232:235], v[84:87]
    ds_read_b64_tr_b16 v[32:33], v1 offset:41984
    v_mul_f32 v69, v69, v77
    v_mul_f32 v70, v70, v78
    v_mfma_f32_16x16x32_bf16 v[92:95], v[36:39], v[236:239], v[92:95]
    ds_read_b64_tr_b16 v[34:35], v1 offset:42496
    v_mul_f32 v71, v71, v79
    v_cvt_pk_bf16_f32 v22, v68, v69
    s_waitcnt lgkmcnt(4)
    v_mfma_f32_16x16x32_bf16 v[80:83], v[40:43], v[240:243], v[80:83]
    ds_read_b64_tr_b16 v[36:37], v2 offset:41984
    v_cvt_pk_bf16_f32 v23, v70, v71
    s_add_u32 s59, s55, 49152
    v_permlane16_swap_b32 v20, v22
    v_mfma_f32_16x16x32_bf16 v[88:91], v[40:43], v[244:247], v[88:91]
    ds_read_b64_tr_b16 v[38:39], v2 offset:42496
    v_permlane16_swap_b32 v21, v23
    buffer_store_dwordx4 v[20:23], v18, s[20:23], s59 offen sc1
    s_add_u32 m0, s50, 16384
    s_nop 0
    buffer_load_dwordx4 v4, s[12:15], s49 offen lds
    s_add_u32 m0, s50, 17408
    s_nop 0
    buffer_load_dwordx4 v5, s[16:19], s49 offen lds
    s_add_u32 s49, s49, 196608
    s_cmp_lg_u32 s47, 0
    s_cbranch_scc1 L_np19
    buffer_load_dword v9, v8, s[20:23], 0 offen sc1
L_np19:
    s_nop 1
    s_branch L_tjA
L_tyA:
    s_waitcnt lgkmcnt(4)
    v_mfma_f32_16x16x32_bf16 v[84:87], v[36:39], v[112:115], v[84:87]
    v_mfma_f32_16x16x32_bf16 v[92:95], v[36:39], v[116:119], v[92:95]
    s_waitcnt vmcnt(4) lgkmcnt(0)
    s_barrier
    ds_read_b64_tr_b16 v[32:33], v1 offset:49152
    ds_read_b64_tr_b16 v[34:35], v1 offset:49664
    v_mul_f32 v30, s54, v16
    v_mul_f32 v48, v30, v48
    v_mfma_f32_16x16x32_bf16 v[80:83], v[40:43], v[120:123], v[80:83]
    ds_read_b64_tr_b16 v[36:37], v2 offset:49152
    v_mul_f32 v49, v30, v49
    v_mfma_f32_16x16x32_bf16 v[88:91], v[40:43], v[124:127], v[88:91]
    ds_read_b64_tr_b16 v[38:39], v2 offset:49664
    v_mul_f32 v50, v30, v50
    v_mfma_f32_16x16x32_bf16 v[84:87], v[44:47], v[120:123], v[84:87]
    ds_read_b64_tr_b16 v[40:41], v1 offset:57344
    v_mul_f32 v51, v30, v51
    v_mfma_f32_16x16x32_bf16 v[92:95], v[44:47], v[124:127], v[92:95]
    ds_read_b64_tr_b16 v[42:43], v1 offset:57856
    v_mul_f32 v52, v30, v52
    s_waitcnt lgkmcnt(4)
    v_mfma_f32_16x16x32_bf16 v[80:83], v[32:35], v[128:131], v[80:83]
    ds_read_b64_tr_b16 v[44:45], v2 offset:57344
    v_mul_f32 v53, v30, v53
    v_mfma_f32_16x16x32_bf16 v[88:91], v[32:35], v[132:135], v[88:91]
    ds_read_b64_tr_b16 v[46:47], v2 offset:57856
    v_mul_f32 v54, v30, v54
    s_waitcnt lgkmcnt(4)
    v_mfma_f32_16x16x32_bf16 v[84:87], v[36:39], v[128:131], v[84:87]
    ds_read_b64_tr_b16 v[32:33], v1 offset:50176
    v_mul_f32 v55, v30, v55
    v_mfma_f32_16x16x32_bf16 v[92:95], v[36:39], v[132:135], v[92:95]
    ds_read_b64_tr_b16 v[34:35], v1 offset:50688
    v_cvt_pk_bf16_f32 v48, v48, v49
    s_waitcnt lgkmcnt(4)
    v_mfma_f32_16x16x32_bf16 v[80:83], v[40:43], v[136:139], v[80:83]
    ds_read_b64_tr_b16 v[36:37], v2 offset:50176
    v_cvt_pk_bf16_f32 v49, v50, v51
    v_mfma_f32_16x16x32_bf16 v[88:91], v[40:43], v[140:143], v[88:91]
    ds_read_b64_tr_b16 v[38:39], v2 offset:50688
    v_cvt_pk_bf16_f32 v50, v52, v53
    v_cvt_pk_bf16_f32 v51, v54, v55
    s_waitcnt lgkmcnt(4)
    v_mfma_f32_16x16x32_bf16 v[84:87], v[44:47], v[136:139], v[84:87]
    ds_read_b64_tr_b16 v[40:41], v1 offset:58368
    s_add_u32 s59, s57, 0
    v_mfma_f32_16x16x32_bf16 v[92:95], v[44:47], v[140:143], v[92:95]
    ds_read_b64_tr_b16 v[42:43], v1 offset:58880
    v_permlane16_swap_b32 v48, v50
    s_waitcnt lgkmcnt(4)
    v_mfma_f32_16x16x32_bf16 v[80:83], v[32:35], v[144:147], v[80:83]
    ds_read_b64_tr_b16 v[44:45], v2 offset:58368
    v_permlane16_swap_b32 v49, v51
    v_mfma_f32_16x16x32_bf16 v[88:91], v[32:35], v[148:151], v[88:91]
    ds_read_b64_tr_b16 v[46:47], v2 offset:58880
    buffer_store_dwordx4 v[48:51], v19, s[20:23], s59 offen sc1
    s_waitcnt lgkmcnt(4)
    v_mfma_f32_16x16x32_bf16 v[84:87], v[36:39], v[144:147], v[84:87]
    v_mfma_f32_16x16x32_bf16 v[92:95], v[36:39], v[148:151], v[92:95]
    s_add_u32 m0, s50, 32768
    s_nop 0
    buffer_load_dwordx4 v4, s[8:11], s49 offen lds
    buffer_load_dwordx4 v5, s[8:11], s49 offen offset:1024 lds
    s_add_u32 s49, s49, 491520
    s_waitcnt vmcnt(4) lgkmcnt(0)
    s_barrier
    ds_read_b64_tr_b16 v[32:33], v1 offset:0
    ds_read_b64_tr_b16 v[34:35], v1 offset:512
    v_mul_f32 v30, s54, v16
    v_mul_f32 v56, v30, v56
    v_mfma_f32_16x16x32_bf16 v[80:83], v[40:43], v[152:155], v[80:83]
    ds_read_b64_tr_b16 v[36:37], v2 offset:0
    v_mul_f32 v57, v30, v57
    v_mfma_f32_16x16x32_bf16 v[88:91], v[40:43], v[156:159], v[88:91]
    ds_read_b64_tr_b16 v[38:39], v2 offset:512
    v_mul_f32 v58, v30, v58
    v_mfma_f32_16x16x32_bf16 v[84:87], v[44:47], v[152:155], v[84:87]
    ds_read_b64_tr_b16 v[40:41], v1 offset:8192
    v_mul_f32 v59, v30, v59
    v_mfma_f32_16x16x32_bf16 v[92:95], v[44:47], v[156:159], v[92:95]
    ds_read_b64_tr_b16 v[42:43], v1 offset:8704
    v_mul_f32 v60, v30, v60
    s_waitcnt lgkmcnt(4)
    v_mfma_f32_16x16x32_bf16 v[80:83], v[32:35], v[160:163], v[80:83]
    ds_read_b64_tr_b16 v[44:45], v2 offset:8192
    v_mul_f32 v61, v30, v61
    v_mfma_f32_16x16x32_bf16 v[88:91], v[32:35], v[164:167], v[88:91]
    ds_read_b64_tr_b16 v[46:47], v2 offset:8704
    v_mul_f32 v62, v30, v62
    s_waitcnt lgkmcnt(4)
    v_mfma_f32_16x16x32_bf16 v[84:87], v[36:39], v[160:163], v[84:87]
    ds_read_b64_tr_b16 v[32:33], v1 offset:1024
    v_mul_f32 v63, v30, v63
    v_mfma_f32_16x16x32_bf16 v[92:95], v[36:39], v[164:167], v[92:95]
    ds_read_b64_tr_b16 v[34:35], v1 offset:1536
    v_cvt_pk_bf16_f32 v56, v56, v57
    s_waitcnt lgkmcnt(4)
    v_mfma_f32_16x16x32_bf16 v[80:83], v[40:43], v[168:171], v[80:83]
    ds_read_b64_tr_b16 v[36:37], v2 offset:1024
    v_cvt_pk_bf16_f32 v57, v58, v59
    v_mfma_f32_16x16x32_bf16 v[88:91], v[40:43], v[172:175], v[88:91]
    ds_read_b64_tr_b16 v[38:39], v2 offset:1536
    v_cvt_pk_bf16_f32 v58, v60, v61
    v_cvt_pk_bf16_f32 v59, v62, v63
    s_waitcnt lgkmcnt(4)
    v_mfma_f32_16x16x32_bf16 v[84:87], v[44:47], v[168:171], v[84:87]
    ds_read_b64_tr_b16 v[40:41], v1 offset:9216
    s_add_u32 s59, s57, 16384
    v_mfma_f32_16x16x32_bf16 v[92:95], v[44:47], v[172:175], v[92:95]
    ds_read_b64_tr_b16 v[42:43], v1 offset:9728
    v_permlane16_swap_b32 v56, v58
    s_waitcnt lgkmcnt(4)
    v_mfma_f32_16x16x32_bf16 v[80:83], v[32:35], v[176:179], v[80:83]
    ds_read_b64_tr_b16 v[44:45], v2 offset:9216
    v_permlane16_swap_b32 v57, v59
    v_mfma_f32_16x16x32_bf16 v[88:91], v[32:35], v[180:183], v[88:91]
    ds_read_b64_tr_b16 v[46:47], v2 offset:9728
    buffer_store_dwordx4 v[56:59], v19, s[20:23], s59 offen sc1
    s_waitcnt lgkmcnt(4)
    v_mfma_f32_16x16x32_bf16 v[84:87], v[36:39], v[176:179], v[84:87]
    v_mfma_f32_16x16x32_bf16 v[92:95], v[36:39], v[180:183], v[92:95]
    v_lshrrev_b32 v4, 3, v0
    v_mul_u32_u24 v4, 3072, v4
    v_add_u32 v4, v4, v28
    v_xor_b32 v5, 0, v4
    s_mul_i32 s49, s46, 24576
    s_add_u32 s49, s49, s77
    s_add_u32 m0, s50, 49152
    s_nop 0
    buffer_load_dwordx4 v4, s[12:15], s49 offen lds
    s_add_u32 m0, s50, 50176
    s_nop 0
    buffer_load_dwordx4 v5, s[16:19], s49 offen lds
    s_add_u32 s49, s49, 196608
    s_waitcnt vmcnt(5) lgkmcnt(0)
    s_barrier
    ds_read_b64_tr_b16 v[32:33], v1 offset:16384
    ds_read_b64_tr_b16 v[34:35], v1 offset:16896
    v_mul_f32 v30, s54, v17
    v_mul_f32 v64, v30, v64
    v_mfma_f32_16x16x32_bf16 v[80:83], v[40:43], v[184:187], v[80:83]
    ds_read_b64_tr_b16 v[36:37], v2 offset:16384
    v_mul_f32 v65, v30, v65
    v_mfma_f32_16x16x32_bf16 v[88:91], v[40:43], v[188:191], v[88:91]
    ds_read_b64_tr_b16 v[38:39], v2 offset:16896
    v_mul_f32 v66, v30, v66
    v_mfma_f32_16x16x32_bf16 v[84:87], v[44:47], v[184:187], v[84:87]
    ds_read_b64_tr_b16 v[40:41], v1 offset:24576
    v_mul_f32 v67, v30, v67
    v_mfma_f32_16x16x32_bf16 v[92:95], v[44:47], v[188:191], v[92:95]
    ds_read_b64_tr_b16 v[42:43], v1 offset:25088
    v_mul_f32 v68, v30, v68
    s_waitcnt lgkmcnt(4)
    v_mfma_f32_16x16x32_bf16 v[80:83], v[32:35], v[192:195], v[80:83]
    ds_read_b64_tr_b16 v[44:45], v2 offset:24576
    v_mul_f32 v69, v30, v69
    v_mfma_f32_16x16x32_bf16 v[88:91], v[32:35], v[196:199], v[88:91]
    ds_read_b64_tr_b16 v[46:47], v2 offset:25088
    v_mul_f32 v70, v30, v70
    s_waitcnt lgkmcnt(4)
    v_mfma_f32_16x16x32_bf16 v[84:87], v[36:39], v[192:195], v[84:87]
    ds_read_b64_tr_b16 v[32:33], v1 offset:17408
    v_mul_f32 v71, v30, v71
    v_mfma_f32_16x16x32_bf16 v[92:95], v[36:39], v[196:199], v[92:95]
    ds_read_b64_tr_b16 v[34:35], v1 offset:17920
    v_cvt_pk_bf16_f32 v64, v64, v65
    s_waitcnt lgkmcnt(4)
    v_mfma_f32_16x16x32_bf16 v[80:83], v[40:43], v[200:203], v[80:83]
    ds_read_b64_tr_b16 v[36:37], v2 offset:17408
    v_cvt_pk_bf16_f32 v65, v66, v67
    v_mfma_f32_16x16x32_bf16 v[88:91], v[40:43], v[204:207], v[88:91]
    ds_read_b64_tr_b16 v[38:39], v2 offset:17920
    v_cvt_pk_bf16_f32 v66, v68, v69
    v_cvt_pk_bf16_f32 v67, v70, v71
    s_waitcnt lgkmcnt(4)
    v_mfma_f32_16x16x32_bf16 v[84:87], v[44:47], v[200:203], v[84:87]
    ds_read_b64_tr_b16 v[40:41], v1 offset:25600
    s_add_u32 s59, s57, 256
    v_mfma_f32_16x16x32_bf16 v[92:95], v[44:47], v[204:207], v[92:95]
    ds_read_b64_tr_b16 v[42:43], v1 offset:26112
    v_permlane16_swap_b32 v64, v66
    s_waitcnt lgkmcnt(4)
    v_mfma_f32_16x16x32_bf16 v[80:83], v[32:35], v[208:211], v[80:83]
    ds_read_b64_tr_b16 v[44:45], v2 offset:25600
    v_permlane16_swap_b32 v65, v67
    v_mfma_f32_16x16x32_bf16 v[88:91], v[32:35], v[212:215], v[88:91]
    ds_read_b64_tr_b16 v[46:47], v2 offset:26112
    buffer_store_dwordx4 v[64:67], v19, s[20:23], s59 offen sc1
    s_waitcnt lgkmcnt(4)
    v_mfma_f32_16x16x32_bf16 v[84:87], v[36:39], v[208:211], v[84:87]
    v_mfma_f32_16x16x32_bf16 v[92:95], v[36:39], v[212:215], v[92:95]
    s_add_u32 m0, s50, 0
    s_nop 0
    buffer_load_dwordx4 v4, s[12:15], s49 offen lds
    s_add_u32 m0, s50, 1024
    s_nop 0
    buffer_load_dwordx4 v5, s[16:19], s49 offen lds
    s_add_u32 s49, s49, 196608
    s_waitcnt vmcnt(5) lgkmcnt(0)
    s_barrier
    ds_read_b64_tr_b16 v[32:33], v1 offset:32768
    ds_read_b64_tr_b16 v[34:35], v1 offset:33280
    v_mul_f32 v30, s54, v17
    v_mfma_f32_16x16x32_bf16 v[80:83], v[40:43], v[216:219], v[80:83]
    ds_read_b64_tr_b16 v[36:37], v2 offset:32768
    v_mul_f32 v72, v30, v72
    v_mfma_f32_16x16x32_bf16 v[88:91], v[40:43], v[220:223], v[88:91]
    ds_read_b64_tr_b16 v[38:39], v2 offset:33280
    v_mul_f32 v73, v30, v73
    v_mfma_f32_16x16x32_bf16 v[84:87], v[44:47], v[216:219], v[84:87]
    v_add_u32 v29, v3, v1
    v_mul_f32 v74, v30, v74
    v_mfma_f32_16x16x32_bf16 v[92:95], v[44:47], v[220:223], v[92:95]
    ds_read_b64_tr_b16 v[40:41], v29 offset:8192
    v_mul_f32 v75, v30, v75
    s_waitcnt lgkmcnt(3)
    v_mfma_f32_16x16x32_bf16 v[80:83], v[32:35], v[224:227], v[80:83]
    v_add_u32 v29, v3, v2
    v_mul_f32 v76, v30, v76
    v_mfma_f32_16x16x32_bf16 v[88:91], v[32:35], v[228:231], v[88:91]
    ds_read_b64_tr_b16 v[44:45], v29 offset:8192
    v_mul_f32 v77, v30, v77
    s_waitcnt lgkmcnt(2)
    v_mfma_f32_16x16x32_bf16 v[84:87], v[36:39], v[224:227], v[84:87]
    ds_read_b64_tr_b16 v[32:33], v1 offset:40960
    v_mfma_f32_16x16x32_bf16 v[92:95], v[36:39], v[228:231], v[92:95]
    ds_read_b64_tr_b16 v[34:35], v1 offset:41472
    v_mul_f32 v78, v30, v78
    s_waitcnt lgkmcnt(3)
    v_mfma_f32_16x16x16_bf16 v[80:83], v[40:41], v[12:13], v[80:83]
    ds_read_b64_tr_b16 v[36:37], v2 offset:40960
    v_mul_f32 v79, v30, v79
    v_mfma_f32_16x16x16_bf16 v[88:91], v[40:41], v[14:15], v[88:91]
    ds_read_b64_tr_b16 v[38:39], v2 offset:41472
    v_cvt_pk_bf16_f32 v72, v72, v73
    s_waitcnt lgkmcnt(4)
    v_mfma_f32_16x16x16_bf16 v[84:87], v[44:45], v[12:13], v[84:87]
    ds_read_b64_tr_b16 v[40:41], v1 offset:33792
    v_cvt_pk_bf16_f32 v73, v74, v75
    v_mfma_f32_16x16x16_bf16 v[92:95], v[44:45], v[14:15], v[92:95]
    ds_read_b64_tr_b16 v[42:43], v1 offset:34304
    v_cvt_pk_bf16_f32 v74, v76, v77
    s_waitcnt lgkmcnt(4)
    v_mfma_f32_16x16x32_bf16 v[80:83], v[32:35], v[232:235], v[80:83]
    ds_read_b64_tr_b16 v[44:45], v2 offset:33792
    v_cvt_pk_bf16_f32 v75, v78, v79
    v_mfma_f32_16x16x32_bf16 v[88:91], v[32:35], v[236:239], v[88:91]
    ds_read_b64_tr_b16 v[46:47], v2 offset:34304
    s_add_u32 s59, s57, 16640
    s_waitcnt lgkmcnt(4)
    v_mfma_f32_16x16x32_bf16 v[84:87], v[36:39], v[232:235], v[84:87]
    ds_read_b64_tr_b16 v[32:33], v1 offset:41984
    v_permlane16_swap_b32 v72, v74
    v_mfma_f32_16x16x32_bf16 v[92:95], v[36:39], v[236:239], v[92:95]
    ds_read_b64_tr_b16 v[34:35], v1 offset:42496
    v_permlane16_swap_b32 v73, v75
    s_waitcnt lgkmcnt(4)
    v_mfma_f32_16x16x32_bf16 v[80:83], v[40:43], v[240:243], v[80:83]
    ds_read_b64_tr_b16 v[36:37], v2 offset:41984
    buffer_store_dwordx4 v[72:75], v19, s[20:23], s59 offen sc1
    v_mfma_f32_16x16x32_bf16 v[88:91], v[40:43], v[244:247], v[88:91]
    ds_read_b64_tr_b16 v[38:39], v2 offset:42496
    s_add_u32 m0, s50, 16384
    s_nop 0
    buffer_load_dwordx4 v4, s[12:15], s49 offen lds
    s_add_u32 m0, s50, 17408
    s_nop 0
    buffer_load_dwordx4 v5, s[16:19], s49 offen lds
    s_add_u32 s49, s49, 196608
    s_cmp_lg_u32 s47, 0
    s_cbranch_scc1 L_np20
    buffer_load_dword v9, v8, s[20:23], 0 offen sc1
L_np20:
    s_nop 1
L_tjA:
    s_waitcnt lgkmcnt(4)
    v_mfma_f32_16x16x32_bf16 v[84:87], v[44:47], v[240:243], v[84:87]
    v_mfma_f32_16x16x32_bf16 v[92:95], v[44:47], v[244:247], v[92:95]
    s_waitcnt vmcnt(5) lgkmcnt(0)
    s_barrier
    ds_read_b64_tr_b16 v[40:41], v1 offset:49152
    ds_read_b64_tr_b16 v[42:43], v1 offset:49664
    v_mfma_f32_16x16x32_bf16 v[80:83], v[32:35], v[248:251], v[80:83]
    ds_read_b64_tr_b16 v[44:45], v2 offset:49152
    v_mfma_f32_16x16x32_bf16 v[88:91], v[32:35], v[252:255], v[88:91]
    ds_read_b64_tr_b16 v[46:47], v2 offset:49664
    v_mfma_f32_16x16x32_bf16 v[84:87], v[36:39], v[248:251], v[84:87]
    ds_read_b64_tr_b16 v[32:33], v1 offset:50176
    v_mfma_f32_16x16x32_bf16 v[92:95], v[36:39], v[252:255], v[92:95]
    ds_read_b64_tr_b16 v[34:35], v1 offset:50688
    s_waitcnt lgkmcnt(4)
    v_mfma_f32_16x16x32_bf16 v[48:51], v[40:43], v[96:99], 0
    ds_read_b64_tr_b16 v[36:37], v2 offset:50176
    v_mfma_f32_16x16x32_bf16 v[64:67], v[40:43], v[100:103], 0
    ds_read_b64_tr_b16 v[38:39], v2 offset:50688
    s_waitcnt lgkmcnt(4)
    v_mfma_f32_16x16x32_bf16 v[52:55], v[44:47], v[96:99], 0
    ds_read_b64_tr_b16 v[40:41], v1 offset:57344
    v_mfma_f32_16x16x32_bf16 v[68:71], v[44:47], v[100:103], 0
    ds_read_b64_tr_b16 v[42:43], v1 offset:57856
    s_waitcnt lgkmcnt(4)
    v_mfma_f32_16x16x32_bf16 v[56:59], v[32:35], v[96:99], 0
    ds_read_b64_tr_b16 v[44:45], v2 offset:57344
    v_mfma_f32_16x16x32_bf16 v[72:75], v[32:35], v[100:103], 0
    ds_read_b64_tr_b16 v[46:47], v2 offset:57856
    s_waitcnt lgkmcnt(4)
    v_mfma_f32_16x16x32_bf16 v[60:63], v[36:39], v[96:99], 0
    ds_read_b64_tr_b16 v[32:33], v1 offset:58368
    v_mfma_f32_16x16x32_bf16 v[76:79], v[36:39], v[100:103], 0
    ds_read_b64_tr_b16 v[34:35], v1 offset:58880
    s_waitcnt lgkmcnt(4)
    v_mfma_f32_16x16x32_bf16 v[48:51], v[40:43], v[104:107], v[48:51]
    ds_read_b64_tr_b16 v[36:37], v2 offset:58368
    v_mfma_f32_16x16x32_bf16 v[64:67], v[40:43], v[108:111], v[64:67]
    ds_read_b64_tr_b16 v[38:39], v2 offset:58880
    s_waitcnt lgkmcnt(4)
    v_mfma_f32_16x16x32_bf16 v[52:55], v[44:47], v[104:107], v[52:55]
    v_mfma_f32_16x16x32_bf16 v[68:71], v[44:47], v[108:111], v[68:71]
    s_add_u32 m0, s50, 32768
    s_nop 0
    buffer_load_dwordx4 v4, s[12:15], s49 offen lds
    s_add_u32 m0, s50, 33792
    s_nop 0
    buffer_load_dwordx4 v5, s[16:19], s49 offen lds
    s_add_u32 s49, s49, 196608
    s_cmp_lg_u32 s47, 0
    s_cbranch_scc1 L_pok21
    s_waitcnt vmcnt(2)
    v_cmp_le_u32 vcc, 2, v9
    s_nop 0
    s_cmp_eq_u64 vcc, -1
    s_cbranch_scc0 L_pslow21
L_pok21:
    s_waitcnt vmcnt(5) lgkmcnt(0)
    s_barrier
    ds_read_b64_tr_b16 v[40:41], v1 offset:0
    ds_read_b64_tr_b16 v[42:43], v1 offset:512
    v_mul_f32 v30, 0xbf317218, v16
    v_mul_f32 v80, v30, v80
    v_mul_f32 v81, v30, v81
    v_mfma_f32_16x16x32_bf16 v[56:59], v[32:35], v[104:107], v[56:59]
    ds_read_b64_tr_b16 v[44:45], v2 offset:0
    v_mul_f32 v82, v30, v82
    v_mul_f32 v83, v30, v83
    v_mfma_f32_16x16x32_bf16 v[72:75], v[32:35], v[108:111], v[72:75]
    ds_read_b64_tr_b16 v[46:47], v2 offset:512
    v_mul_f32 v84, v30, v84
    v_mul_f32 v85, v30, v85
    v_mfma_f32_16x16x32_bf16 v[60:63], v[36:39], v[104:107], v[60:63]
    ds_read_b64_tr_b16 v[32:33], v1 offset:1024
    v_mul_f32 v86, v30, v86
    v_mul_f32 v87, v30, v87
    v_mfma_f32_16x16x32_bf16 v[76:79], v[36:39], v[108:111], v[76:79]
    ds_read_b64_tr_b16 v[34:35], v1 offset:1536
    v_cvt_pk_bf16_f32 v80, v80, v81
    v_cvt_pk_bf16_f32 v81, v82, v83
    s_waitcnt lgkmcnt(4)
    v_mfma_f32_16x16x32_bf16 v[48:51], v[40:43], v[112:115], v[48:51]
    ds_read_b64_tr_b16 v[36:37], v2 offset:1024
    v_cvt_pk_bf16_f32 v82, v84, v85
    v_cvt_pk_bf16_f32 v83, v86, v87
    s_add_u32 s59, s3, 0
    v_mfma_f32_16x16x32_bf16 v[64:67], v[40:43], v[116:119], v[64:67]
    ds_read_b64_tr_b16 v[38:39], v2 offset:1536
    v_permlane16_swap_b32 v80, v82
    v_permlane16_swap_b32 v81, v83
    s_waitcnt lgkmcnt(4)
    v_mfma_f32_16x16x32_bf16 v[52:55], v[44:47], v[112:115], v[52:55]
    ds_read_b64_tr_b16 v[40:41], v1 offset:8192
    buffer_store_dwordx4 v[80:83], v19, s[20:23], s59 offen sc1
    v_mfma_f32_16x16x32_bf16 v[68:71], v[44:47], v[116:119], v[68:71]
    ds_read_b64_tr_b16 v[42:43], v1 offset:8704
    v_mul_f32 v30, 0xbf317218, v17
    v_mul_f32 v88, v30, v88
    v_mul_f32 v89, v30, v89
    s_waitcnt lgkmcnt(4)
    v_mfma_f32_16x16x32_bf16 v[56:59], v[32:35], v[112:115], v[56:59]
    ds_read_b64_tr_b16 v[44:45], v2 offset:8192
    v_mul_f32 v90, v30, v90
    v_mul_f32 v91, v30, v91
    v_mfma_f32_16x16x32_bf16 v[72:75], v[32:35], v[116:119], v[72:75]
    ds_read_b64_tr_b16 v[46:47], v2 offset:8704
    v_mul_f32 v92, v30, v92
    v_mul_f32 v93, v30, v93
    s_waitcnt lgkmcnt(4)
    v_mfma_f32_16x16x32_bf16 v[60:63], v[36:39], v[112:115], v[60:63]
    ds_read_b64_tr_b16 v[32:33], v1 offset:9216
    v_mul_f32 v94, v30, v94
    v_mul_f32 v95, v30, v95
    v_mfma_f32_16x16x32_bf16 v[76:79], v[36:39], v[116:119], v[76:79]
    ds_read_b64_tr_b16 v[34:35], v1 offset:9728
    v_cvt_pk_bf16_f32 v88, v88, v89
    v_cvt_pk_bf16_f32 v89, v90, v91
    s_waitcnt lgkmcnt(4)
    v_mfma_f32_16x16x32_bf16 v[48:51], v[40:43], v[120:123], v[48:51]
    ds_read_b64_tr_b16 v[36:37], v2 offset:9216
    v_cvt_pk_bf16_f32 v90, v92, v93
    v_cvt_pk_bf16_f32 v91, v94, v95
    s_add_u32 s59, s3, 256
    v_mfma_f32_16x16x32_bf16 v[64:67], v[40:43], v[124:127], v[64:67]
    ds_read_b64_tr_b16 v[38:39], v2 offset:9728
    v_permlane16_swap_b32 v88, v90
    v_permlane16_swap_b32 v89, v91
    s_waitcnt lgkmcnt(4)
    v_mfma_f32_16x16x32_bf16 v[52:55], v[44:47], v[120:123], v[52:55]
    buffer_store_dwordx4 v[88:91], v19, s[20:23], s59 offen sc1
    v_mfma_f32_16x16x32_bf16 v[68:71], v[44:47], v[124:127], v[68:71]
    s_add_u32 m0, s50, 49152
    s_nop 0
    buffer_load_dwordx4 v4, s[12:15], s49 offen lds
    s_add_u32 m0, s50, 50176
    s_nop 0
    buffer_load_dwordx4 v5, s[16:19], s49 offen lds
    s_add_u32 s49, s49, 196608
    s_waitcnt vmcnt(6) lgkmcnt(0)
    s_barrier
    ds_read_b64_tr_b16 v[40:41], v1 offset:16384
    ds_read_b64_tr_b16 v[42:43], v1 offset:16896
    s_mul_i32 s59, s46, 48
    v_add_u32 v30, s59, v0
    v_mfma_f32_16x16x32_bf16 v[56:59], v[32:35], v[120:123], v[56:59]
    ds_read_b64_tr_b16 v[44:45], v2 offset:16384
    s_sub_i32 s59, 2, s69
    s_lshl_b32 s59, s59, 7
    v_cmp_le_i32 vcc, s59, v30
    v_mfma_f32_16x16x32_bf16 v[72:75], v[32:35], v[124:127], v[72:75]
    ds_read_b64_tr_b16 v[46:47], v2 offset:16896
    v_mov_b32 v21, 0x3f80
    v_mfma_f32_16x16x32_bf16 v[60:63], v[36:39], v[120:123], v[60:63]
    ds_read_b64_tr_b16 v[32:33], v1 offset:17408
    v_lshlrev_b32 v31, 4, v30
    v_cndmask_b32 v20, 0, v21, vcc
    v_mfma_f32_16x16x32_bf16 v[76:79], v[36:39], v[124:127], v[76:79]
    ds_read_b64_tr_b16 v[34:35], v1 offset:17920
    v_lshrrev_b32 v22, 7, v30
    s_waitcnt lgkmcnt(4)
    v_mfma_f32_16x16x32_bf16 v[48:51], v[40:43], v[128:131], v[48:51]
    ds_read_b64_tr_b16 v[36:37], v2 offset:17408
    v_mul_u32_u24 v22, 489472, v22
    v_add_u32 v22, v22, v31
    v_mfma_f32_16x16x32_bf16 v[64:67], v[40:43], v[132:135], v[64:67]
    ds_read_b64_tr_b16 v[38:39], v2 offset:17920
    v_mov_b32 v23, 2130706432
    s_waitcnt lgkmcnt(4)
    v_mfma_f32_16x16x32_bf16 v[52:55], v[44:47], v[128:131], v[52:55]
    ds_read_b64_tr_b16 v[40:41], v1 offset:24576
    v_cndmask_b32 v28, v23, v22, vcc
    s_mov_b32 vcc_lo, 0x11111111
    v_mfma_f32_16x16x32_bf16 v[68:71], v[44:47], v[132:135], v[68:71]
    ds_read_b64_tr_b16 v[42:43], v1 offset:25088
    s_mov_b32 vcc_hi, 0x11111111
    v_cndmask_b32 v20, 0, v20, vcc
    s_waitcnt lgkmcnt(4)
    v_mfma_f32_16x16x32_bf16 v[56:59], v[32:35], v[128:131], v[56:59]
    ds_read_b64_tr_b16 v[44:45], v2 offset:24576
    v_mov_b32 v21, 0
    v_mov_b32 v22, v20
    v_mfma_f32_16x16x32_bf16 v[72:75], v[32:35], v[132:135], v[72:75]
    ds_read_b64_tr_b16 v[46:47], v2 offset:25088
    v_mov_b32 v23, 0
    s_waitcnt lgkmcnt(4)
    v_mfma_f32_16x16x32_bf16 v[60:63], v[36:39], v[128:131], v[60:63]
    ds_read_b64_tr_b16 v[32:33], v1 offset:25600
    v_add_u32 v31, 127680, v31
    ds_write_b128 v31, v[20:23]
    v_mfma_f32_16x16x32_bf16 v[76:79], v[36:39], v[132:135], v[76:79]
    ds_read_b64_tr_b16 v[34:35], v1 offset:26112
    s_add_u32 s58, s78, 0
    buffer_load_dwordx4 v[112:115], v6, s[20:23], s58 offen offset:0 sc1
    s_waitcnt lgkmcnt(5)
    v_mfma_f32_16x16x32_bf16 v[48:51], v[40:43], v[136:139], v[48:51]
    ds_read_b64_tr_b16 v[36:37], v2 offset:25600
    v_mfma_f32_16x16x32_bf16 v[64:67], v[40:43], v[140:143], v[64:67]
    ds_read_b64_tr_b16 v[38:39], v2 offset:26112
    s_add_u32 s58, s78, 0
    buffer_load_dwordx4 v[116:119], v6, s[20:23], s58 offen offset:1024 sc1
    s_waitcnt lgkmcnt(5)
    v_mfma_f32_16x16x32_bf16 v[52:55], v[44:47], v[136:139], v[52:55]
    v_mfma_f32_16x16x32_bf16 v[68:71], v[44:47], v[140:143], v[68:71]
    s_add_u32 m0, s50, 0
    s_nop 0
    buffer_load_dwordx4 v4, s[12:15], s49 offen lds
    s_add_u32 m0, s50, 1024
    s_nop 0
    buffer_load_dwordx4 v5, s[16:19], s49 offen lds
    s_add_u32 s49, s49, 196608
    s_waitcnt vmcnt(6) lgkmcnt(0)
    s_barrier
    ds_read_b64_tr_b16 v[40:41], v1 offset:32768
    ds_read_b64_tr_b16 v[42:43], v1 offset:33280
    v_mov_b32 v30, 0xffff
    s_lshl_b32 s60, -1, 0
    s_lshl_b32 s61, -1, 4
    v_mfma_f32_16x16x32_bf16 v[56:59], v[32:35], v[136:139], v[56:59]
    ds_read_b64_tr_b16 v[44:45], v2 offset:32768
    v_cndmask_b32 v88, 0, v30, s[60:61]
    s_lshl_b32 s60, -1, 1
    v_mfma_f32_16x16x32_bf16 v[72:75], v[32:35], v[140:143], v[72:75]
    ds_read_b64_tr_b16 v[46:47], v2 offset:33280
    s_lshl_b32 s61, -1, 5
    v_cndmask_b32 v88, v88, -1, s[60:61]
    v_mfma_f32_16x16x32_bf16 v[60:63], v[36:39], v[136:139], v[60:63]
    ds_read_b64_tr_b16 v[32:33], v1 offset:33792
    s_lshl_b32 s60, -1, 2
    s_lshl_b32 s61, -1, 6
    v_cndmask_b32 v89, 0, v30, s[60:61]
    v_mfma_f32_16x16x32_bf16 v[76:79], v[36:39], v[140:143], v[76:79]
    ds_read_b64_tr_b16 v[34:35], v1 offset:34304
    s_lshl_b32 s60, -1, 3
    s_lshl_b32 s61, -1, 7
    s_waitcnt lgkmcnt(4)
    v_mfma_f32_16x16x32_bf16 v[48:51], v[40:43], v[144:147], v[48:51]
    ds_read_b64_tr_b16 v[36:37], v2 offset:33792
    v_cndmask_b32 v89, v89, -1, s[60:61]
    s_lshl_b32 s60, -1, 8
    v_mfma_f32_16x16x32_bf16 v[64:67], v[40:43], v[148:151], v[64:67]
    ds_read_b64_tr_b16 v[38:39], v2 offset:34304
    s_lshl_b32 s61, -1, 12
    v_cndmask_b32 v90, 0, v30, s[60:61]
    s_waitcnt lgkmcnt(4)
    v_mfma_f32_16x16x32_bf16 v[52:55], v[44:47], v[144:147], v[52:55]
    ds_read_b64_tr_b16 v[40:41], v1 offset:40960
    s_lshl_b32 s60, -1, 9
    s_lshl_b32 s61, -1, 13
    v_cndmask_b32 v90, v90, -1, s[60:61]
    v_mfma_f32_16x16x32_bf16 v[68:71], v[44:47], v[148:151], v[68:71]
    ds_read_b64_tr_b16 v[42:43], v1 offset:41472
    s_lshl_b32 s60, -1, 10
    s_lshl_b32 s61, -1, 14
    s_waitcnt lgkmcnt(4)
    v_mfma_f32_16x16x32_bf16 v[56:59], v[32:35], v[144:147], v[56:59]
    ds_read_b64_tr_b16 v[44:45], v2 offset:40960
    v_cndmask_b32 v91, 0, v30, s[60:61]
    s_lshl_b32 s60, -1, 11
    v_mfma_f32_16x16x32_bf16 v[72:75], v[32:35], v[148:151], v[72:75]
    ds_read_b64_tr_b16 v[46:47], v2 offset:41472
    s_lshl_b32 s61, -1, 15
    v_cndmask_b32 v91, v91, -1, s[60:61]
    s_waitcnt lgkmcnt(4)
    v_mfma_f32_16x16x32_bf16 v[60:63], v[36:39], v[144:147], v[60:63]
    ds_read_b64_tr_b16 v[32:33], v1 offset:41984
    s_add_u32 s58, s78, 0
    buffer_load_dwordx4 v[120:123], v6, s[20:23], s58 offen offset:2048 sc1
    v_mfma_f32_16x16x32_bf16 v[76:79], v[36:39], v[148:151], v[76:79]
    ds_read_b64_tr_b16 v[34:35], v1 offset:42496
    s_add_u32 s58, s78, 0
    s_waitcnt lgkmcnt(4)
    v_mfma_f32_16x16x32_bf16 v[48:51], v[40:43], v[152:155], v[48:51]
    ds_read_b64_tr_b16 v[36:37], v2 offset:41984
    buffer_load_dwordx4 v[124:127], v6, s[20:23], s58 offen offset:3072 sc1
    v_mfma_f32_16x16x32_bf16 v[64:67], v[40:43], v[156:159], v[64:67]
    ds_read_b64_tr_b16 v[38:39], v2 offset:42496
    s_add_u32 s58, s78, 0
    buffer_load_dwordx4 v[128:131], v7, s[20:23], s58 offen offset:0 sc1
    s_waitcnt lgkmcnt(4)
    v_mfma_f32_16x16x32_bf16 v[52:55], v[44:47], v[152:155], v[52:55]
    v_mfma_f32_16x16x32_bf16 v[68:71], v[44:47], v[156:159], v[68:71]
    s_add_u32 m0, s50, 16384
    s_nop 0
    buffer_load_dwordx4 v4, s[12:15], s49 offen lds
    s_add_u32 m0, s50, 17408
    s_nop 0
    buffer_load_dwordx4 v5, s[16:19], s49 offen lds
    s_add_u32 s49, s49, 196608
    s_waitcnt vmcnt(9) lgkmcnt(0)
    s_barrier
    ds_read_b64_tr_b16 v[40:41], v1 offset:49152
    ds_read_b64_tr_b16 v[42:43], v1 offset:49664
    v_mov_b32 v30, 0xffff
    s_lshl_b32 s60, -1, 16
    v_mfma_f32_16x16x32_bf16 v[56:59], v[32:35], v[152:155], v[56:59]
    ds_read_b64_tr_b16 v[44:45], v2 offset:49152
    s_lshl_b32 s61, -1, 20
    v_cndmask_b32 v92, 0, v30, s[60:61]
    v_mfma_f32_16x16x32_bf16 v[72:75], v[32:35], v[156:159], v[72:75]
    ds_read_b64_tr_b16 v[46:47], v2 offset:49664
    s_lshl_b32 s60, -1, 17
    s_lshl_b32 s61, -1, 21
    v_mfma_f32_16x16x32_bf16 v[60:63], v[36:39], v[152:155], v[60:63]
    v_add_u32 v29, v3, v1
    v_cndmask_b32 v92, v92, -1, s[60:61]
    v_mfma_f32_16x16x32_bf16 v[76:79], v[36:39], v[156:159], v[76:79]
    ds_read_b64_tr_b16 v[32:33], v29 offset:4096
    s_lshl_b32 s60, -1, 18
    s_lshl_b32 s61, -1, 22
    v_cndmask_b32 v93, 0, v30, s[60:61]
    s_waitcnt lgkmcnt(3)
    v_mfma_f32_16x16x32_bf16 v[48:51], v[40:43], v[160:163], v[48:51]
    v_add_u32 v29, v3, v2
    s_lshl_b32 s60, -1, 19
    v_mfma_f32_16x16x32_bf16 v[64:67], v[40:43], v[164:167], v[64:67]
    ds_read_b64_tr_b16 v[36:37], v29 offset:4096
    s_lshl_b32 s61, -1, 23
    v_cndmask_b32 v93, v93, -1, s[60:61]
    s_waitcnt lgkmcnt(2)
    v_mfma_f32_16x16x32_bf16 v[52:55], v[44:47], v[160:163], v[52:55]
    ds_read_b64_tr_b16 v[40:41], v1 offset:50176
    s_lshl_b32 s60, -1, 24
    s_lshl_b32 s61, -1, 28
    v_mfma_f32_16x16x32_bf16 v[68:71], v[44:47], v[164:167], v[68:71]
    ds_read_b64_tr_b16 v[42:43], v1 offset:50688
    v_cndmask_b32 v94, 0, v30, s[60:61]
    s_lshl_b32 s60, -1, 25
    s_waitcnt lgkmcnt(3)
    v_mfma_f32_16x16x16_bf16 v[48:51], v[32:33], v[12:13], v[48:51]
    ds_read_b64_tr_b16 v[44:45], v2 offset:50176
    s_lshl_b32 s61, -1, 29
    v_cndmask_b32 v94, v94, -1, s[60:61]
    v_mfma_f32_16x16x16_bf16 v[64:67], v[32:33], v[14:15], v[64:67]
    ds_read_b64_tr_b16 v[46:47], v2 offset:50688
    s_lshl_b32 s60, -1, 26
    s_waitcnt lgkmcnt(4)
    v_mfma_f32_16x16x16_bf16 v[52:55], v[36:37], v[12:13], v[52:55]
    ds_read_b64_tr_b16 v[32:33], v1 offset:57344
    s_lshl_b32 s61, -1, 30
    v_cndmask_b32 v95, 0, v30, s[60:61]
    v_mfma_f32_16x16x16_bf16 v[68:71], v[36:37], v[14:15], v[68:71]
    ds_read_b64_tr_b16 v[34:35], v1 offset:57856
    s_lshl_b32 s60, -1, 27
    s_lshl_b32 s61, -1, 31
    s_waitcnt lgkmcnt(4)
    v_mfma_f32_16x16x32_bf16 v[56:59], v[40:43], v[160:163], v[56:59]
    ds_read_b64_tr_b16 v[36:37], v2 offset:57344
    v_cndmask_b32 v95, v95, -1, s[60:61]
    s_add_u32 s58, s78, 5120
    v_mfma_f32_16x16x32_bf16 v[72:75], v[40:43], v[164:167], v[72:75]
    ds_read_b64_tr_b16 v[38:39], v2 offset:57856
    buffer_load_dwordx4 v[132:135], v6, s[20:23], s58 offen offset:0 sc1
    s_waitcnt lgkmcnt(4)
    v_mfma_f32_16x16x32_bf16 v[60:63], v[44:47], v[160:163], v[60:63]
    ds_read_b64_tr_b16 v[40:41], v1 offset:58368
    s_add_u32 s58, s78, 5120
    v_mfma_f32_16x16x32_bf16 v[76:79], v[44:47], v[164:167], v[76:79]
    ds_read_b64_tr_b16 v[42:43], v1 offset:58880
    buffer_load_dwordx4 v[136:139], v6, s[20:23], s58 offen offset:1024 sc1
    s_waitcnt lgkmcnt(4)
    v_mfma_f32_16x16x32_bf16 v[48:51], v[32:35], v[168:171], v[48:51]
    ds_read_b64_tr_b16 v[44:45], v2 offset:58368
    s_add_u32 s58, s78, 5120
    v_mfma_f32_16x16x32_bf16 v[64:67], v[32:35], v[172:175], v[64:67]
    ds_read_b64_tr_b16 v[46:47], v2 offset:58880
    buffer_load_dwordx4 v[140:143], v6, s[20:23], s58 offen offset:2048 sc1
    s_waitcnt lgkmcnt(4)
    v_mfma_f32_16x16x32_bf16 v[52:55], v[36:39], v[168:171], v[52:55]
    v_mfma_f32_16x16x32_bf16 v[68:71], v[36:39], v[172:175], v[68:71]
    s_add_u32 m0, s50, 32768
    s_nop 0
    buffer_load_dwordx4 v4, s[12:15], s49 offen lds
    s_add_u32 m0, s50, 33792
    s_nop 0
    buffer_load_dwordx4 v5, s[16:19], s49 offen lds
    s_add_u32 s49, s49, 196608
    s_waitcnt vmcnt(10) lgkmcnt(0)
    s_barrier
    ds_read_b64_tr_b16 v[32:33], v1 offset:0
    ds_read_b64_tr_b16 v[34:35], v1 offset:512
    s_add_u32 s58, s78, 5120
    buffer_load_dwordx4 v[144:147], v6, s[20:23], s58 offen offset:3072 sc1
    v_mfma_f32_16x16x32_bf16 v[56:59], v[40:43], v[168:171], v[56:59]
    ds_read_b64_tr_b16 v[36:37], v2 offset:0
    v_mfma_f32_16x16x32_bf16 v[72:75], v[40:43], v[172:175], v[72:75]
    ds_read_b64_tr_b16 v[38:39], v2 offset:512
    s_add_u32 s58, s78, 5120
    buffer_load_dwordx4 v[148:151], v7, s[20:23], s58 offen offset:0 sc1
    v_mfma_f32_16x16x32_bf16 v[60:63], v[44:47], v[168:171], v[60:63]
    v_add_u32 v29, v3, v1
    v_mfma_f32_16x16x32_bf16 v[76:79], v[44:47], v[172:175], v[76:79]
    ds_read_b64_tr_b16 v[40:41], v29 offset:6144
    s_add_u32 s58, s78, 10240
    buffer_load_dwordx4 v[152:155], v6, s[20:23], s58 offen offset:0 sc1
    s_waitcnt lgkmcnt(3)
    v_mfma_f32_16x16x32_bf16 v[48:51], v[32:35], v[176:179], v[48:51]
    v_add_u32 v29, v3, v2
    v_mfma_f32_16x16x32_bf16 v[64:67], v[32:35], v[180:183], v[64:67]
    ds_read_b64_tr_b16 v[44:45], v29 offset:6144
    v_lshrrev_b32 v30, 4, v0
    s_waitcnt lgkmcnt(2)
    v_mfma_f32_16x16x32_bf16 v[52:55], v[36:39], v[176:179], v[52:55]
    ds_read_b64_tr_b16 v[32:33], v1 offset:1024
    v_sub_u32 v30, s69, v30
    v_mfma_f32_16x16x32_bf16 v[68:71], v[36:39], v[180:183], v[68:71]
    ds_read_b64_tr_b16 v[34:35], v1 offset:1536
    v_max_i32 v30, 0, v30
    s_waitcnt lgkmcnt(3)
    v_mfma_f32_16x16x16_bf16 v[56:59], v[40:41], v[12:13], v[56:59]
    ds_read_b64_tr_b16 v[36:37], v2 offset:1024
    v_mov_b32 v31, s79
    v_mfma_f32_16x16x16_bf16 v[72:75], v[40:41], v[14:15], v[72:75]
    ds_read_b64_tr_b16 v[38:39], v2 offset:1536
    s_mov_b32 vcc_lo, 0
    s_mov_b32 vcc_hi, 0xffff0000
    s_waitcnt lgkmcnt(4)
    v_mfma_f32_16x16x16_bf16 v[60:63], v[44:45], v[12:13], v[60:63]
    ds_read_b64_tr_b16 v[40:41], v1 offset:8192
    v_cndmask_b32 v31, v30, v31, vcc
    v_mfma_f32_16x16x16_bf16 v[76:79], v[44:45], v[14:15], v[76:79]
    ds_read_b64_tr_b16 v[42:43], v1 offset:8704
    v_bfe_u32 v30, v31, 3, 1
    v_and_b32 v31, 7, v31
    s_waitcnt lgkmcnt(4)
    v_mfma_f32_16x16x32_bf16 v[56:59], v[32:35], v[176:179], v[56:59]
    ds_read_b64_tr_b16 v[44:45], v2 offset:8192
    v_lshlrev_b32 v31, 10, v31
    v_mfma_f32_16x16x32_bf16 v[72:75], v[32:35], v[180:183], v[72:75]
    ds_read_b64_tr_b16 v[46:47], v2 offset:8704
    v_lshl_add_u32 v31, v30, 7, v31
    s_waitcnt lgkmcnt(4)
    v_mfma_f32_16x16x32_bf16 v[60:63], v[36:39], v[176:179], v[60:63]
    ds_read_b64_tr_b16 v[32:33], v1 offset:9216
    v_bfe_u32 v30, v0, 2, 2
    v_mfma_f32_16x16x32_bf16 v[76:79], v[36:39], v[180:183], v[76:79]
    ds_read_b64_tr_b16 v[34:35], v1 offset:9728
    v_and_b32 v8, 3, v0
    s_waitcnt lgkmcnt(4)
    v_mfma_f32_16x16x32_bf16 v[48:51], v[40:43], v[184:187], v[48:51]
    ds_read_b64_tr_b16 v[36:37], v2 offset:9216
    v_lshlrev_b32 v8, 13, v8
    v_mfma_f32_16x16x32_bf16 v[64:67], v[40:43], v[188:191], v[64:67]
    ds_read_b64_tr_b16 v[38:39], v2 offset:9728
    v_lshl_add_u32 v8, v30, 8, v8
    s_waitcnt lgkmcnt(4)
    v_mfma_f32_16x16x32_bf16 v[52:55], v[44:47], v[184:187], v[52:55]
    v_add_u32 v8, v8, v31
    v_mfma_f32_16x16x32_bf16 v[68:71], v[44:47], v[188:191], v[68:71]
    s_add_u32 m0, s50, 49152
    s_nop 0
    buffer_load_dwordx4 v4, s[12:15], s49 offen lds
    s_add_u32 m0, s50, 50176
    s_nop 0
    buffer_load_dwordx4 v5, s[16:19], s49 offen lds
    s_add_u32 s49, s49, 196608
    s_waitcnt vmcnt(10) lgkmcnt(0)
    s_barrier
    ds_read_b64_tr_b16 v[40:41], v1 offset:16384
    ds_read_b64_tr_b16 v[42:43], v1 offset:16896
    v_and_b32 v20, 31, v0
    v_lshrrev_b32 v21, 5, v0
    v_mfma_f32_16x16x32_bf16 v[56:59], v[32:35], v[184:187], v[56:59]
    ds_read_b64_tr_b16 v[44:45], v2 offset:16384
    s_lshl_b32 s58, s47, 9
    s_add_u32 s60, s58, 65536
    v_mfma_f32_16x16x32_bf16 v[72:75], v[32:35], v[188:191], v[72:75]
    ds_read_b64_tr_b16 v[46:47], v2 offset:16896
    v_mul_u32_u24 v86, 6208, v21
    v_mfma_f32_16x16x32_bf16 v[60:63], v[36:39], v[184:187], v[60:63]
    ds_read_b64_tr_b16 v[32:33], v1 offset:17408
    v_lshl_add_u32 v86, v20, 4, v86
    v_add_u32 v86, s60, v86
    v_mfma_f32_16x16x32_bf16 v[76:79], v[36:39], v[188:191], v[76:79]
    ds_read_b64_tr_b16 v[34:35], v1 offset:17920
    s_add_u32 s61, s58, 77952
    s_waitcnt lgkmcnt(4)
    v_mfma_f32_16x16x32_bf16 v[48:51], v[40:43], v[192:195], v[48:51]
    ds_read_b64_tr_b16 v[36:37], v2 offset:17408
    v_lshl_add_u32 v87, v20, 4, s61
    s_lshl2_add_u32 s58, s69, s47
    v_mfma_f32_16x16x32_bf16 v[64:67], v[40:43], v[196:199], v[64:67]
    ds_read_b64_tr_b16 v[38:39], v2 offset:17920
    s_lshr_b32 s59, s70, 2
    s_lshl3_add_u32 s58, s58, s59
    s_waitcnt lgkmcnt(4)
    v_mfma_f32_16x16x32_bf16 v[52:55], v[44:47], v[192:195], v[52:55]
    ds_read_b64_tr_b16 v[40:41], v1 offset:24576
    s_mul_i32 s58, s58, 5120
    s_add_u32 s58, s58, 16777216
    s_and_b32 s59, s70, 3
    v_mfma_f32_16x16x32_bf16 v[68:71], v[44:47], v[196:199], v[68:71]
    ds_read_b64_tr_b16 v[42:43], v1 offset:25088
    s_lshl_b32 s60, s59, 10
    s_add_u32 s57, s58, s60
    s_lshl_b32 s60, s59, 7
    s_waitcnt lgkmcnt(4)
    v_mfma_f32_16x16x32_bf16 v[56:59], v[32:35], v[192:195], v[56:59]
    ds_read_b64_tr_b16 v[44:45], v2 offset:24576
    s_add_u32 s3, s58, s60
    s_add_u32 s3, s3, 4096
    v_mfma_f32_16x16x32_bf16 v[72:75], v[32:35], v[196:199], v[72:75]
    ds_read_b64_tr_b16 v[46:47], v2 offset:25088
    s_add_u32 s58, s78, 10240
    buffer_load_dwordx4 v[156:159], v6, s[20:23], s58 offen offset:1024 sc1
    s_waitcnt lgkmcnt(4)
    v_mfma_f32_16x16x32_bf16 v[60:63], v[36:39], v[192:195], v[60:63]
    ds_read_b64_tr_b16 v[32:33], v1 offset:25600
    v_mfma_f32_16x16x32_bf16 v[76:79], v[36:39], v[196:199], v[76:79]
    ds_read_b64_tr_b16 v[34:35], v1 offset:26112
    s_add_u32 s58, s78, 10240
    buffer_load_dwordx4 v[160:163], v6, s[20:23], s58 offen offset:2048 sc1
    s_waitcnt lgkmcnt(4)
    v_mfma_f32_16x16x32_bf16 v[48:51], v[40:43], v[200:203], v[48:51]
    ds_read_b64_tr_b16 v[36:37], v2 offset:25600
    v_mfma_f32_16x16x32_bf16 v[64:67], v[40:43], v[204:207], v[64:67]
    ds_read_b64_tr_b16 v[38:39], v2 offset:26112
    s_add_u32 s58, s78, 10240
    buffer_load_dwordx4 v[164:167], v6, s[20:23], s58 offen offset:3072 sc1
    s_waitcnt lgkmcnt(4)
    v_mfma_f32_16x16x32_bf16 v[52:55], v[44:47], v[200:203], v[52:55]
    v_mfma_f32_16x16x32_bf16 v[68:71], v[44:47], v[204:207], v[68:71]
    s_add_u32 m0, s50, 0
    s_nop 0
    buffer_load_dwordx4 v4, s[12:15], s49 offen lds
    s_add_u32 m0, s50, 1024
    s_nop 0
    buffer_load_dwordx4 v5, s[16:19], s49 offen lds
    s_add_u32 s49, s49, 196608
    s_cmp_lg_u32 s47, 0
    s_cbranch_scc1 L_np22
    buffer_load_dword v9, v8, s[20:23], 0 offen sc1
L_np22:
    s_waitcnt vmcnt(10)
    s_barrier
    ds_read_b64_tr_b16 v[40:41], v1 offset:32768
    ds_read_b64_tr_b16 v[42:43], v1 offset:33280
    v_lshrrev_b32 v21, 5, v0
    s_lshl_b32 s58, s47, 9
    v_bfe_u32 v20, v0, 2, 2
    s_waitcnt lgkmcnt(4)
    v_mfma_f32_16x16x32_bf16 v[56:59], v[32:35], v[200:203], v[56:59]
    ds_read_b64_tr_b16 v[44:45], v2 offset:32768
    v_lshl_add_u32 v20, v21, 2, v20
    v_mfma_f32_16x16x32_bf16 v[72:75], v[32:35], v[204:207], v[72:75]
    ds_read_b64_tr_b16 v[46:47], v2 offset:33280
    v_lshlrev_b32 v20, 4, v20
    v_and_b32 v3, 1, v0
    s_waitcnt lgkmcnt(4)
    v_mfma_f32_16x16x32_bf16 v[60:63], v[36:39], v[200:203], v[60:63]
    ds_read_b64_tr_b16 v[32:33], v1 offset:33792
    v_mul_u32_u24 v3, 6208, v3
    v_and_b32 v22, 2, v0
    v_mfma_f32_16x16x32_bf16 v[76:79], v[36:39], v[204:207], v[76:79]
    ds_read_b64_tr_b16 v[34:35], v1 offset:34304
    v_lshl_add_u32 v3, v22, 2, v3
    s_waitcnt lgkmcnt(4)
    v_mfma_f32_16x16x32_bf16 v[48:51], v[40:43], v[208:211], v[48:51]
    ds_read_b64_tr_b16 v[36:37], v2 offset:33792
    s_add_u32 s59, s58, 96576
    v_add3_u32 v3, v3, v20, s59
    s_add_u32 s60, s58, 108992
    v_mfma_f32_16x16x32_bf16 v[64:67], v[40:43], v[212:215], v[64:67]
    ds_read_b64_tr_b16 v[38:39], v2 offset:34304
    v_add_u32 v20, s60, v20
    s_mov_b32 vcc_lo, 0x33330000
    s_waitcnt lgkmcnt(4)
    v_mfma_f32_16x16x32_bf16 v[52:55], v[44:47], v[208:211], v[52:55]
    ds_read_b64_tr_b16 v[40:41], v1 offset:40960
    s_mov_b32 vcc_hi, 0x33330000
    v_cndmask_b32 v3, v3, v20, vcc
    v_mfma_f32_16x16x32_bf16 v[68:71], v[44:47], v[212:215], v[68:71]
    ds_read_b64_tr_b16 v[42:43], v1 offset:41472
    s_add_u32 s59, s58, 127688
    v_lshl_add_u32 v20, v21, 6, s59
    s_lshl_b64 vcc, vcc, 2
    s_waitcnt lgkmcnt(4)
    v_mfma_f32_16x16x32_bf16 v[56:59], v[32:35], v[208:211], v[56:59]
    ds_read_b64_tr_b16 v[44:45], v2 offset:40960
    v_cndmask_b32 v3, v3, v20, vcc
    v_add_u32 v20, 16, v20
    v_mfma_f32_16x16x32_bf16 v[72:75], v[32:35], v[212:215], v[72:75]
    ds_read_b64_tr_b16 v[46:47], v2 offset:41472
    s_mov_b32 vcc_lo, 0x22220000
    s_mov_b32 vcc_hi, 0x22220000
    v_cndmask_b32 v3, v3, v20, vcc
    s_waitcnt lgkmcnt(4)
    v_mfma_f32_16x16x32_bf16 v[60:63], v[36:39], v[208:211], v[60:63]
    ds_read_b64_tr_b16 v[32:33], v1 offset:41984
    s_add_u32 s58, s78, 10240
    buffer_load_dwordx4 v[168:171], v7, s[20:23], s58 offen offset:0 sc1
    v_mfma_f32_16x16x32_bf16 v[76:79], v[36:39], v[212:215], v[76:79]
    ds_read_b64_tr_b16 v[34:35], v1 offset:42496
    s_waitcnt lgkmcnt(4)
    v_mfma_f32_16x16x32_bf16 v[48:51], v[40:43], v[216:219], v[48:51]
    ds_read_b64_tr_b16 v[36:37], v2 offset:41984
    s_add_u32 s58, s78, 15360
    buffer_load_dwordx4 v[172:175], v6, s[20:23], s58 offen offset:0 sc1
    v_mfma_f32_16x16x32_bf16 v[64:67], v[40:43], v[220:223], v[64:67]
    ds_read_b64_tr_b16 v[38:39], v2 offset:42496
    s_add_u32 s58, s78, 15360
    buffer_load_dwordx4 v[176:179], v6, s[20:23], s58 offen offset:1024 sc1
    s_waitcnt lgkmcnt(4)
    v_mfma_f32_16x16x32_bf16 v[52:55], v[44:47], v[216:219], v[52:55]
    v_mfma_f32_16x16x32_bf16 v[68:71], v[44:47], v[220:223], v[68:71]
    s_cmp_lg_u32 s47, 0
    s_cbranch_scc1 L_pok23
    s_waitcnt vmcnt(3)
    v_cmp_le_u32 vcc, 3, v9
    s_nop 0
    s_cmp_eq_u64 vcc, -1
    s_cbranch_scc0 L_pslow23
L_pok23:
    s_waitcnt vmcnt(8)
    s_barrier
    ds_read_b64_tr_b16 v[40:41], v1 offset:49152
    ds_read_b64_tr_b16 v[42:43], v1 offset:49664
    v_lshrrev_b32 v21, 5, v0
    s_waitcnt lgkmcnt(4)
    v_mfma_f32_16x16x32_bf16 v[56:59], v[32:35], v[216:219], v[56:59]
    ds_read_b64_tr_b16 v[44:45], v2 offset:49152
    v_mfma_f32_16x16x32_bf16 v[72:75], v[32:35], v[220:223], v[72:75]
    ds_read_b64_tr_b16 v[46:47], v2 offset:49664
    v_bfe_u32 v20, v0, 4, 1
    s_waitcnt lgkmcnt(4)
    v_mfma_f32_16x16x32_bf16 v[60:63], v[36:39], v[216:219], v[60:63]
    ds_read_b64_tr_b16 v[32:33], v1 offset:50176
    v_mfma_f32_16x16x32_bf16 v[76:79], v[36:39], v[220:223], v[76:79]
    ds_read_b64_tr_b16 v[34:35], v1 offset:50688
    v_mul_u32_u24 v20, 20480, v20
    s_waitcnt lgkmcnt(4)
    v_mfma_f32_16x16x32_bf16 v[48:51], v[40:43], v[224:227], v[48:51]
    ds_read_b64_tr_b16 v[36:37], v2 offset:50176
    v_mfma_f32_16x16x32_bf16 v[64:67], v[40:43], v[228:231], v[64:67]
    ds_read_b64_tr_b16 v[38:39], v2 offset:50688
    v_and_b32 v22, 15, v0
    s_waitcnt lgkmcnt(4)
    v_mfma_f32_16x16x32_bf16 v[52:55], v[44:47], v[224:227], v[52:55]
    ds_read_b64_tr_b16 v[40:41], v1 offset:57344
    v_mfma_f32_16x16x32_bf16 v[68:71], v[44:47], v[228:231], v[68:71]
    ds_read_b64_tr_b16 v[42:43], v1 offset:57856
    v_lshl_add_u32 v4, v22, 4, v20
    s_waitcnt lgkmcnt(4)
    v_mfma_f32_16x16x32_bf16 v[56:59], v[32:35], v[224:227], v[56:59]
    ds_read_b64_tr_b16 v[44:45], v2 offset:57344
    v_mfma_f32_16x16x32_bf16 v[72:75], v[32:35], v[228:231], v[72:75]
    ds_read_b64_tr_b16 v[46:47], v2 offset:57856
    v_lshl_add_u32 v4, v21, 8, v4
    s_waitcnt lgkmcnt(4)
    v_mfma_f32_16x16x32_bf16 v[60:63], v[36:39], v[224:227], v[60:63]
    ds_read_b64_tr_b16 v[32:33], v1 offset:58368
    v_mfma_f32_16x16x32_bf16 v[76:79], v[36:39], v[228:231], v[76:79]
    ds_read_b64_tr_b16 v[34:35], v1 offset:58880
    v_lshl_add_u32 v5, v22, 3, v20
    s_waitcnt lgkmcnt(4)
    v_mfma_f32_16x16x32_bf16 v[48:51], v[40:43], v[232:235], v[48:51]
    ds_read_b64_tr_b16 v[36:37], v2 offset:58368
    v_mfma_f32_16x16x32_bf16 v[64:67], v[40:43], v[236:239], v[64:67]
    ds_read_b64_tr_b16 v[38:39], v2 offset:58880
    v_lshl_add_u32 v5, v21, 30, v5
    s_waitcnt lgkmcnt(4)
    v_mfma_f32_16x16x32_bf16 v[52:55], v[44:47], v[232:235], v[52:55]
    v_mfma_f32_16x16x32_bf16 v[68:71], v[44:47], v[236:239], v[68:71]
    s_add_u32 m0, s82, 65536
    s_add_u32 s59, s81, 229376
    s_mov_b32 exec_hi, 0xffff
    buffer_load_dwordx4 v28, s[20:23], s59 offen sc1 lds
    s_mov_b32 exec_hi, -1
    s_add_u32 m0, s82, 71744
    s_add_u32 s59, s81, 231424
    s_mov_b32 exec_hi, 0xffff
    buffer_load_dwordx4 v28, s[20:23], s59 offen sc1 lds
    s_mov_b32 exec_hi, -1
    s_add_u32 m0, s82, 77952
    s_add_u32 s59, s81, 233472
    s_mov_b32 exec_hi, 0xffff
    buffer_load_dwordx4 v28, s[20:23], s59 offen sc1 lds
    s_mov_b32 exec_hi, -1
    s_add_u32 m0, s82, 84160
    s_add_u32 s59, s81, 235520
    s_mov_b32 exec_hi, 0xffff
    buffer_load_dwordx4 v28, s[20:23], s59 offen sc1 lds
    s_mov_b32 exec_hi, -1
    s_add_u32 m0, s82, 90368
    s_add_u32 s59, s81, 237568
    s_mov_b32 exec_hi, 0xffff
    buffer_load_dwordx4 v28, s[20:23], s59 offen sc1 lds
    s_mov_b32 exec_hi, -1
    s_waitcnt vmcnt(8)
    s_barrier
    ds_read_b64_tr_b16 v[40:41], v1 offset:0
    ds_read_b64_tr_b16 v[42:43], v1 offset:512
    s_waitcnt lgkmcnt(4)
    v_mfma_f32_16x16x32_bf16 v[56:59], v[32:35], v[232:235], v[56:59]
    ds_read_b64_tr_b16 v[44:45], v2 offset:0
    v_mfma_f32_16x16x32_bf16 v[72:75], v[32:35], v[236:239], v[72:75]
    ds_read_b64_tr_b16 v[46:47], v2 offset:512
    s_waitcnt lgkmcnt(4)
    v_mfma_f32_16x16x32_bf16 v[60:63], v[36:39], v[232:235], v[60:63]
    ds_read_b64_tr_b16 v[32:33], v1 offset:1024
    v_mfma_f32_16x16x32_bf16 v[76:79], v[36:39], v[236:239], v[76:79]
    ds_read_b64_tr_b16 v[34:35], v1 offset:1536
    s_waitcnt lgkmcnt(4)
    v_mfma_f32_16x16x32_bf16 v[48:51], v[40:43], v[240:243], v[48:51]
    ds_read_b64_tr_b16 v[36:37], v2 offset:1024
    v_mfma_f32_16x16x32_bf16 v[64:67], v[40:43], v[244:247], v[64:67]
    ds_read_b64_tr_b16 v[38:39], v2 offset:1536
    s_waitcnt lgkmcnt(4)
    v_mfma_f32_16x16x32_bf16 v[52:55], v[44:47], v[240:243], v[52:55]
    ds_read_b64_tr_b16 v[40:41], v1 offset:8192
    v_mfma_f32_16x16x32_bf16 v[68:71], v[44:47], v[244:247], v[68:71]
    ds_read_b64_tr_b16 v[42:43], v1 offset:8704
    s_waitcnt lgkmcnt(4)
    v_mfma_f32_16x16x32_bf16 v[56:59], v[32:35], v[240:243], v[56:59]
    ds_read_b64_tr_b16 v[44:45], v2 offset:8192
    v_mfma_f32_16x16x32_bf16 v[72:75], v[32:35], v[244:247], v[72:75]
    ds_read_b64_tr_b16 v[46:47], v2 offset:8704
    s_waitcnt lgkmcnt(4)
    v_mfma_f32_16x16x32_bf16 v[60:63], v[36:39], v[240:243], v[60:63]
    ds_read_b64_tr_b16 v[32:33], v1 offset:9216
    v_mfma_f32_16x16x32_bf16 v[76:79], v[36:39], v[244:247], v[76:79]
    ds_read_b64_tr_b16 v[34:35], v1 offset:9728
    s_waitcnt lgkmcnt(4)
    v_mfma_f32_16x16x32_bf16 v[48:51], v[40:43], v[248:251], v[48:51]
    ds_read_b64_tr_b16 v[36:37], v2 offset:9216
    v_mfma_f32_16x16x32_bf16 v[64:67], v[40:43], v[252:255], v[64:67]
    ds_read_b64_tr_b16 v[38:39], v2 offset:9728
    s_waitcnt lgkmcnt(4)
    v_mfma_f32_16x16x32_bf16 v[52:55], v[44:47], v[248:251], v[52:55]
    v_mfma_f32_16x16x32_bf16 v[68:71], v[44:47], v[252:255], v[68:71]
    s_waitcnt lgkmcnt(2)
    v_mfma_f32_16x16x32_bf16 v[56:59], v[32:35], v[248:251], v[56:59]
    v_mfma_f32_16x16x32_bf16 v[72:75], v[32:35], v[252:255], v[72:75]
    s_waitcnt lgkmcnt(0)
    v_mfma_f32_16x16x32_bf16 v[60:63], v[36:39], v[248:251], v[60:63]
    v_mfma_f32_16x16x32_bf16 v[76:79], v[36:39], v[252:255], v[76:79]
    s_add_u32 m0, s82, 96576
    s_add_u32 s59, s81, 393216
    s_mov_b32 exec_hi, 0xffff
    buffer_load_dwordx4 v28, s[20:23], s59 offen sc1 lds
    s_mov_b32 exec_hi, -1
    s_add_u32 m0, s82, 102784
    s_add_u32 s59, s81, 395264
    s_mov_b32 exec_hi, 0xffff
    buffer_load_dwordx4 v28, s[20:23], s59 offen sc1 lds
    s_mov_b32 exec_hi, -1
    s_add_u32 m0, s82, 108992
    s_add_u32 s59, s81, 397312
    s_mov_b32 exec_hi, 0xffff
    buffer_load_dwordx4 v28, s[20:23], s59 offen sc1 lds
    s_mov_b32 exec_hi, -1
    s_add_u32 m0, s82, 115200
    s_add_u32 s59, s81, 399360
    s_mov_b32 exec_hi, 0xffff
    buffer_load_dwordx4 v28, s[20:23], s59 offen sc1 lds
    s_mov_b32 exec_hi, -1
    s_add_u32 m0, s82, 121408
    s_add_u32 s59, s81, 401408
    s_mov_b32 exec_hi, 0xffff
    buffer_load_dwordx4 v28, s[20:23], s59 offen sc1 lds
    s_mov_b32 exec_hi, -1
    s_lshl_b32 s59, s47, 9
    s_add_u32 s59, s59, s81
    s_add_u32 s60, s59, 1048576
    s_add_u32 s59, s59, 1052672
    v_lshrrev_b32 v30, 5, v0
    v_and_b32 v19, 0x1f0, v6
    v_lshl_add_u32 v19, v30, 11, v19
    v_lshl_add_u32 v30, v30, 30, v19
    buffer_load_dwordx4 v[80:83], v19, s[20:23], s60 offen sc1
    buffer_load_dwordx2 v[84:85], v30, s[20:23], s59 offen sc1
    v_mul_f32 v56, v48, v56
    v_mul_f32 v57, v49, v57
    v_mul_f32 v58, v50, v58
    v_mul_f32 v59, v51, v59
    v_mul_f32 v48, v16, v48
    v_mul_f32 v49, v16, v49
    v_mul_f32 v50, v16, v50
    v_mul_f32 v51, v16, v51
    v_exp_f32 v48, v48
    v_exp_f32 v49, v49
    v_exp_f32 v50, v50
    v_exp_f32 v51, v51
    s_add_u32 s58, s78, 15360
    buffer_load_dwordx4 v[180:183], v6, s[20:23], s58 offen offset:2048 sc1
    v_fma_f32 v48, v48, v10, v10
    v_fma_f32 v49, v49, v10, v10
    v_fma_f32 v50, v50, v10, v10
    v_fma_f32 v51, v51, v10, v10
    v_rcp_f32 v48, v48
    v_rcp_f32 v49, v49
    v_rcp_f32 v50, v50
    v_rcp_f32 v51, v51
    v_mul_f32 v48, v48, v56
    v_mul_f32 v49, v49, v57
    v_mul_f32 v50, v50, v58
    v_mul_f32 v51, v51, v59
    s_add_u32 s58, s78, 15360
    buffer_load_dwordx4 v[184:187], v6, s[20:23], s58 offen offset:3072 sc1
    v_cvt_pk_bf16_f32 v20, v48, v49
    v_cvt_pk_bf16_f32 v21, v50, v51
    v_mul_f32 v60, v52, v60
    v_mul_f32 v61, v53, v61
    v_mul_f32 v62, v54, v62
    v_mul_f32 v63, v55, v63
    v_mul_f32 v52, v16, v52
    v_mul_f32 v53, v16, v53
    v_mul_f32 v54, v16, v54
    v_mul_f32 v55, v16, v55
    v_exp_f32 v52, v52
    v_exp_f32 v53, v53
    s_add_u32 s58, s78, 15360
    buffer_load_dwordx4 v[188:191], v7, s[20:23], s58 offen offset:0 sc1
    v_exp_f32 v54, v54
    v_exp_f32 v55, v55
    v_fma_f32 v52, v52, v10, v10
    v_fma_f32 v53, v53, v10, v10
    v_fma_f32 v54, v54, v10, v10
    v_fma_f32 v55, v55, v10, v10
    v_rcp_f32 v52, v52
    v_rcp_f32 v53, v53
    v_rcp_f32 v54, v54
    v_rcp_f32 v55, v55
    v_mul_f32 v52, v52, v60
    v_mul_f32 v53, v53, v61
    buffer_load_dwordx4 v[192:195], v6, s[20:23], s40 offen offset:0 sc1
    v_mul_f32 v54, v54, v62
    v_mul_f32 v55, v55, v63
    v_cvt_pk_bf16_f32 v22, v52, v53
    v_cvt_pk_bf16_f32 v23, v54, v55
    s_add_u32 s59, s56, 0
    v_permlane16_swap_b32 v20, v22
    v_permlane16_swap_b32 v21, v23
    buffer_store_dwordx4 v[20:23], v18, s[20:23], s59 offen sc1
    v_mul_f32 v72, v64, v72
    v_mul_f32 v73, v65, v73
    v_mul_f32 v74, v66, v74
    v_mul_f32 v75, v67, v75
    v_mul_f32 v64, v17, v64
    v_mul_f32 v65, v17, v65
    v_mul_f32 v66, v17, v66
    buffer_load_dwordx4 v[196:199], v6, s[20:23], s41 offen offset:0 sc1
    v_mul_f32 v67, v17, v67
    v_exp_f32 v64, v64
    v_exp_f32 v65, v65
    v_exp_f32 v66, v66
    v_exp_f32 v67, v67
    v_fma_f32 v64, v64, v11, v11
    v_fma_f32 v65, v65, v11, v11
    v_fma_f32 v66, v66, v11, v11
    v_fma_f32 v67, v67, v11, v11
    v_rcp_f32 v64, v64
    v_rcp_f32 v65, v65
    v_rcp_f32 v66, v66
    buffer_load_dwordx4 v[200:203], v6, s[20:23], s42 offen offset:0 sc1
    v_rcp_f32 v67, v67
    v_mul_f32 v64, v64, v72
    v_mul_f32 v65, v65, v73
    v_mul_f32 v66, v66, v74
    v_mul_f32 v67, v67, v75
    v_cvt_pk_bf16_f32 v20, v64, v65
    v_cvt_pk_bf16_f32 v21, v66, v67
    v_mul_f32 v76, v68, v76
    v_mul_f32 v77, v69, v77
    v_mul_f32 v78, v70, v78
    v_mul_f32 v79, v71, v79
    v_mul_f32 v68, v17, v68
    buffer_load_dwordx4 v[204:207], v6, s[20:23], s43 offen offset:0 sc1
    v_mul_f32 v69, v17, v69
    v_mul_f32 v70, v17, v70
    v_mul_f32 v71, v17, v71
    v_exp_f32 v68, v68
    v_exp_f32 v69, v69
    v_exp_f32 v70, v70
    v_exp_f32 v71, v71
    v_fma_f32 v68, v68, v11, v11
    v_fma_f32 v69, v69, v11, v11
    v_fma_f32 v70, v70, v11, v11
    v_fma_f32 v71, v71, v11, v11
    v_rcp_f32 v68, v68
    buffer_load_dwordx4 v[208:211], v6, s[20:23], s40 offen offset:1024 sc1
    v_rcp_f32 v69, v69
    v_rcp_f32 v70, v70
    v_rcp_f32 v71, v71
    v_mul_f32 v68, v68, v76
    v_mul_f32 v69, v69, v77
    v_mul_f32 v70, v70, v78
    v_mul_f32 v71, v71, v79
    v_cvt_pk_bf16_f32 v22, v68, v69
    v_cvt_pk_bf16_f32 v23, v70, v71
    s_add_u32 s59, s56, 49152
    v_permlane16_swap_b32 v20, v22
    v_permlane16_swap_b32 v21, v23
    buffer_store_dwordx4 v[20:23], v18, s[20:23], s59 offen sc1
    s_waitcnt vmcnt(10)
    s_barrier
    s_setprio 3
    ds_read_b128 v[20:23], v86 offset:0
    ds_read_b64 v[24:25], v87 offset:0
    ds_read_b128 v[28:31], v86 offset:4096
    ds_read_b64 v[26:27], v87 offset:4096
    ds_read_b64_tr_b16 v[40:41], v3 offset:0
    ds_read_b64_tr_b16 v[42:43], v3 offset:128
    ds_read_b64_tr_b16 v[44:45], v3 offset:256
    ds_read_b64_tr_b16 v[46:47], v3 offset:384
    ds_read_b64_tr_b16 v[12:13], v3 offset:4096
    ds_read_b64_tr_b16 v[14:15], v3 offset:4224
    ds_read_b64_tr_b16 v[16:17], v3 offset:4352
    ds_read_b64_tr_b16 v[18:19], v3 offset:4480
    s_waitcnt lgkmcnt(10)
    v_mfma_f32_32x32x16_bf16 v[48:63], v[20:23], v[80:83], 0
    v_mfma_f32_32x32x8_bf16 v[48:63], v[24:25], v[84:85], v[48:63]
    s_waitcnt lgkmcnt(8)
    v_mfma_f32_32x32x16_bf16 v[64:79], v[28:31], v[80:83], 0
    v_mfma_f32_32x32x8_bf16 v[64:79], v[26:27], v[84:85], v[64:79]
    ds_read_b128 v[20:23], v86 offset:512
    ds_read_b64 v[24:25], v87 offset:512
    s_lshl_b32 s60, -1, 0
    s_lshl_b32 s61, -1, 4
    s_nop 7
    v_cndmask_b32 v48, v48, v64, s[60:61]
    s_lshl_b32 s60, -1, 1
    s_lshl_b32 s61, -1, 5
    v_cndmask_b32 v49, v49, v65, s[60:61]
    s_lshl_b32 s60, -1, 2
    s_lshl_b32 s61, -1, 6
    v_cndmask_b32 v50, v50, v66, s[60:61]
    s_lshl_b32 s60, -1, 3
    s_lshl_b32 s61, -1, 7
    v_cndmask_b32 v51, v51, v67, s[60:61]
    s_lshl_b32 s60, -1, 8
    s_lshl_b32 s61, -1, 12
    v_cndmask_b32 v52, v52, v68, s[60:61]
    s_lshl_b32 s60, -1, 9
    s_lshl_b32 s61, -1, 13
    v_cndmask_b32 v53, v53, v69, s[60:61]
    s_lshl_b32 s60, -1, 10
    s_lshl_b32 s61, -1, 14
    v_cndmask_b32 v54, v54, v70, s[60:61]
    s_lshl_b32 s60, -1, 11
    s_lshl_b32 s61, -1, 15
    v_cndmask_b32 v55, v55, v71, s[60:61]
    s_lshl_b32 s60, -1, 16
    s_lshl_b32 s61, -1, 20
    v_cndmask_b32 v56, v56, v72, s[60:61]
    s_lshl_b32 s60, -1, 17
    s_lshl_b32 s61, -1, 21
    v_cndmask_b32 v57, v57, v73, s[60:61]
    s_lshl_b32 s60, -1, 18
    s_lshl_b32 s61, -1, 22
    v_cndmask_b32 v58, v58, v74, s[60:61]
    s_lshl_b32 s60, -1, 19
    s_lshl_b32 s61, -1, 23
    v_cndmask_b32 v59, v59, v75, s[60:61]
    s_lshl_b32 s60, -1, 24
    s_lshl_b32 s61, -1, 28
    v_cndmask_b32 v60, v60, v76, s[60:61]
    s_lshl_b32 s60, -1, 25
    s_lshl_b32 s61, -1, 29
    v_cndmask_b32 v61, v61, v77, s[60:61]
    s_lshl_b32 s60, -1, 26
    s_lshl_b32 s61, -1, 30
    v_cndmask_b32 v62, v62, v78, s[60:61]
    s_lshl_b32 s60, -1, 27
    s_lshl_b32 s61, -1, 31
    v_cndmask_b32 v63, v63, v79, s[60:61]
    v_exp_f32 v48, v48
    v_exp_f32 v49, v49
    v_exp_f32 v50, v50
    v_exp_f32 v51, v51
    s_waitcnt lgkmcnt(0)
    v_mfma_f32_32x32x16_bf16 v[64:79], v[20:23], v[80:83], 0
    v_exp_f32 v52, v52
    v_exp_f32 v53, v53
    v_exp_f32 v54, v54
    v_exp_f32 v55, v55
    v_mfma_f32_32x32x8_bf16 v[64:79], v[24:25], v[84:85], v[64:79]
    ds_read_b128 v[28:31], v86 offset:1024
    ds_read_b64 v[26:27], v87 offset:1024
    v_cvt_pk_bf16_f32 v32, v48, v49
    v_cvt_pk_bf16_f32 v33, v50, v51
    v_cvt_pk_bf16_f32 v34, v52, v53
    v_cvt_pk_bf16_f32 v35, v54, v55
    v_and_b32 v88, v88, v32
    v_and_b32 v89, v89, v33
    v_and_b32 v90, v90, v34
    v_and_b32 v91, v91, v35
    v_xor_b32 v32, v88, v32
    v_xor_b32 v33, v89, v33
    v_xor_b32 v34, v90, v34
    v_xor_b32 v35, v91, v35
    v_mfma_f32_32x32x16_bf16 v[96:111], v[12:15], v[88:91], 0
    v_exp_f32 v56, v56
    v_exp_f32 v57, v57
    v_exp_f32 v58, v58
    v_exp_f32 v59, v59
    buffer_load_dwordx4 v[212:215], v6, s[20:23], s41 offen offset:1024 sc1
    v_mfma_f32_32x32x16_bf16 v[96:111], v[40:43], v[32:35], v[96:111]
    v_exp_f32 v60, v60
    v_exp_f32 v61, v61
    v_exp_f32 v62, v62
    v_exp_f32 v63, v63
    v_cvt_pk_bf16_f32 v36, v56, v57
    v_cvt_pk_bf16_f32 v37, v58, v59
    v_cvt_pk_bf16_f32 v38, v60, v61
    v_cvt_pk_bf16_f32 v39, v62, v63
    v_and_b32 v92, v92, v36
    v_and_b32 v93, v93, v37
    v_and_b32 v94, v94, v38
    v_and_b32 v95, v95, v39
    v_xor_b32 v36, v92, v36
    v_xor_b32 v37, v93, v37
    v_xor_b32 v38, v94, v38
    v_xor_b32 v39, v95, v39
    v_mfma_f32_32x32x16_bf16 v[96:111], v[16:19], v[92:95], v[96:111]
    s_nop 0
    v_mfma_f32_32x32x16_bf16 v[96:111], v[44:47], v[36:39], v[96:111]
    ds_read_b64_tr_b16 v[12:13], v3 offset:512
    ds_read_b64_tr_b16 v[14:15], v3 offset:640
    ds_read_b64_tr_b16 v[16:17], v3 offset:768
    ds_read_b64_tr_b16 v[18:19], v3 offset:896
    v_exp_f32 v64, v64
    v_exp_f32 v65, v65
    v_exp_f32 v66, v66
    v_exp_f32 v67, v67
    s_waitcnt lgkmcnt(4)
    v_mfma_f32_32x32x16_bf16 v[48:63], v[28:31], v[80:83], 0
    ds_read_b64_tr_b16 v[40:41], v3 offset:1024
    ds_read_b64_tr_b16 v[42:43], v3 offset:1152
    buffer_load_dwordx4 v[216:219], v6, s[20:23], s42 offen offset:1024 sc1
    v_exp_f32 v68, v68
    v_exp_f32 v69, v69
    v_exp_f32 v70, v70
    v_exp_f32 v71, v71
    v_mfma_f32_32x32x8_bf16 v[48:63], v[26:27], v[84:85], v[48:63]
    ds_read_b64_tr_b16 v[44:45], v3 offset:1280
    ds_read_b64_tr_b16 v[46:47], v3 offset:1408
    v_cvt_pk_bf16_f32 v32, v64, v65
    v_cvt_pk_bf16_f32 v33, v66, v67
    v_cvt_pk_bf16_f32 v34, v68, v69
    v_cvt_pk_bf16_f32 v35, v70, v71
    v_exp_f32 v72, v72
    v_exp_f32 v73, v73
    s_waitcnt lgkmcnt(4)
    v_mfma_f32_32x32x16_bf16 v[96:111], v[12:15], v[32:35], v[96:111]
    v_exp_f32 v74, v74
    v_exp_f32 v75, v75
    v_exp_f32 v76, v76
    v_exp_f32 v77, v77
    v_exp_f32 v78, v78
    v_exp_f32 v79, v79
    v_cvt_pk_bf16_f32 v36, v72, v73
    v_cvt_pk_bf16_f32 v37, v74, v75
    v_cvt_pk_bf16_f32 v38, v76, v77
    v_cvt_pk_bf16_f32 v39, v78, v79
    ds_read_b128 v[20:23], v86 offset:1536
    ds_read_b64 v[24:25], v87 offset:1536
    v_mfma_f32_32x32x16_bf16 v[96:111], v[16:19], v[36:39], v[96:111]
    buffer_load_dwordx4 v[220:223], v6, s[20:23], s43 offen offset:1024 sc1
    s_setprio 2
    s_waitcnt vmcnt(3)
    v_mov_b32 v2, 162816
    v_mov_b32 v9, 1
    s_mov_b64 exec, 1
    ds_add_rtn_u32 v9, v2, v9 offset:24
    s_mov_b64 exec, -1
    v_exp_f32 v48, v48
    v_exp_f32 v49, v49
    v_exp_f32 v50, v50
    v_exp_f32 v51, v51
    s_waitcnt lgkmcnt(1)
    v_mfma_f32_32x32x16_bf16 v[64:79], v[20:23], v[80:83], 0
    ds_read_b64_tr_b16 v[12:13], v3 offset:1536
    ds_read_b64_tr_b16 v[14:15], v3 offset:1664
    v_exp_f32 v52, v52
    v_exp_f32 v53, v53
    v_exp_f32 v54, v54
    v_exp_f32 v55, v55
    s_waitcnt lgkmcnt(2)
    v_readfirstlane_b32 s58, v9
    s_nop 0
    s_cmp_lg_u32 s58, 7
    s_cbranch_scc1 L_nf24
    v_mov_b32 v8, 4
    v_mov_b32 v9, 0
    s_mov_b64 exec, 1
    buffer_store_dword v8, v9, s[20:23], s52 offen sc1
    s_mov_b64 exec, -1
L_nf24:
    v_mfma_f32_32x32x8_bf16 v[64:79], v[24:25], v[84:85], v[64:79]
    ds_read_b64_tr_b16 v[16:17], v3 offset:1792
    ds_read_b64_tr_b16 v[18:19], v3 offset:1920
    v_cvt_pk_bf16_f32 v32, v48, v49
    v_cvt_pk_bf16_f32 v33, v50, v51
    v_cvt_pk_bf16_f32 v34, v52, v53
    v_cvt_pk_bf16_f32 v35, v54, v55
    v_exp_f32 v56, v56
    v_exp_f32 v57, v57
    v_mfma_f32_32x32x16_bf16 v[96:111], v[40:43], v[32:35], v[96:111]
    v_exp_f32 v58, v58
    v_exp_f32 v59, v59
    v_exp_f32 v60, v60
    v_exp_f32 v61, v61
    v_exp_f32 v62, v62
    v_exp_f32 v63, v63
    v_cvt_pk_bf16_f32 v36, v56, v57
    v_cvt_pk_bf16_f32 v37, v58, v59
    v_cvt_pk_bf16_f32 v38, v60, v61
    v_cvt_pk_bf16_f32 v39, v62, v63
    ds_read_b128 v[28:31], v86 offset:2048
    ds_read_b64 v[26:27], v87 offset:2048
    buffer_load_dwordx4 v[224:227], v6, s[20:23], s40 offen offset:2048 sc1
    v_mfma_f32_32x32x16_bf16 v[96:111], v[44:47], v[36:39], v[96:111]
    v_exp_f32 v64, v64
    v_exp_f32 v65, v65
    v_exp_f32 v66, v66
    v_exp_f32 v67, v67
    s_waitcnt lgkmcnt(0)
    v_mfma_f32_32x32x16_bf16 v[48:63], v[28:31], v[80:83], 0
    ds_read_b64_tr_b16 v[40:41], v3 offset:2048
    ds_read_b64_tr_b16 v[42:43], v3 offset:2176
    buffer_load_dwordx4 v[228:231], v6, s[20:23], s41 offen offset:2048 sc1
    v_exp_f32 v68, v68
    v_exp_f32 v69, v69
    v_exp_f32 v70, v70
    v_exp_f32 v71, v71
    v_mfma_f32_32x32x8_bf16 v[48:63], v[26:27], v[84:85], v[48:63]
    ds_read_b64_tr_b16 v[44:45], v3 offset:2304
    ds_read_b64_tr_b16 v[46:47], v3 offset:2432
    v_cvt_pk_bf16_f32 v32, v64, v65
    v_cvt_pk_bf16_f32 v33, v66, v67
    v_cvt_pk_bf16_f32 v34, v68, v69
    v_cvt_pk_bf16_f32 v35, v70, v71
    v_exp_f32 v72, v72
    v_exp_f32 v73, v73
    v_mfma_f32_32x32x16_bf16 v[96:111], v[12:15], v[32:35], v[96:111]
    v_exp_f32 v74, v74
    v_exp_f32 v75, v75
    v_exp_f32 v76, v76
    v_exp_f32 v77, v77
    v_exp_f32 v78, v78
    v_exp_f32 v79, v79
    v_cvt_pk_bf16_f32 v36, v72, v73
    v_cvt_pk_bf16_f32 v37, v74, v75
    v_cvt_pk_bf16_f32 v38, v76, v77
    v_cvt_pk_bf16_f32 v39, v78, v79
    ds_read_b128 v[20:23], v86 offset:2560
    ds_read_b64 v[24:25], v87 offset:2560
    v_mfma_f32_32x32x16_bf16 v[96:111], v[16:19], v[36:39], v[96:111]
    buffer_load_dwordx4 v[232:235], v6, s[20:23], s42 offen offset:2048 sc1
    s_setprio 1
    v_exp_f32 v48, v48
    v_exp_f32 v49, v49
    v_exp_f32 v50, v50
    v_exp_f32 v51, v51
    s_waitcnt lgkmcnt(0)
    v_mfma_f32_32x32x16_bf16 v[64:79], v[20:23], v[80:83], 0
    ds_read_b64_tr_b16 v[12:13], v3 offset:2560
    ds_read_b64_tr_b16 v[14:15], v3 offset:2688
    v_exp_f32 v52, v52
    v_exp_f32 v53, v53
    v_exp_f32 v54, v54
    v_exp_f32 v55, v55
    v_mfma_f32_32x32x8_bf16 v[64:79], v[24:25], v[84:85], v[64:79]
    ds_read_b64_tr_b16 v[16:17], v3 offset:2816
    ds_read_b64_tr_b16 v[18:19], v3 offset:2944
    v_cvt_pk_bf16_f32 v32, v48, v49
    v_cvt_pk_bf16_f32 v33, v50, v51
    v_cvt_pk_bf16_f32 v34, v52, v53
    v_cvt_pk_bf16_f32 v35, v54, v55
    v_exp_f32 v56, v56
    v_exp_f32 v57, v57
    v_mfma_f32_32x32x16_bf16 v[96:111], v[40:43], v[32:35], v[96:111]
    v_exp_f32 v58, v58
    v_exp_f32 v59, v59
    v_exp_f32 v60, v60
    v_exp_f32 v61, v61
    v_exp_f32 v62, v62
    v_exp_f32 v63, v63
    v_cvt_pk_bf16_f32 v36, v56, v57
    v_cvt_pk_bf16_f32 v37, v58, v59
    v_cvt_pk_bf16_f32 v38, v60, v61
    v_cvt_pk_bf16_f32 v39, v62, v63
    ds_read_b128 v[28:31], v86 offset:3072
    ds_read_b64 v[26:27], v87 offset:3072
    buffer_load_dwordx4 v[236:239], v6, s[20:23], s43 offen offset:2048 sc1
    v_mfma_f32_32x32x16_bf16 v[96:111], v[44:47], v[36:39], v[96:111]
    v_exp_f32 v64, v64
    v_exp_f32 v65, v65
    v_exp_f32 v66, v66
    v_exp_f32 v67, v67
    s_waitcnt lgkmcnt(0)
    v_mfma_f32_32x32x16_bf16 v[48:63], v[28:31], v[80:83], 0
    ds_read_b64_tr_b16 v[40:41], v3 offset:3072
    ds_read_b64_tr_b16 v[42:43], v3 offset:3200
    v_exp_f32 v68, v68
    v_exp_f32 v69, v69
    v_exp_f32 v70, v70
    v_exp_f32 v71, v71
    v_mfma_f32_32x32x8_bf16 v[48:63], v[26:27], v[84:85], v[48:63]
    ds_read_b64_tr_b16 v[44:45], v3 offset:3328
    ds_read_b64_tr_b16 v[46:47], v3 offset:3456
    v_cvt_pk_bf16_f32 v32, v64, v65
    v_cvt_pk_bf16_f32 v33, v66, v67
    v_cvt_pk_bf16_f32 v34, v68, v69
    v_cvt_pk_bf16_f32 v35, v70, v71
    v_exp_f32 v72, v72
    v_exp_f32 v73, v73
    v_mfma_f32_32x32x16_bf16 v[96:111], v[12:15], v[32:35], v[96:111]
    buffer_load_dwordx4 v[240:243], v6, s[20:23], s40 offen offset:3072 sc1
    v_exp_f32 v74, v74
    v_exp_f32 v75, v75
    v_exp_f32 v76, v76
    v_exp_f32 v77, v77
    v_exp_f32 v78, v78
    v_exp_f32 v79, v79
    v_cvt_pk_bf16_f32 v36, v72, v73
    v_cvt_pk_bf16_f32 v37, v74, v75
    v_cvt_pk_bf16_f32 v38, v76, v77
    v_cvt_pk_bf16_f32 v39, v78, v79
    ds_read_b128 v[20:23], v86 offset:3584
    ds_read_b64 v[24:25], v87 offset:3584
    v_mfma_f32_32x32x16_bf16 v[96:111], v[16:19], v[36:39], v[96:111]
    buffer_load_dwordx4 v[244:247], v6, s[20:23], s41 offen offset:3072 sc1
    s_setprio 0
    v_exp_f32 v48, v48
    v_exp_f32 v49, v49
    v_exp_f32 v50, v50
    v_exp_f32 v51, v51
    s_waitcnt lgkmcnt(0)
    v_mfma_f32_32x32x16_bf16 v[64:79], v[20:23], v[80:83], 0
    ds_read_b64_tr_b16 v[12:13], v3 offset:3584
    ds_read_b64_tr_b16 v[14:15], v3 offset:3712
    v_exp_f32 v52, v52
    v_exp_f32 v53, v53
    v_exp_f32 v54, v54
    v_exp_f32 v55, v55
    v_mfma_f32_32x32x8_bf16 v[64:79], v[24:25], v[84:85], v[64:79]
    ds_read_b64_tr_b16 v[16:17], v3 offset:3840
    ds_read_b64_tr_b16 v[18:19], v3 offset:3968
    v_cvt_pk_bf16_f32 v32, v48, v49
    v_cvt_pk_bf16_f32 v33, v50, v51
    v_cvt_pk_bf16_f32 v34, v52, v53
    v_cvt_pk_bf16_f32 v35, v54, v55
    v_exp_f32 v56, v56
    v_exp_f32 v57, v57
    v_mfma_f32_32x32x16_bf16 v[96:111], v[40:43], v[32:35], v[96:111]
    v_exp_f32 v58, v58
    v_exp_f32 v59, v59
    v_exp_f32 v60, v60
    v_exp_f32 v61, v61
    v_exp_f32 v62, v62
    v_exp_f32 v63, v63
    v_cvt_pk_bf16_f32 v36, v56, v57
    v_cvt_pk_bf16_f32 v37, v58, v59
    v_cvt_pk_bf16_f32 v38, v60, v61
    v_cvt_pk_bf16_f32 v39, v62, v63
    buffer_load_dwordx4 v[248:251], v6, s[20:23], s42 offen offset:3072 sc1
    s_nop 0
    v_mfma_f32_32x32x16_bf16 v[96:111], v[44:47], v[36:39], v[96:111]
    v_lshrrev_b32 v10, 4, v0
    v_lshlrev_b32 v10, 13, v10
    s_lshr_b32 s58, s79, 3
    s_lshl1_add_u32 s58, s47, s58
    s_and_b32 s59, s79, 7
    s_lshl3_add_u32 s58, s59, s58
    s_lshl_b32 s79, s58, 7
    v_add_u32 v1, s83, v6
    v_exp_f32 v64, v64
    v_exp_f32 v65, v65
    v_exp_f32 v66, v66
    v_exp_f32 v67, v67
    v_exp_f32 v68, v68
    v_exp_f32 v69, v69
    v_exp_f32 v70, v70
    v_exp_f32 v71, v71
    v_cvt_pk_bf16_f32 v32, v64, v65
    v_cvt_pk_bf16_f32 v33, v66, v67
    v_cvt_pk_bf16_f32 v34, v68, v69
    v_cvt_pk_bf16_f32 v35, v70, v71
    v_exp_f32 v72, v72
    v_exp_f32 v73, v73
    s_waitcnt lgkmcnt(0)
    v_mfma_f32_32x32x16_bf16 v[96:111], v[12:15], v[32:35], v[96:111]
    buffer_load_dwordx4 v[252:255], v6, s[20:23], s43 offen offset:3072 sc1
    v_exp_f32 v74, v74
    v_exp_f32 v75, v75
    v_exp_f32 v76, v76
    v_exp_f32 v77, v77
    v_exp_f32 v78, v78
    v_exp_f32 v79, v79
    v_cvt_pk_bf16_f32 v36, v72, v73
    v_cvt_pk_bf16_f32 v37, v74, v75
    v_cvt_pk_bf16_f32 v38, v76, v77
    v_cvt_pk_bf16_f32 v39, v78, v79
    s_nop 1
    v_mfma_f32_32x32x16_bf16 v[96:111], v[16:19], v[36:39], v[96:111]
    v_mov_b32 v8, 0x2b800000
    v_mov_b32 v9, 0x53800000
    s_nop 9
    v_med3_f32 v8, v108, v8, v9
    v_mul_f32 v9, 0, v96
    v_fmac_f32 v9, 0, v97
    v_fmac_f32 v8, 0, v98
    v_fmac_f32 v9, 0, v99
    v_fmac_f32 v8, 0, v100
    v_fmac_f32 v9, 0, v101
    v_fmac_f32 v8, 0, v102
    v_fmac_f32 v9, 0, v103
    v_fmac_f32 v8, 0, v104
    v_fmac_f32 v9, 0, v105
    v_fmac_f32 v8, 0, v106
    v_fmac_f32 v9, 0, v107
    v_add_f32 v8, v8, v9
    v_cmp_eq_f32 vcc, v8, v108
    s_nop 0
    s_cmp_eq_u64 vcc, -1
    s_cbranch_scc1 L_aokA
    s_call_b64 s[62:63], L_fallback
L_aokA:
    v_mov_b32 v9, 1
    s_mov_b64 exec, 1
    ds_add_u32 v2, v9 offset:28
    s_mov_b64 exec, -1
    v_rcp_f32 v8, v108
    s_nop 0
    v_mul_f32 v96, v8, v96
    v_mul_f32 v97, v8, v97
    v_mul_f32 v98, v8, v98
    v_mul_f32 v99, v8, v99
    v_mul_f32 v100, v8, v100
    v_mul_f32 v101, v8, v101
    v_mul_f32 v102, v8, v102
    v_mul_f32 v103, v8, v103
    v_mul_f32 v104, v8, v104
    v_mul_f32 v105, v8, v105
    v_mul_f32 v106, v8, v106
    v_mul_f32 v107, v8, v107
    v_cvt_pk_bf16_f32 v48, v96, v97
    v_cvt_pk_bf16_f32 v49, v98, v99
    v_cvt_pk_bf16_f32 v50, v100, v101
    v_cvt_pk_bf16_f32 v51, v102, v103
    v_cvt_pk_bf16_f32 v52, v104, v105
    v_cvt_pk_bf16_f32 v53, v106, v107
    buffer_store_dwordx4 v[48:51], v4, s[20:23], s57 offen sc1
    buffer_store_dwordx2 v[52:53], v5, s[20:23], s3 offen sc1
    v_mov_b32 v8, 162816
    s_setprio 0
    buffer_load_dword v11, v10, s[20:23], s79 offen sc1
    v_mfma_f32_16x16x32_bf16 v[32:35], v[112:115], v[192:195], 0
    v_mfma_f32_16x16x32_bf16 v[52:55], v[112:115], v[196:199], 0
    v_mfma_f32_16x16x32_bf16 v[72:75], v[112:115], v[200:203], 0
    v_mfma_f32_16x16x32_bf16 v[92:95], v[112:115], v[204:207], 0
    v_mfma_f32_16x16x32_bf16 v[36:39], v[116:119], v[192:195], 0
    v_mfma_f32_16x16x32_bf16 v[56:59], v[116:119], v[196:199], 0
    v_mfma_f32_16x16x32_bf16 v[76:79], v[116:119], v[200:203], 0
    v_mfma_f32_16x16x32_bf16 v[96:99], v[116:119], v[204:207], 0
    v_mfma_f32_16x16x32_bf16 v[40:43], v[120:123], v[192:195], 0
    v_mfma_f32_16x16x32_bf16 v[60:63], v[120:123], v[196:199], 0
    v_mfma_f32_16x16x32_bf16 v[80:83], v[120:123], v[200:203], 0
    v_mfma_f32_16x16x32_bf16 v[100:103], v[120:123], v[204:207], 0
    v_mfma_f32_16x16x32_bf16 v[44:47], v[124:127], v[192:195], 0
    v_mfma_f32_16x16x32_bf16 v[64:67], v[124:127], v[196:199], 0
    v_mfma_f32_16x16x32_bf16 v[84:87], v[124:127], v[200:203], 0
    v_mfma_f32_16x16x32_bf16 v[104:107], v[124:127], v[204:207], 0
    v_mfma_f32_16x16x32_bf16 v[48:51], v[128:131], v[192:195], 0
    v_mfma_f32_16x16x32_bf16 v[68:71], v[128:131], v[196:199], 0
    v_mfma_f32_16x16x32_bf16 v[88:91], v[128:131], v[200:203], 0
    v_mfma_f32_16x16x32_bf16 v[108:111], v[128:131], v[204:207], 0
    s_waitcnt vmcnt(11)
    v_mfma_f32_16x16x32_bf16 v[32:35], v[132:135], v[208:211], v[32:35]
    v_mfma_f32_16x16x32_bf16 v[52:55], v[132:135], v[212:215], v[52:55]
    s_add_u32 s58, s78, 40960
    buffer_load_dwordx4 v[112:115], v6, s[20:23], s58 offen offset:0 sc1
    v_mfma_f32_16x16x32_bf16 v[72:75], v[132:135], v[216:219], v[72:75]
    v_mfma_f32_16x16x32_bf16 v[92:95], v[132:135], v[220:223], v[92:95]
    s_add_u32 s58, s78, 40960
    buffer_load_dwordx4 v[116:119], v6, s[20:23], s58 offen offset:1024 sc1
    v_mfma_f32_16x16x32_bf16 v[36:39], v[136:139], v[208:211], v[36:39]
    v_mfma_f32_16x16x32_bf16 v[56:59], v[136:139], v[212:215], v[56:59]
    s_add_u32 s58, s78, 40960
    buffer_load_dwordx4 v[120:123], v6, s[20:23], s58 offen offset:2048 sc1
    v_mfma_f32_16x16x32_bf16 v[76:79], v[136:139], v[216:219], v[76:79]
    v_mfma_f32_16x16x32_bf16 v[96:99], v[136:139], v[220:223], v[96:99]
    s_add_u32 s58, s78, 40960
    buffer_load_dwordx4 v[124:127], v6, s[20:23], s58 offen offset:3072 sc1
    v_mfma_f32_16x16x32_bf16 v[40:43], v[140:143], v[208:211], v[40:43]
    v_mfma_f32_16x16x32_bf16 v[60:63], v[140:143], v[212:215], v[60:63]
    s_add_u32 s58, s78, 40960
    buffer_load_dwordx4 v[128:131], v7, s[20:23], s58 offen offset:0 sc1
    v_mfma_f32_16x16x32_bf16 v[80:83], v[140:143], v[216:219], v[80:83]
    v_mfma_f32_16x16x32_bf16 v[100:103], v[140:143], v[220:223], v[100:103]
    v_mfma_f32_16x16x32_bf16 v[44:47], v[144:147], v[208:211], v[44:47]
    v_mfma_f32_16x16x32_bf16 v[64:67], v[144:147], v[212:215], v[64:67]
    v_mfma_f32_16x16x32_bf16 v[84:87], v[144:147], v[216:219], v[84:87]
    v_mfma_f32_16x16x32_bf16 v[104:107], v[144:147], v[220:223], v[104:107]
    v_mfma_f32_16x16x32_bf16 v[48:51], v[148:151], v[208:211], v[48:51]
    v_mfma_f32_16x16x32_bf16 v[68:71], v[148:151], v[212:215], v[68:71]
    v_mfma_f32_16x16x32_bf16 v[88:91], v[148:151], v[216:219], v[88:91]
    v_mfma_f32_16x16x32_bf16 v[108:111], v[148:151], v[220:223], v[108:111]
    s_waitcnt vmcnt(5)
    v_cmp_le_u32 vcc, 4, v11
    s_nop 0
    s_cmp_eq_u64 vcc, -1
    s_cbranch_scc0 L_pslow25
L_pok25:
    v_mfma_f32_16x16x32_bf16 v[32:35], v[152:155], v[224:227], v[32:35]
    v_mfma_f32_16x16x32_bf16 v[52:55], v[152:155], v[228:231], v[52:55]
    s_add_u32 s58, s40, 4096
    buffer_load_dwordx4 v[192:195], v6, s[20:23], s58 offen offset:0 sc1
    v_mfma_f32_16x16x32_bf16 v[72:75], v[152:155], v[232:235], v[72:75]
    v_mfma_f32_16x16x32_bf16 v[92:95], v[152:155], v[236:239], v[92:95]
    s_add_u32 s58, s41, 4096
    buffer_load_dwordx4 v[196:199], v6, s[20:23], s58 offen offset:0 sc1
    v_mfma_f32_16x16x32_bf16 v[36:39], v[156:159], v[224:227], v[36:39]
    v_mfma_f32_16x16x32_bf16 v[56:59], v[156:159], v[228:231], v[56:59]
    s_add_u32 s58, s42, 4096
    buffer_load_dwordx4 v[200:203], v6, s[20:23], s58 offen offset:0 sc1
    v_mfma_f32_16x16x32_bf16 v[76:79], v[156:159], v[232:235], v[76:79]
    v_mfma_f32_16x16x32_bf16 v[96:99], v[156:159], v[236:239], v[96:99]
    s_add_u32 s58, s43, 4096
    buffer_load_dwordx4 v[204:207], v6, s[20:23], s58 offen offset:0 sc1
    v_mfma_f32_16x16x32_bf16 v[40:43], v[160:163], v[224:227], v[40:43]
    v_mfma_f32_16x16x32_bf16 v[60:63], v[160:163], v[228:231], v[60:63]
    s_add_u32 s58, s40, 4096
    buffer_load_dwordx4 v[208:211], v6, s[20:23], s58 offen offset:1024 sc1
    v_mfma_f32_16x16x32_bf16 v[80:83], v[160:163], v[232:235], v[80:83]
    v_mfma_f32_16x16x32_bf16 v[100:103], v[160:163], v[236:239], v[100:103]
    s_add_u32 s58, s41, 4096
    buffer_load_dwordx4 v[212:215], v6, s[20:23], s58 offen offset:1024 sc1
    v_mfma_f32_16x16x32_bf16 v[44:47], v[164:167], v[224:227], v[44:47]
    v_mfma_f32_16x16x32_bf16 v[64:67], v[164:167], v[228:231], v[64:67]
    s_add_u32 s58, s42, 4096
    buffer_load_dwordx4 v[216:219], v6, s[20:23], s58 offen offset:1024 sc1
    v_mfma_f32_16x16x32_bf16 v[84:87], v[164:167], v[232:235], v[84:87]
    v_mfma_f32_16x16x32_bf16 v[104:107], v[164:167], v[236:239], v[104:107]
    s_add_u32 s58, s43, 4096
    buffer_load_dwordx4 v[220:223], v6, s[20:23], s58 offen offset:1024 sc1
    v_mfma_f32_16x16x32_bf16 v[48:51], v[168:171], v[224:227], v[48:51]
    v_mfma_f32_16x16x32_bf16 v[68:71], v[168:171], v[228:231], v[68:71]
    v_mfma_f32_16x16x32_bf16 v[88:91], v[168:171], v[232:235], v[88:91]
    v_mfma_f32_16x16x32_bf16 v[108:111], v[168:171], v[236:239], v[108:111]
    v_mov_b32 v2, 1
    s_mov_b64 exec, 1
    ds_add_rtn_u32 v2, v8, v2 offset:20
    s_mov_b64 exec, -1
    v_mfma_f32_16x16x32_bf16 v[32:35], v[172:175], v[240:243], v[32:35]
    v_mfma_f32_16x16x32_bf16 v[52:55], v[172:175], v[244:247], v[52:55]
    s_add_u32 s58, s40, 4096
    buffer_load_dwordx4 v[224:227], v6, s[20:23], s58 offen offset:2048 sc1
    v_mfma_f32_16x16x32_bf16 v[72:75], v[172:175], v[248:251], v[72:75]
    v_mfma_f32_16x16x32_bf16 v[92:95], v[172:175], v[252:255], v[92:95]
    s_add_u32 s58, s41, 4096
    buffer_load_dwordx4 v[228:231], v6, s[20:23], s58 offen offset:2048 sc1
    v_mfma_f32_16x16x32_bf16 v[36:39], v[176:179], v[240:243], v[36:39]
    v_mfma_f32_16x16x32_bf16 v[56:59], v[176:179], v[244:247], v[56:59]
    s_waitcnt lgkmcnt(0)
    v_readfirstlane_b32 s58, v2
    s_nop 0
    s_cmp_lg_u32 s58, 7
    s_cbranch_scc1 L_nf26
    v_mov_b32 v4, 5
    v_mov_b32 v5, 0
    s_mov_b64 exec, 1
    buffer_store_dword v4, v5, s[20:23], s52 offen sc1
    s_mov_b64 exec, -1
L_nf26:
    v_mfma_f32_16x16x32_bf16 v[76:79], v[176:179], v[248:251], v[76:79]
    v_mfma_f32_16x16x32_bf16 v[96:99], v[176:179], v[252:255], v[96:99]
    s_add_u32 s58, s42, 4096
    buffer_load_dwordx4 v[232:235], v6, s[20:23], s58 offen offset:2048 sc1
    v_mfma_f32_16x16x32_bf16 v[40:43], v[180:183], v[240:243], v[40:43]
    v_mfma_f32_16x16x32_bf16 v[60:63], v[180:183], v[244:247], v[60:63]
    s_add_u32 s58, s43, 4096
    buffer_load_dwordx4 v[236:239], v6, s[20:23], s58 offen offset:2048 sc1
    v_mfma_f32_16x16x32_bf16 v[80:83], v[180:183], v[248:251], v[80:83]
    v_mfma_f32_16x16x32_bf16 v[100:103], v[180:183], v[252:255], v[100:103]
    s_add_u32 s58, s78, 46080
    buffer_load_dwordx4 v[132:135], v6, s[20:23], s58 offen offset:0 sc1
    v_mfma_f32_16x16x32_bf16 v[44:47], v[184:187], v[240:243], v[44:47]
    v_mfma_f32_16x16x32_bf16 v[64:67], v[184:187], v[244:247], v[64:67]
    s_add_u32 s58, s78, 46080
    buffer_load_dwordx4 v[136:139], v6, s[20:23], s58 offen offset:1024 sc1
    v_mfma_f32_16x16x32_bf16 v[84:87], v[184:187], v[248:251], v[84:87]
    v_mfma_f32_16x16x32_bf16 v[104:107], v[184:187], v[252:255], v[104:107]
    s_add_u32 s58, s78, 46080
    buffer_load_dwordx4 v[140:143], v6, s[20:23], s58 offen offset:2048 sc1
    v_mfma_f32_16x16x32_bf16 v[48:51], v[188:191], v[240:243], v[48:51]
    v_mfma_f32_16x16x32_bf16 v[68:71], v[188:191], v[244:247], v[68:71]
    v_mfma_f32_16x16x32_bf16 v[88:91], v[188:191], v[248:251], v[88:91]
    v_mfma_f32_16x16x32_bf16 v[108:111], v[188:191], v[252:255], v[108:111]
L_lw27:
    ds_read_b32 v9, v8 offset:20
    s_waitcnt lgkmcnt(0)
    v_readfirstlane_b32 s58, v9
    s_nop 0
    s_cmp_ge_u32 s58, 8
    s_cbranch_scc1 L_lwd27
    s_sleep 1
    s_branch L_lw27
L_lwd27:
    ds_read_b128 v[12:15], v1 offset:0
    ds_read_b128 v[16:19], v1 offset:1024
    ds_read_b128 v[20:23], v1 offset:2048
    ds_read_b128 v[24:27], v1 offset:3072
    ds_read_b128 v[28:31], v1 offset:4096
    s_waitcnt vmcnt(11)
    s_waitcnt lgkmcnt(4)
    v_mfma_f32_16x16x32_bf16 v[32:35], v[12:15], v[192:195], v[32:35]
    v_mfma_f32_16x16x32_bf16 v[52:55], v[12:15], v[196:199], v[52:55]
    s_add_u32 s58, s40, 4096
    buffer_load_dwordx4 v[240:243], v6, s[20:23], s58 offen offset:3072 sc1
    v_mfma_f32_16x16x32_bf16 v[72:75], v[12:15], v[200:203], v[72:75]
    v_mfma_f32_16x16x32_bf16 v[92:95], v[12:15], v[204:207], v[92:95]
    s_add_u32 s58, s41, 4096
    buffer_load_dwordx4 v[244:247], v6, s[20:23], s58 offen offset:3072 sc1
    s_waitcnt lgkmcnt(3)
    v_mfma_f32_16x16x32_bf16 v[36:39], v[16:19], v[192:195], v[36:39]
    ds_read_b128 v[12:15], v1 offset:5120
    v_mfma_f32_16x16x32_bf16 v[56:59], v[16:19], v[196:199], v[56:59]
    s_add_u32 s58, s42, 4096
    buffer_load_dwordx4 v[248:251], v6, s[20:23], s58 offen offset:3072 sc1
    v_mfma_f32_16x16x32_bf16 v[76:79], v[16:19], v[200:203], v[76:79]
    v_mfma_f32_16x16x32_bf16 v[96:99], v[16:19], v[204:207], v[96:99]
    s_add_u32 s58, s43, 4096
    buffer_load_dwordx4 v[252:255], v6, s[20:23], s58 offen offset:3072 sc1
    s_waitcnt lgkmcnt(3)
    v_mfma_f32_16x16x32_bf16 v[40:43], v[20:23], v[192:195], v[40:43]
    ds_read_b128 v[16:19], v1 offset:6144
    v_mfma_f32_16x16x32_bf16 v[60:63], v[20:23], v[196:199], v[60:63]
    s_add_u32 s58, s78, 46080
    buffer_load_dwordx4 v[144:147], v6, s[20:23], s58 offen offset:3072 sc1
    v_mfma_f32_16x16x32_bf16 v[80:83], v[20:23], v[200:203], v[80:83]
    v_mfma_f32_16x16x32_bf16 v[100:103], v[20:23], v[204:207], v[100:103]
    s_add_u32 s58, s78, 46080
    buffer_load_dwordx4 v[148:151], v7, s[20:23], s58 offen offset:0 sc1
    s_waitcnt lgkmcnt(3)
    v_mfma_f32_16x16x32_bf16 v[44:47], v[24:27], v[192:195], v[44:47]
    ds_read_b128 v[20:23], v1 offset:7168
    v_mfma_f32_16x16x32_bf16 v[64:67], v[24:27], v[196:199], v[64:67]
    s_add_u32 s58, s78, 51200
    buffer_load_dwordx4 v[152:155], v6, s[20:23], s58 offen offset:0 sc1
    v_mfma_f32_16x16x32_bf16 v[84:87], v[24:27], v[200:203], v[84:87]
    v_mfma_f32_16x16x32_bf16 v[104:107], v[24:27], v[204:207], v[104:107]
    s_waitcnt lgkmcnt(3)
    v_mfma_f32_16x16x32_bf16 v[48:51], v[28:31], v[192:195], v[48:51]
    ds_read_b128 v[24:27], v1 offset:8192
    v_mfma_f32_16x16x32_bf16 v[68:71], v[28:31], v[196:199], v[68:71]
    v_mfma_f32_16x16x32_bf16 v[88:91], v[28:31], v[200:203], v[88:91]
    v_mfma_f32_16x16x32_bf16 v[108:111], v[28:31], v[204:207], v[108:111]
    ds_read_b128 v[28:31], v1 offset:9216
    s_waitcnt vmcnt(14)
    s_waitcnt lgkmcnt(4)
    v_mfma_f32_16x16x32_bf16 v[32:35], v[12:15], v[208:211], v[32:35]
    v_mfma_f32_16x16x32_bf16 v[52:55], v[12:15], v[212:215], v[52:55]
    s_add_u32 s58, s78, 51200
    buffer_load_dwordx4 v[156:159], v6, s[20:23], s58 offen offset:1024 sc1
    v_mfma_f32_16x16x32_bf16 v[72:75], v[12:15], v[216:219], v[72:75]
    v_mfma_f32_16x16x32_bf16 v[92:95], v[12:15], v[220:223], v[92:95]
    s_add_u32 s58, s78, 51200
    buffer_load_dwordx4 v[160:163], v6, s[20:23], s58 offen offset:2048 sc1
    s_waitcnt lgkmcnt(3)
    v_mfma_f32_16x16x32_bf16 v[36:39], v[16:19], v[208:211], v[36:39]
    ds_read_b128 v[12:15], v1 offset:10240
    v_mfma_f32_16x16x32_bf16 v[56:59], v[16:19], v[212:215], v[56:59]
    s_add_u32 s58, s78, 51200
    buffer_load_dwordx4 v[164:167], v6, s[20:23], s58 offen offset:3072 sc1
    v_mfma_f32_16x16x32_bf16 v[76:79], v[16:19], v[216:219], v[76:79]
    v_mfma_f32_16x16x32_bf16 v[96:99], v[16:19], v[220:223], v[96:99]
    s_add_u32 s58, s40, 8192
    buffer_load_dwordx4 v[192:195], v6, s[20:23], s58 offen offset:0 sc1
    s_waitcnt lgkmcnt(3)
    v_mfma_f32_16x16x32_bf16 v[40:43], v[20:23], v[208:211], v[40:43]
    ds_read_b128 v[16:19], v1 offset:11264
    v_mfma_f32_16x16x32_bf16 v[60:63], v[20:23], v[212:215], v[60:63]
    s_add_u32 s58, s41, 8192
    buffer_load_dwordx4 v[196:199], v6, s[20:23], s58 offen offset:0 sc1
    v_mfma_f32_16x16x32_bf16 v[80:83], v[20:23], v[216:219], v[80:83]
    v_mfma_f32_16x16x32_bf16 v[100:103], v[20:23], v[220:223], v[100:103]
    s_add_u32 s58, s42, 8192
    buffer_load_dwordx4 v[200:203], v6, s[20:23], s58 offen offset:0 sc1
    s_waitcnt lgkmcnt(3)
    v_mfma_f32_16x16x32_bf16 v[44:47], v[24:27], v[208:211], v[44:47]
    ds_read_b128 v[20:23], v1 offset:12288
    v_mfma_f32_16x16x32_bf16 v[64:67], v[24:27], v[212:215], v[64:67]
    s_add_u32 s58, s43, 8192
    buffer_load_dwordx4 v[204:207], v6, s[20:23], s58 offen offset:0 sc1
    v_mfma_f32_16x16x32_bf16 v[84:87], v[24:27], v[216:219], v[84:87]
    v_mfma_f32_16x16x32_bf16 v[104:107], v[24:27], v[220:223], v[104:107]
    s_waitcnt lgkmcnt(3)
    v_mfma_f32_16x16x32_bf16 v[48:51], v[28:31], v[208:211], v[48:51]
    ds_read_b128 v[24:27], v1 offset:13312
    v_mfma_f32_16x16x32_bf16 v[68:71], v[28:31], v[212:215], v[68:71]
    v_mfma_f32_16x16x32_bf16 v[88:91], v[28:31], v[216:219], v[88:91]
    v_mfma_f32_16x16x32_bf16 v[108:111], v[28:31], v[220:223], v[108:111]
    ds_read_b128 v[28:31], v1 offset:14336
    s_waitcnt vmcnt(17)
    s_waitcnt lgkmcnt(4)
    v_mfma_f32_16x16x32_bf16 v[32:35], v[12:15], v[224:227], v[32:35]
    v_mfma_f32_16x16x32_bf16 v[52:55], v[12:15], v[228:231], v[52:55]
    s_add_u32 s58, s78, 51200
    buffer_load_dwordx4 v[168:171], v7, s[20:23], s58 offen offset:0 sc1
    v_mfma_f32_16x16x32_bf16 v[72:75], v[12:15], v[232:235], v[72:75]
    v_mfma_f32_16x16x32_bf16 v[92:95], v[12:15], v[236:239], v[92:95]
    s_add_u32 s58, s78, 56320
    buffer_load_dwordx4 v[172:175], v6, s[20:23], s58 offen offset:0 sc1
    s_waitcnt lgkmcnt(3)
    v_mfma_f32_16x16x32_bf16 v[36:39], v[16:19], v[224:227], v[36:39]
    ds_read_b128 v[12:15], v1 offset:15360
    v_mfma_f32_16x16x32_bf16 v[56:59], v[16:19], v[228:231], v[56:59]
    s_add_u32 s58, s78, 56320
    buffer_load_dwordx4 v[176:179], v6, s[20:23], s58 offen offset:1024 sc1
    v_mfma_f32_16x16x32_bf16 v[76:79], v[16:19], v[232:235], v[76:79]
    v_mfma_f32_16x16x32_bf16 v[96:99], v[16:19], v[236:239], v[96:99]
    s_add_u32 s58, s40, 8192
    buffer_load_dwordx4 v[208:211], v6, s[20:23], s58 offen offset:1024 sc1
    s_waitcnt lgkmcnt(3)
    v_mfma_f32_16x16x32_bf16 v[40:43], v[20:23], v[224:227], v[40:43]
    ds_read_b128 v[16:19], v1 offset:16384
    v_mfma_f32_16x16x32_bf16 v[60:63], v[20:23], v[228:231], v[60:63]
    s_add_u32 s58, s41, 8192
    buffer_load_dwordx4 v[212:215], v6, s[20:23], s58 offen offset:1024 sc1
    v_mfma_f32_16x16x32_bf16 v[80:83], v[20:23], v[232:235], v[80:83]
    v_mfma_f32_16x16x32_bf16 v[100:103], v[20:23], v[236:239], v[100:103]
    s_add_u32 s58, s42, 8192
    buffer_load_dwordx4 v[216:219], v6, s[20:23], s58 offen offset:1024 sc1
    s_waitcnt lgkmcnt(3)
    v_mfma_f32_16x16x32_bf16 v[44:47], v[24:27], v[224:227], v[44:47]
    ds_read_b128 v[20:23], v1 offset:17408
    v_mfma_f32_16x16x32_bf16 v[64:67], v[24:27], v[228:231], v[64:67]
    s_add_u32 s58, s43, 8192
    buffer_load_dwordx4 v[220:223], v6, s[20:23], s58 offen offset:1024 sc1
    v_mfma_f32_16x16x32_bf16 v[84:87], v[24:27], v[232:235], v[84:87]
    v_mfma_f32_16x16x32_bf16 v[104:107], v[24:27], v[236:239], v[104:107]
    s_waitcnt lgkmcnt(3)
    v_mfma_f32_16x16x32_bf16 v[48:51], v[28:31], v[224:227], v[48:51]
    ds_read_b128 v[24:27], v1 offset:18432
    v_mfma_f32_16x16x32_bf16 v[68:71], v[28:31], v[228:231], v[68:71]
    v_mfma_f32_16x16x32_bf16 v[88:91], v[28:31], v[232:235], v[88:91]
    v_mfma_f32_16x16x32_bf16 v[108:111], v[28:31], v[236:239], v[108:111]
    ds_read_b128 v[28:31], v1 offset:19456
    s_waitcnt vmcnt(17)
    s_waitcnt lgkmcnt(4)
    v_mfma_f32_16x16x32_bf16 v[32:35], v[12:15], v[240:243], v[32:35]
    v_mfma_f32_16x16x32_bf16 v[52:55], v[12:15], v[244:247], v[52:55]
    s_add_u32 s58, s78, 56320
    buffer_load_dwordx4 v[180:183], v6, s[20:23], s58 offen offset:2048 sc1
    v_mfma_f32_16x16x32_bf16 v[72:75], v[12:15], v[248:251], v[72:75]
    v_mfma_f32_16x16x32_bf16 v[92:95], v[12:15], v[252:255], v[92:95]
    s_add_u32 s58, s78, 56320
    buffer_load_dwordx4 v[184:187], v6, s[20:23], s58 offen offset:3072 sc1
    s_waitcnt lgkmcnt(3)
    v_mfma_f32_16x16x32_bf16 v[36:39], v[16:19], v[240:243], v[36:39]
    v_mfma_f32_16x16x32_bf16 v[56:59], v[16:19], v[244:247], v[56:59]
    s_add_u32 s58, s78, 56320
    buffer_load_dwordx4 v[188:191], v7, s[20:23], s58 offen offset:0 sc1
    v_mfma_f32_16x16x32_bf16 v[76:79], v[16:19], v[248:251], v[76:79]
    v_mfma_f32_16x16x32_bf16 v[96:99], v[16:19], v[252:255], v[96:99]
    s_add_u32 s58, s40, 8192
    buffer_load_dwordx4 v[224:227], v6, s[20:23], s58 offen offset:2048 sc1
    s_waitcnt lgkmcnt(2)
    v_mfma_f32_16x16x32_bf16 v[40:43], v[20:23], v[240:243], v[40:43]
    v_mfma_f32_16x16x32_bf16 v[60:63], v[20:23], v[244:247], v[60:63]
    s_add_u32 s58, s41, 8192
    buffer_load_dwordx4 v[228:231], v6, s[20:23], s58 offen offset:2048 sc1
    v_mfma_f32_16x16x32_bf16 v[80:83], v[20:23], v[248:251], v[80:83]
    v_mfma_f32_16x16x32_bf16 v[100:103], v[20:23], v[252:255], v[100:103]
    s_add_u32 s58, s42, 8192
    buffer_load_dwordx4 v[232:235], v6, s[20:23], s58 offen offset:2048 sc1
    s_waitcnt lgkmcnt(1)
    v_mfma_f32_16x16x32_bf16 v[44:47], v[24:27], v[240:243], v[44:47]
    v_mfma_f32_16x16x32_bf16 v[64:67], v[24:27], v[244:247], v[64:67]
    s_add_u32 s58, s43, 8192
    buffer_load_dwordx4 v[236:239], v6, s[20:23], s58 offen offset:2048 sc1
    v_mfma_f32_16x16x32_bf16 v[84:87], v[24:27], v[248:251], v[84:87]
    v_mfma_f32_16x16x32_bf16 v[104:107], v[24:27], v[252:255], v[104:107]
    s_waitcnt lgkmcnt(0)
    v_mfma_f32_16x16x32_bf16 v[48:51], v[28:31], v[240:243], v[48:51]
    v_mfma_f32_16x16x32_bf16 v[68:71], v[28:31], v[244:247], v[68:71]
    v_mfma_f32_16x16x32_bf16 v[88:91], v[28:31], v[248:251], v[88:91]
    v_mfma_f32_16x16x32_bf16 v[108:111], v[28:31], v[252:255], v[108:111]
    v_mov_b32 v9, 256
    s_mov_b64 exec, 1
    ds_add_u32 v8, v9 offset:4
    s_mov_b64 exec, -1
    v_mov_b32 v9, 1
    s_mov_b64 exec, 1
    ds_add_u32 v8, v9 offset:32
    s_mov_b64 exec, -1
    s_waitcnt vmcnt(14)
    v_mfma_f32_16x16x32_bf16 v[32:35], v[112:115], v[192:195], v[32:35]
    v_mfma_f32_16x16x32_bf16 v[52:55], v[112:115], v[196:199], v[52:55]
    s_add_u32 s58, s40, 8192
    buffer_load_dwordx4 v[240:243], v6, s[20:23], s58 offen offset:3072 sc1
    v_mfma_f32_16x16x32_bf16 v[72:75], v[112:115], v[200:203], v[72:75]
    v_mfma_f32_16x16x32_bf16 v[92:95], v[112:115], v[204:207], v[92:95]
    s_add_u32 s58, s41, 8192
    buffer_load_dwordx4 v[244:247], v6, s[20:23], s58 offen offset:3072 sc1
    v_mfma_f32_16x16x32_bf16 v[36:39], v[116:119], v[192:195], v[36:39]
    v_mfma_f32_16x16x32_bf16 v[56:59], v[116:119], v[196:199], v[56:59]
    s_add_u32 s58, s42, 8192
    buffer_load_dwordx4 v[248:251], v6, s[20:23], s58 offen offset:3072 sc1
    v_mfma_f32_16x16x32_bf16 v[76:79], v[116:119], v[200:203], v[76:79]
    v_mfma_f32_16x16x32_bf16 v[96:99], v[116:119], v[204:207], v[96:99]
    s_add_u32 s58, s43, 8192
    buffer_load_dwordx4 v[252:255], v6, s[20:23], s58 offen offset:3072 sc1
    v_mfma_f32_16x16x32_bf16 v[40:43], v[120:123], v[192:195], v[40:43]
    v_mfma_f32_16x16x32_bf16 v[60:63], v[120:123], v[196:199], v[60:63]
    s_add_u32 s58, s47, 1
    s_and_b32 s58, s58, 3
    s_mul_i32 s58, s58, 15360
    s_add_u32 s58, s58, 0
    v_add_u32 v12, s58, v6
    v_mfma_f32_16x16x32_bf16 v[80:83], v[120:123], v[200:203], v[80:83]
    v_mfma_f32_16x16x32_bf16 v[100:103], v[120:123], v[204:207], v[100:103]
    s_add_u32 s58, s47, 2
    s_and_b32 s58, s58, 3
    s_mul_i32 s58, s58, 15360
    s_add_u32 s58, s58, 5120
    v_add_u32 v13, s58, v6
    v_mfma_f32_16x16x32_bf16 v[44:47], v[124:127], v[192:195], v[44:47]
    v_mfma_f32_16x16x32_bf16 v[64:67], v[124:127], v[196:199], v[64:67]
    s_add_u32 s58, s47, 3
    s_and_b32 s58, s58, 3
    s_mul_i32 s58, s58, 15360
    s_add_u32 s58, s58, 10240
    v_add_u32 v14, s58, v6
    v_mfma_f32_16x16x32_bf16 v[84:87], v[124:127], v[200:203], v[84:87]
    v_mfma_f32_16x16x32_bf16 v[104:107], v[124:127], v[204:207], v[104:107]
    s_mul_i32 s59, s47, 15360
    s_add_u32 s59, s59, 0
    v_add_u32 v10, s59, v6
    v_mfma_f32_16x16x32_bf16 v[48:51], v[128:131], v[192:195], v[48:51]
    v_mfma_f32_16x16x32_bf16 v[68:71], v[128:131], v[196:199], v[68:71]
    v_mfma_f32_16x16x32_bf16 v[88:91], v[128:131], v[200:203], v[88:91]
    v_mfma_f32_16x16x32_bf16 v[108:111], v[128:131], v[204:207], v[108:111]
    s_waitcnt vmcnt(11)
    v_mfma_f32_16x16x32_bf16 v[32:35], v[132:135], v[208:211], v[32:35]
    v_mfma_f32_16x16x32_bf16 v[52:55], v[132:135], v[212:215], v[52:55]
    ds_read_b32 v9, v8 offset:4
    v_mfma_f32_16x16x32_bf16 v[72:75], v[132:135], v[216:219], v[72:75]
    v_mfma_f32_16x16x32_bf16 v[92:95], v[132:135], v[220:223], v[92:95]
    v_mfma_f32_16x16x32_bf16 v[36:39], v[136:139], v[208:211], v[36:39]
    v_mfma_f32_16x16x32_bf16 v[56:59], v[136:139], v[212:215], v[56:59]
    v_mfma_f32_16x16x32_bf16 v[76:79], v[136:139], v[216:219], v[76:79]
    v_mfma_f32_16x16x32_bf16 v[96:99], v[136:139], v[220:223], v[96:99]
    v_mfma_f32_16x16x32_bf16 v[40:43], v[140:143], v[208:211], v[40:43]
    v_mfma_f32_16x16x32_bf16 v[60:63], v[140:143], v[212:215], v[60:63]
    v_mfma_f32_16x16x32_bf16 v[80:83], v[140:143], v[216:219], v[80:83]
    v_mfma_f32_16x16x32_bf16 v[100:103], v[140:143], v[220:223], v[100:103]
    v_mfma_f32_16x16x32_bf16 v[44:47], v[144:147], v[208:211], v[44:47]
    v_mfma_f32_16x16x32_bf16 v[64:67], v[144:147], v[212:215], v[64:67]
    v_mfma_f32_16x16x32_bf16 v[84:87], v[144:147], v[216:219], v[84:87]
    v_mfma_f32_16x16x32_bf16 v[104:107], v[144:147], v[220:223], v[104:107]
    v_mfma_f32_16x16x32_bf16 v[48:51], v[148:151], v[208:211], v[48:51]
    v_mfma_f32_16x16x32_bf16 v[68:71], v[148:151], v[212:215], v[68:71]
    v_mfma_f32_16x16x32_bf16 v[88:91], v[148:151], v[216:219], v[88:91]
    v_mfma_f32_16x16x32_bf16 v[108:111], v[148:151], v[220:223], v[108:111]
    s_waitcnt lgkmcnt(0)
    v_readfirstlane_b32 s58, v9
    s_nop 0
    s_cmp_ge_u32 s58, 0x400
    s_cbranch_scc1 L_stg
L_lw28:
    ds_read_b32 v9, v8 offset:4
    s_waitcnt lgkmcnt(0)
    v_readfirstlane_b32 s58, v9
    s_nop 0
    s_cmp_ge_u32 s58, 1024
    s_cbranch_scc1 L_lwd28
    s_sleep 1
    s_branch L_lw28
L_lwd28:
L_stg:
    s_waitcnt vmcnt(4)
    v_mfma_f32_16x16x32_bf16 v[52:55], v[152:155], v[228:231], v[52:55]
    v_mfma_f32_16x16x32_bf16 v[56:59], v[156:159], v[228:231], v[56:59]
    v_mfma_f32_16x16x32_bf16 v[60:63], v[160:163], v[228:231], v[60:63]
    v_mfma_f32_16x16x32_bf16 v[64:67], v[164:167], v[228:231], v[64:67]
    v_mfma_f32_16x16x32_bf16 v[68:71], v[168:171], v[228:231], v[68:71]
    s_waitcnt vmcnt(0)
    v_mfma_f32_16x16x32_bf16 v[52:55], v[172:175], v[244:247], v[52:55]
    v_mfma_f32_16x16x32_bf16 v[56:59], v[176:179], v[244:247], v[56:59]
    v_mfma_f32_16x16x32_bf16 v[60:63], v[180:183], v[244:247], v[60:63]
    v_mfma_f32_16x16x32_bf16 v[64:67], v[184:187], v[244:247], v[64:67]
    v_mfma_f32_16x16x32_bf16 v[68:71], v[188:191], v[244:247], v[68:71]
    v_mfma_f32_16x16x32_bf16 v[72:75], v[152:155], v[232:235], v[72:75]
    s_nop 2
    ds_write_b128 v12, v[52:55] offset:0
    v_mfma_f32_16x16x32_bf16 v[76:79], v[156:159], v[232:235], v[76:79]
    v_mfma_f32_16x16x32_bf16 v[80:83], v[160:163], v[232:235], v[80:83]
    ds_write_b128 v12, v[56:59] offset:1024
    v_mfma_f32_16x16x32_bf16 v[84:87], v[164:167], v[232:235], v[84:87]
    v_mfma_f32_16x16x32_bf16 v[88:91], v[168:171], v[232:235], v[88:91]
    ds_write_b128 v12, v[60:63] offset:2048
    v_mfma_f32_16x16x32_bf16 v[72:75], v[172:175], v[248:251], v[72:75]
    v_mfma_f32_16x16x32_bf16 v[76:79], v[176:179], v[248:251], v[76:79]
    ds_write_b128 v12, v[64:67] offset:3072
    v_mfma_f32_16x16x32_bf16 v[80:83], v[180:183], v[248:251], v[80:83]
    v_mfma_f32_16x16x32_bf16 v[84:87], v[184:187], v[248:251], v[84:87]
    ds_write_b128 v12, v[68:71] offset:4096
    v_mfma_f32_16x16x32_bf16 v[88:91], v[188:191], v[248:251], v[88:91]
    v_mfma_f32_16x16x32_bf16 v[92:95], v[152:155], v[236:239], v[92:95]
    s_nop 0
    ds_write_b128 v13, v[72:75] offset:0
    v_mfma_f32_16x16x32_bf16 v[96:99], v[156:159], v[236:239], v[96:99]
    v_mfma_f32_16x16x32_bf16 v[100:103], v[160:163], v[236:239], v[100:103]
    ds_write_b128 v13, v[76:79] offset:1024
    v_mfma_f32_16x16x32_bf16 v[104:107], v[164:167], v[236:239], v[104:107]
    v_mfma_f32_16x16x32_bf16 v[108:111], v[168:171], v[236:239], v[108:111]
    ds_write_b128 v13, v[80:83] offset:2048
    v_mfma_f32_16x16x32_bf16 v[92:95], v[172:175], v[252:255], v[92:95]
    v_mfma_f32_16x16x32_bf16 v[96:99], v[176:179], v[252:255], v[96:99]
    ds_write_b128 v13, v[84:87] offset:3072
    v_mfma_f32_16x16x32_bf16 v[100:103], v[180:183], v[252:255], v[100:103]
    v_mfma_f32_16x16x32_bf16 v[104:107], v[184:187], v[252:255], v[104:107]
    ds_write_b128 v13, v[88:91] offset:4096
    v_mfma_f32_16x16x32_bf16 v[108:111], v[188:191], v[252:255], v[108:111]
    v_mfma_f32_16x16x32_bf16 v[32:35], v[152:155], v[224:227], v[32:35]
    s_nop 0
    ds_write_b128 v14, v[92:95] offset:0
    v_mfma_f32_16x16x32_bf16 v[36:39], v[156:159], v[224:227], v[36:39]
    v_mfma_f32_16x16x32_bf16 v[40:43], v[160:163], v[224:227], v[40:43]
    ds_write_b128 v14, v[96:99] offset:1024
    v_mfma_f32_16x16x32_bf16 v[44:47], v[164:167], v[224:227], v[44:47]
    v_mfma_f32_16x16x32_bf16 v[48:51], v[168:171], v[224:227], v[48:51]
    ds_write_b128 v14, v[100:103] offset:2048
    v_mfma_f32_16x16x32_bf16 v[32:35], v[172:175], v[240:243], v[32:35]
    v_mfma_f32_16x16x32_bf16 v[36:39], v[176:179], v[240:243], v[36:39]
    ds_write_b128 v14, v[104:107] offset:3072
    v_mfma_f32_16x16x32_bf16 v[40:43], v[180:183], v[240:243], v[40:43]
    v_mfma_f32_16x16x32_bf16 v[44:47], v[184:187], v[240:243], v[44:47]
    ds_write_b128 v14, v[108:111] offset:4096
    v_mfma_f32_16x16x32_bf16 v[48:51], v[188:191], v[240:243], v[48:51]
    v_mov_b32 v9, 1
    s_mov_b64 exec, 1
    ds_add_u32 v8, v9 offset:0
    s_mov_b64 exec, -1
L_lw29:
    ds_read_b32 v9, v8 offset:0
    s_waitcnt lgkmcnt(0)
    v_readfirstlane_b32 s58, v9
    s_nop 0
    s_cmp_ge_u32 s58, 4
    s_cbranch_scc1 L_lwd29
    s_branch L_lw29
L_lwd29:
    ds_read_b128 v[52:55], v10 offset:0
    ds_read_b128 v[72:75], v10 offset:5120
    ds_read_b128 v[92:95], v10 offset:10240
    ds_read_b128 v[56:59], v10 offset:1024
    ds_read_b128 v[76:79], v10 offset:6144
    ds_read_b128 v[96:99], v10 offset:11264
    ds_read_b128 v[60:63], v10 offset:2048
    ds_read_b128 v[80:83], v10 offset:7168
    ds_read_b128 v[100:103], v10 offset:12288
    ds_read_b128 v[64:67], v10 offset:3072
    ds_read_b128 v[84:87], v10 offset:8192
    ds_read_b128 v[104:107], v10 offset:13312
    ds_read_b128 v[68:71], v10 offset:4096
    ds_read_b128 v[88:91], v10 offset:9216
    ds_read_b128 v[108:111], v10 offset:14336
    s_lshl_b32 s58, s47, 2
    v_add_u32 v8, s58, v8
    s_waitcnt lgkmcnt(12)
    v_add_f32 v32, v32, v52
    v_add_f32 v72, v72, v92
    v_add_f32 v33, v33, v53
    v_add_f32 v73, v73, v93
    v_add_f32 v34, v34, v54
    v_add_f32 v74, v74, v94
    v_add_f32 v35, v35, v55
    v_add_f32 v75, v75, v95
    v_add_f32 v32, v32, v72
    v_add_f32 v33, v33, v73
    v_add_f32 v34, v34, v74
    v_add_f32 v35, v35, v75
    v_mul_f32 v52, 0xbfb8aa3b, v32
    v_mul_f32 v53, 0xbfb8aa3b, v33
    v_mul_f32 v54, 0xbfb8aa3b, v34
    v_mul_f32 v55, 0xbfb8aa3b, v35
    v_exp_f32 v52, v52
    v_exp_f32 v53, v53
    v_exp_f32 v54, v54
    v_exp_f32 v55, v55
    v_add_f32 v52, 1.0, v52
    v_add_f32 v53, 1.0, v53
    v_add_f32 v54, 1.0, v54
    v_add_f32 v55, 1.0, v55
    v_rcp_f32 v52, v52
    v_rcp_f32 v53, v53
    v_rcp_f32 v54, v54
    v_rcp_f32 v55, v55
    v_mul_f32 v32, v32, v52
    v_mul_f32 v33, v33, v53
    v_mul_f32 v34, v34, v54
    v_mul_f32 v35, v35, v55
    ds_write_b128 v10, v[32:35] offset:0
    s_waitcnt lgkmcnt(10)
    v_add_f32 v36, v36, v56
    v_add_f32 v76, v76, v96
    v_add_f32 v37, v37, v57
    v_add_f32 v77, v77, v97
    v_add_f32 v38, v38, v58
    v_add_f32 v78, v78, v98
    v_add_f32 v39, v39, v59
    v_add_f32 v79, v79, v99
    v_add_f32 v36, v36, v76
    v_add_f32 v37, v37, v77
    v_add_f32 v38, v38, v78
    v_add_f32 v39, v39, v79
    v_mul_f32 v56, 0xbfb8aa3b, v36
    v_mul_f32 v57, 0xbfb8aa3b, v37
    v_mul_f32 v58, 0xbfb8aa3b, v38
    v_mul_f32 v59, 0xbfb8aa3b, v39
    v_exp_f32 v56, v56
    v_exp_f32 v57, v57
    v_exp_f32 v58, v58
    v_exp_f32 v59, v59
    v_add_f32 v56, 1.0, v56
    v_add_f32 v57, 1.0, v57
    v_add_f32 v58, 1.0, v58
    v_add_f32 v59, 1.0, v59
    v_rcp_f32 v56, v56
    v_rcp_f32 v57, v57
    v_rcp_f32 v58, v58
    v_rcp_f32 v59, v59
    v_mul_f32 v36, v36, v56
    v_mul_f32 v37, v37, v57
    v_mul_f32 v38, v38, v58
    v_mul_f32 v39, v39, v59
    ds_write_b128 v10, v[36:39] offset:1024
    s_waitcnt lgkmcnt(8)
    v_add_f32 v40, v40, v60
    v_add_f32 v80, v80, v100
    v_add_f32 v41, v41, v61
    v_add_f32 v81, v81, v101
    v_add_f32 v42, v42, v62
    v_add_f32 v82, v82, v102
    v_add_f32 v43, v43, v63
    v_add_f32 v83, v83, v103
    v_add_f32 v40, v40, v80
    v_add_f32 v41, v41, v81
    v_add_f32 v42, v42, v82
    v_add_f32 v43, v43, v83
    v_mul_f32 v60, 0xbfb8aa3b, v40
    v_mul_f32 v61, 0xbfb8aa3b, v41
    v_mul_f32 v62, 0xbfb8aa3b, v42
    v_mul_f32 v63, 0xbfb8aa3b, v43
    v_exp_f32 v60, v60
    v_exp_f32 v61, v61
    v_exp_f32 v62, v62
    v_exp_f32 v63, v63
    v_add_f32 v60, 1.0, v60
    v_add_f32 v61, 1.0, v61
    v_add_f32 v62, 1.0, v62
    v_add_f32 v63, 1.0, v63
    v_rcp_f32 v60, v60
    v_rcp_f32 v61, v61
    v_rcp_f32 v62, v62
    v_rcp_f32 v63, v63
    v_mul_f32 v40, v40, v60
    v_mul_f32 v41, v41, v61
    v_mul_f32 v42, v42, v62
    v_mul_f32 v43, v43, v63
    ds_write_b128 v10, v[40:43] offset:2048
    s_waitcnt lgkmcnt(6)
    v_add_f32 v44, v44, v64
    v_add_f32 v84, v84, v104
    v_add_f32 v45, v45, v65
    v_add_f32 v85, v85, v105
    v_add_f32 v46, v46, v66
    v_add_f32 v86, v86, v106
    v_add_f32 v47, v47, v67
    v_add_f32 v87, v87, v107
    v_add_f32 v44, v44, v84
    v_add_f32 v45, v45, v85
    v_add_f32 v46, v46, v86
    v_add_f32 v47, v47, v87
    v_mul_f32 v64, 0xbfb8aa3b, v44
    v_mul_f32 v65, 0xbfb8aa3b, v45
    v_mul_f32 v66, 0xbfb8aa3b, v46
    v_mul_f32 v67, 0xbfb8aa3b, v47
    v_exp_f32 v64, v64
    v_exp_f32 v65, v65
    v_exp_f32 v66, v66
    v_exp_f32 v67, v67
    v_add_f32 v64, 1.0, v64
    v_add_f32 v65, 1.0, v65
    v_add_f32 v66, 1.0, v66
    v_add_f32 v67, 1.0, v67
    v_rcp_f32 v64, v64
    v_rcp_f32 v65, v65
    v_rcp_f32 v66, v66
    v_rcp_f32 v67, v67
    v_mul_f32 v44, v44, v64
    v_mul_f32 v45, v45, v65
    v_mul_f32 v46, v46, v66
    v_mul_f32 v47, v47, v67
    ds_write_b128 v10, v[44:47] offset:3072
    s_waitcnt lgkmcnt(4)
    v_add_f32 v48, v48, v68
    v_add_f32 v88, v88, v108
    v_add_f32 v49, v49, v69
    v_add_f32 v89, v89, v109
    v_add_f32 v50, v50, v70
    v_add_f32 v90, v90, v110
    v_add_f32 v51, v51, v71
    v_add_f32 v91, v91, v111
    v_add_f32 v48, v48, v88
    v_add_f32 v49, v49, v89
    v_add_f32 v50, v50, v90
    v_add_f32 v51, v51, v91
    v_mul_f32 v68, 0xbfb8aa3b, v48
    v_mul_f32 v69, 0xbfb8aa3b, v49
    v_mul_f32 v70, 0xbfb8aa3b, v50
    v_mul_f32 v71, 0xbfb8aa3b, v51
    v_exp_f32 v68, v68
    v_exp_f32 v69, v69
    v_exp_f32 v70, v70
    v_exp_f32 v71, v71
    v_add_f32 v68, 1.0, v68
    v_add_f32 v69, 1.0, v69
    v_add_f32 v70, 1.0, v70
    v_add_f32 v71, 1.0, v71
    v_rcp_f32 v68, v68
    v_rcp_f32 v69, v69
    v_rcp_f32 v70, v70
    v_rcp_f32 v71, v71
    v_mul_f32 v48, v48, v68
    v_mul_f32 v49, v49, v69
    v_mul_f32 v50, v50, v70
    v_mul_f32 v51, v51, v71
    ds_write_b128 v10, v[48:51] offset:4096
    v_mov_b32 v9, 1
    s_mov_b64 exec, 1
    ds_add_u32 v8, v9 offset:48
    s_mov_b64 exec, -1
    s_endpgm
L_pslow12:
    s_mov_b32 s73, 0
L_ploop12:
    s_sleep 8
    buffer_load_dword v11, v2, s[20:23], 0 offen sc1
    s_waitcnt vmcnt(0)
    v_cmp_le_u32 vcc, 5, v11
    s_nop 0
    s_cmp_eq_u64 vcc, -1
    s_cbranch_scc1 L_pok12
    s_add_u32 s73, s73, 1
    s_cmp_lt_u32 s73, 16000
    s_cbranch_scc1 L_ploop12
    s_branch L_pok12
L_pslow16:
    s_mov_b32 s73, 0
L_ploop16:
    s_sleep 6
    buffer_load_dword v9, v8, s[24:27], 0 offen sc1
    s_waitcnt vmcnt(0)
    v_cmp_le_u32 vcc, 1, v9
    s_nop 0
    s_cmp_eq_u64 vcc, -1
    s_cbranch_scc1 L_pok16
    s_add_u32 s73, s73, 1
    s_cmp_lt_u32 s73, 16000
    s_cbranch_scc1 L_ploop16
    s_branch L_pok16
L_pslow18:
    s_mov_b32 s73, 0
L_ploop18:
    s_sleep 6
    buffer_load_dword v9, v8, s[20:23], 0 offen sc1
    s_waitcnt vmcnt(0)
    v_cmp_le_u32 vcc, 1, v9
    s_nop 0
    s_cmp_eq_u64 vcc, -1
    s_cbranch_scc1 L_pok18
    s_add_u32 s73, s73, 1
    s_cmp_lt_u32 s73, 16000
    s_cbranch_scc1 L_ploop18
    s_branch L_pok18
L_pslow21:
    s_mov_b32 s73, 0
L_ploop21:
    s_sleep 6
    buffer_load_dword v9, v8, s[20:23], 0 offen sc1
    s_waitcnt vmcnt(0)
    v_cmp_le_u32 vcc, 2, v9
    s_nop 0
    s_cmp_eq_u64 vcc, -1
    s_cbranch_scc1 L_pok21
    s_add_u32 s73, s73, 1
    s_cmp_lt_u32 s73, 16000
    s_cbranch_scc1 L_ploop21
    s_branch L_pok21
L_pslow23:
    s_mov_b32 s73, 0
L_ploop23:
    s_sleep 6
    buffer_load_dword v9, v8, s[20:23], 0 offen sc1
    s_waitcnt vmcnt(0)
    v_cmp_le_u32 vcc, 3, v9
    s_nop 0
    s_cmp_eq_u64 vcc, -1
    s_cbranch_scc1 L_pok23
    s_add_u32 s73, s73, 1
    s_cmp_lt_u32 s73, 16000
    s_cbranch_scc1 L_ploop23
    s_branch L_pok23
L_pslow25:
    s_mov_b32 s73, 0
L_ploop25:
    s_sleep 8
    buffer_load_dword v11, v10, s[20:23], s79 offen sc1
    s_waitcnt vmcnt(0)
    v_cmp_le_u32 vcc, 4, v11
    s_nop 0
    s_cmp_eq_u64 vcc, -1
    s_cbranch_scc1 L_pok25
    s_add_u32 s73, s73, 1
    s_cmp_lt_u32 s73, 16000
    s_cbranch_scc1 L_ploop25
    s_branch L_pok25
L_fallback:
    s_nop 7
    s_nop 7
    v_mov_b32 v9, 0xff800000
    v_mov_b32 v8, 0xff800000
    s_lshl2_add_u32 s58, s69, s47
    s_sub_i32 s58, 8, s58
    s_max_i32 s58, s58, 0
L_fb0:
    s_lshl_b32 s59, s58, 9
    v_add_u32 v88, s59, v86
    v_add_u32 v89, s59, v87
    v_add_u32 v90, s59, v3
    ds_read_b128 v[20:23], v88 offset:0
    ds_read_b64 v[24:25], v89 offset:0
    s_cmp_eq_u32 s58, 0
    s_cselect_b32 s55, -1, 0
    s_and_b32 s59, s58, 7
    s_cselect_b32 s54, -1, 0
    s_waitcnt lgkmcnt(0)
    v_mfma_f32_32x32x16_bf16 v[48:63], v[20:23], v[80:83], 0
    v_mfma_f32_32x32x8_bf16 v[48:63], v[24:25], v[84:85], v[48:63]
    s_lshl_b32 s60, -1, 0
    s_lshl_b32 s61, -1, 4
    s_xor_b32 s60, s60, s55
    s_xor_b32 s61, s61, s55
    s_or_b32 s60, s60, s54
    s_or_b32 s61, s61, s54
    s_nop 5
    v_cndmask_b32 v48, v9, v48, s[60:61]
    s_lshl_b32 s60, -1, 1
    s_lshl_b32 s61, -1, 5
    s_xor_b32 s60, s60, s55
    s_xor_b32 s61, s61, s55
    s_or_b32 s60, s60, s54
    s_or_b32 s61, s61, s54
    v_cndmask_b32 v49, v9, v49, s[60:61]
    s_lshl_b32 s60, -1, 2
    s_lshl_b32 s61, -1, 6
    s_xor_b32 s60, s60, s55
    s_xor_b32 s61, s61, s55
    s_or_b32 s60, s60, s54
    s_or_b32 s61, s61, s54
    v_cndmask_b32 v50, v9, v50, s[60:61]
    s_lshl_b32 s60, -1, 3
    s_lshl_b32 s61, -1, 7
    s_xor_b32 s60, s60, s55
    s_xor_b32 s61, s61, s55
    s_or_b32 s60, s60, s54
    s_or_b32 s61, s61, s54
    v_cndmask_b32 v51, v9, v51, s[60:61]
    s_lshl_b32 s60, -1, 8
    s_lshl_b32 s61, -1, 12
    s_xor_b32 s60, s60, s55
    s_xor_b32 s61, s61, s55
    s_or_b32 s60, s60, s54
    s_or_b32 s61, s61, s54
    v_cndmask_b32 v52, v9, v52, s[60:61]
    s_lshl_b32 s60, -1, 9
    s_lshl_b32 s61, -1, 13
    s_xor_b32 s60, s60, s55
    s_xor_b32 s61, s61, s55
    s_or_b32 s60, s60, s54
    s_or_b32 s61, s61, s54
    v_cndmask_b32 v53, v9, v53, s[60:61]
    s_lshl_b32 s60, -1, 10
    s_lshl_b32 s61, -1, 14
    s_xor_b32 s60, s60, s55
    s_xor_b32 s61, s61, s55
    s_or_b32 s60, s60, s54
    s_or_b32 s61, s61, s54
    v_cndmask_b32 v54, v9, v54, s[60:61]
    s_lshl_b32 s60, -1, 11
    s_lshl_b32 s61, -1, 15
    s_xor_b32 s60, s60, s55
    s_xor_b32 s61, s61, s55
    s_or_b32 s60, s60, s54
    s_or_b32 s61, s61, s54
    v_cndmask_b32 v55, v9, v55, s[60:61]
    s_lshl_b32 s60, -1, 16
    s_lshl_b32 s61, -1, 20
    s_xor_b32 s60, s60, s55
    s_xor_b32 s61, s61, s55
    s_or_b32 s60, s60, s54
    s_or_b32 s61, s61, s54
    v_cndmask_b32 v56, v9, v56, s[60:61]
    s_lshl_b32 s60, -1, 17
    s_lshl_b32 s61, -1, 21
    s_xor_b32 s60, s60, s55
    s_xor_b32 s61, s61, s55
    s_or_b32 s60, s60, s54
    s_or_b32 s61, s61, s54
    v_cndmask_b32 v57, v9, v57, s[60:61]
    s_lshl_b32 s60, -1, 18
    s_lshl_b32 s61, -1, 22
    s_xor_b32 s60, s60, s55
    s_xor_b32 s61, s61, s55
    s_or_b32 s60, s60, s54
    s_or_b32 s61, s61, s54
    v_cndmask_b32 v58, v9, v58, s[60:61]
    s_lshl_b32 s60, -1, 19
    s_lshl_b32 s61, -1, 23
    s_xor_b32 s60, s60, s55
    s_xor_b32 s61, s61, s55
    s_or_b32 s60, s60, s54
    s_or_b32 s61, s61, s54
    v_cndmask_b32 v59, v9, v59, s[60:61]
    s_lshl_b32 s60, -1, 24
    s_lshl_b32 s61, -1, 28
    s_xor_b32 s60, s60, s55
    s_xor_b32 s61, s61, s55
    s_or_b32 s60, s60, s54
    s_or_b32 s61, s61, s54
    v_cndmask_b32 v60, v9, v60, s[60:61]
    s_lshl_b32 s60, -1, 25
    s_lshl_b32 s61, -1, 29
    s_xor_b32 s60, s60, s55
    s_xor_b32 s61, s61, s55
    s_or_b32 s60, s60, s54
    s_or_b32 s61, s61, s54
    v_cndmask_b32 v61, v9, v61, s[60:61]
    s_lshl_b32 s60, -1, 26
    s_lshl_b32 s61, -1, 30
    s_xor_b32 s60, s60, s55
    s_xor_b32 s61, s61, s55
    s_or_b32 s60, s60, s54
    s_or_b32 s61, s61, s54
    v_cndmask_b32 v62, v9, v62, s[60:61]
    s_lshl_b32 s60, -1, 27
    s_lshl_b32 s61, -1, 31
    s_xor_b32 s60, s60, s55
    s_xor_b32 s61, s61, s55
    s_or_b32 s60, s60, s54
    s_or_b32 s61, s61, s54
    v_cndmask_b32 v63, v9, v63, s[60:61]
    v_max3_f32 v8, v8, v48, v49
    v_max3_f32 v8, v8, v50, v51
    v_max3_f32 v8, v8, v52, v53
    v_max3_f32 v8, v8, v54, v55
    v_max3_f32 v8, v8, v56, v57
    v_max3_f32 v8, v8, v58, v59
    v_max3_f32 v8, v8, v60, v61
    v_max3_f32 v8, v8, v62, v63
    s_nop 1
    s_add_u32 s58, s58, 1
    s_cmp_le_u32 s58, 8
    s_cbranch_scc1 L_fb0
    v_mov_b32 v88, v8
    s_nop 1
    v_permlane32_swap_b32 v8, v88
    v_max_f32 v8, v8, v88
    v_mov_b32 v96, 0
    v_mov_b32 v97, 0
    v_mov_b32 v98, 0
    v_mov_b32 v99, 0
    v_mov_b32 v100, 0
    v_mov_b32 v101, 0
    v_mov_b32 v102, 0
    v_mov_b32 v103, 0
    v_mov_b32 v104, 0
    v_mov_b32 v105, 0
    v_mov_b32 v106, 0
    v_mov_b32 v107, 0
    v_mov_b32 v108, 0
    v_mov_b32 v109, 0
    v_mov_b32 v110, 0
    v_mov_b32 v111, 0
    s_lshl2_add_u32 s58, s69, s47
    s_sub_i32 s58, 8, s58
    s_max_i32 s58, s58, 0
L_fb1:
    s_lshl_b32 s59, s58, 9
    v_add_u32 v88, s59, v86
    v_add_u32 v89, s59, v87
    v_add_u32 v90, s59, v3
    ds_read_b128 v[20:23], v88 offset:0
    ds_read_b64 v[24:25], v89 offset:0
    ds_read_b64_tr_b16 v[40:41], v90 offset:0
    ds_read_b64_tr_b16 v[42:43], v90 offset:128
    ds_read_b64_tr_b16 v[44:45], v90 offset:256
    ds_read_b64_tr_b16 v[46:47], v90 offset:384
    s_cmp_eq_u32 s58, 0
    s_cselect_b32 s55, -1, 0
    s_and_b32 s59, s58, 7
    s_cselect_b32 s54, -1, 0
    s_waitcnt lgkmcnt(0)
    v_mfma_f32_32x32x16_bf16 v[48:63], v[20:23], v[80:83], 0
    v_mfma_f32_32x32x8_bf16 v[48:63], v[24:25], v[84:85], v[48:63]
    s_lshl_b32 s60, -1, 0
    s_lshl_b32 s61, -1, 4
    s_xor_b32 s60, s60, s55
    s_xor_b32 s61, s61, s55
    s_or_b32 s60, s60, s54
    s_or_b32 s61, s61, s54
    s_nop 5
    v_cndmask_b32 v48, v9, v48, s[60:61]
    s_lshl_b32 s60, -1, 1
    s_lshl_b32 s61, -1, 5
    s_xor_b32 s60, s60, s55
    s_xor_b32 s61, s61, s55
    s_or_b32 s60, s60, s54
    s_or_b32 s61, s61, s54
    v_cndmask_b32 v49, v9, v49, s[60:61]
    s_lshl_b32 s60, -1, 2
    s_lshl_b32 s61, -1, 6
    s_xor_b32 s60, s60, s55
    s_xor_b32 s61, s61, s55
    s_or_b32 s60, s60, s54
    s_or_b32 s61, s61, s54
    v_cndmask_b32 v50, v9, v50, s[60:61]
    s_lshl_b32 s60, -1, 3
    s_lshl_b32 s61, -1, 7
    s_xor_b32 s60, s60, s55
    s_xor_b32 s61, s61, s55
    s_or_b32 s60, s60, s54
    s_or_b32 s61, s61, s54
    v_cndmask_b32 v51, v9, v51, s[60:61]
    s_lshl_b32 s60, -1, 8
    s_lshl_b32 s61, -1, 12
    s_xor_b32 s60, s60, s55
    s_xor_b32 s61, s61, s55
    s_or_b32 s60, s60, s54
    s_or_b32 s61, s61, s54
    v_cndmask_b32 v52, v9, v52, s[60:61]
    s_lshl_b32 s60, -1, 9
    s_lshl_b32 s61, -1, 13
    s_xor_b32 s60, s60, s55
    s_xor_b32 s61, s61, s55
    s_or_b32 s60, s60, s54
    s_or_b32 s61, s61, s54
    v_cndmask_b32 v53, v9, v53, s[60:61]
    s_lshl_b32 s60, -1, 10
    s_lshl_b32 s61, -1, 14
    s_xor_b32 s60, s60, s55
    s_xor_b32 s61, s61, s55
    s_or_b32 s60, s60, s54
    s_or_b32 s61, s61, s54
    v_cndmask_b32 v54, v9, v54, s[60:61]
    s_lshl_b32 s60, -1, 11
    s_lshl_b32 s61, -1, 15
    s_xor_b32 s60, s60, s55
    s_xor_b32 s61, s61, s55
    s_or_b32 s60, s60, s54
    s_or_b32 s61, s61, s54
    v_cndmask_b32 v55, v9, v55, s[60:61]
    s_lshl_b32 s60, -1, 16
    s_lshl_b32 s61, -1, 20
    s_xor_b32 s60, s60, s55
    s_xor_b32 s61, s61, s55
    s_or_b32 s60, s60, s54
    s_or_b32 s61, s61, s54
    v_cndmask_b32 v56, v9, v56, s[60:61]
    s_lshl_b32 s60, -1, 17
    s_lshl_b32 s61, -1, 21
    s_xor_b32 s60, s60, s55
    s_xor_b32 s61, s61, s55
    s_or_b32 s60, s60, s54
    s_or_b32 s61, s61, s54
    v_cndmask_b32 v57, v9, v57, s[60:61]
    s_lshl_b32 s60, -1, 18
    s_lshl_b32 s61, -1, 22
    s_xor_b32 s60, s60, s55
    s_xor_b32 s61, s61, s55
    s_or_b32 s60, s60, s54
    s_or_b32 s61, s61, s54
    v_cndmask_b32 v58, v9, v58, s[60:61]
    s_lshl_b32 s60, -1, 19
    s_lshl_b32 s61, -1, 23
    s_xor_b32 s60, s60, s55
    s_xor_b32 s61, s61, s55
    s_or_b32 s60, s60, s54
    s_or_b32 s61, s61, s54
    v_cndmask_b32 v59, v9, v59, s[60:61]
    s_lshl_b32 s60, -1, 24
    s_lshl_b32 s61, -1, 28
    s_xor_b32 s60, s60, s55
    s_xor_b32 s61, s61, s55
    s_or_b32 s60, s60, s54
    s_or_b32 s61, s61, s54
    v_cndmask_b32 v60, v9, v60, s[60:61]
    s_lshl_b32 s60, -1, 25
    s_lshl_b32 s61, -1, 29
    s_xor_b32 s60, s60, s55
    s_xor_b32 s61, s61, s55
    s_or_b32 s60, s60, s54
    s_or_b32 s61, s61, s54
    v_cndmask_b32 v61, v9, v61, s[60:61]
    s_lshl_b32 s60, -1, 26
    s_lshl_b32 s61, -1, 30
    s_xor_b32 s60, s60, s55
    s_xor_b32 s61, s61, s55
    s_or_b32 s60, s60, s54
    s_or_b32 s61, s61, s54
    v_cndmask_b32 v62, v9, v62, s[60:61]
    s_lshl_b32 s60, -1, 27
    s_lshl_b32 s61, -1, 31
    s_xor_b32 s60, s60, s55
    s_xor_b32 s61, s61, s55
    s_or_b32 s60, s60, s54
    s_or_b32 s61, s61, s54
    v_cndmask_b32 v63, v9, v63, s[60:61]
    v_sub_f32 v48, v48, v8
    v_sub_f32 v49, v49, v8
    v_sub_f32 v50, v50, v8
    v_sub_f32 v51, v51, v8
    v_sub_f32 v52, v52, v8
    v_sub_f32 v53, v53, v8
    v_sub_f32 v54, v54, v8
    v_sub_f32 v55, v55, v8
    v_sub_f32 v56, v56, v8
    v_sub_f32 v57, v57, v8
    v_sub_f32 v58, v58, v8
    v_sub_f32 v59, v59, v8
    v_sub_f32 v60, v60, v8
    v_sub_f32 v61, v61, v8
    v_sub_f32 v62, v62, v8
    v_sub_f32 v63, v63, v8
    v_exp_f32 v48, v48
    v_exp_f32 v49, v49
    v_exp_f32 v50, v50
    v_exp_f32 v51, v51
    v_exp_f32 v52, v52
    v_exp_f32 v53, v53
    v_exp_f32 v54, v54
    v_exp_f32 v55, v55
    v_exp_f32 v56, v56
    v_exp_f32 v57, v57
    v_exp_f32 v58, v58
    v_exp_f32 v59, v59
    v_exp_f32 v60, v60
    v_exp_f32 v61, v61
    v_exp_f32 v62, v62
    v_exp_f32 v63, v63
    v_cvt_pk_bf16_f32 v32, v48, v49
    v_cvt_pk_bf16_f32 v33, v50, v51
    v_cvt_pk_bf16_f32 v34, v52, v53
    v_cvt_pk_bf16_f32 v35, v54, v55
    v_cvt_pk_bf16_f32 v36, v56, v57
    v_cvt_pk_bf16_f32 v37, v58, v59
    v_cvt_pk_bf16_f32 v38, v60, v61
    v_cvt_pk_bf16_f32 v39, v62, v63
    v_mfma_f32_32x32x16_bf16 v[96:111], v[40:43], v[32:35], v[96:111]
    s_nop 0
    v_mfma_f32_32x32x16_bf16 v[96:111], v[44:47], v[36:39], v[96:111]
    s_nop 11
    s_add_u32 s58, s58, 1
    s_cmp_le_u32 s58, 8
    s_cbranch_scc1 L_fb1
    s_setpc_b64 s[62:63]
L_end:
    s_endpgm
.section .rodata,"a"
.p2align 6
.amdhsa_kernel recurrent_scan__sliding_block__swiglu_ffn__prompt_kernel
  .amdhsa_next_free_vgpr 256
  .amdhsa_next_free_sgpr 102
  .amdhsa_accum_offset 256
  .amdhsa_group_segment_fixed_size 0
  .amdhsa_kernarg_size 80
  .amdhsa_user_sgpr_count 2
  .amdhsa_user_sgpr_kernarg_segment_ptr 1
  .amdhsa_system_sgpr_workgroup_id_x 1
.end_amdhsa_kernel
```
